```python
import torch

def _softmax(x, axis=-1):
    return torch.softmax(x, dim=axis)
def _gelu(x):
    return torch.nn.functional.gelu(x, approximate="tanh")
def _silu(x):
    return torch.nn.functional.silu(x)
def _sigmoid(x):
    return torch.sigmoid(x)
def _layernorm(x, axis=-1, eps=1e-5):
    m = x.mean(dim=axis, keepdim=True)
    v = x.var(dim=axis, keepdim=True, unbiased=False)
    return (x - m) / torch.sqrt(v + eps)
def _scatter_add(tgt, idx, src, axis=0):
    return tgt.clone().index_add_(axis, idx, src)
def _segment_sum(src, seg, n):
    out = torch.zeros((n,) + src.shape[1:], dtype=src.dtype)
    return out.index_add_(0, seg, src)
def _pad(x, pw):
    flat = tuple(v for pair in reversed(pw) for v in pair)
    return torch.nn.functional.pad(x, flat)

kernel_name = 'interleave_layers__grouped_kv_mqa__moe_arch_mod__prompt'

def setup_inputs():

    _w = (lambda a: (lambda t: t.to(torch.bfloat16) if t.is_floating_point() else t)(torch.as_tensor(a)))
    def _A_setup():
        B, S, D, H = 1, 2048, 640, 32
        Dh = D // H
        return {
            "x": _w((lambda *s: torch.randn(*s, dtype=torch.bfloat16) * 0.05)(B, S, D)),
            "wq": _w((lambda *s: torch.randn(*s, dtype=torch.bfloat16) * 0.05)(D, H * Dh)),
            "wk": _w((lambda *s: torch.randn(*s, dtype=torch.bfloat16) * 0.05)(D, Dh)),
            "wv": _w((lambda *s: torch.randn(*s, dtype=torch.bfloat16) * 0.05)(D, Dh)),
            "wo": _w((lambda *s: torch.randn(*s, dtype=torch.bfloat16) * 0.05)(H * Dh, D)),
        }
    _A_in = _A_setup()

    def _B_setup():
        B, S, D, F, C = 1, 2048, 640, 1728, 2
        return {
            "x": _w((lambda *s: torch.randn(*s, dtype=torch.bfloat16) * 0.05)(B, S, D)),
            "w_r": _w((lambda *s: torch.randn(*s, dtype=torch.bfloat16) * 0.05)(D)),
            "w_gate": _w((lambda *s: torch.randn(*s, dtype=torch.bfloat16) * 0.05)(D, F)),
            "w_up": _w((lambda *s: torch.randn(*s, dtype=torch.bfloat16) * 0.05)(D, F)),
            "w_down": _w((lambda *s: torch.randn(*s, dtype=torch.bfloat16) * 0.05)(F, D)),
        }
    _B_in = _B_setup()

    return {
        "A_x": _A_in["x"],
        "A_wq": _A_in["wq"],
        "A_wk": _A_in["wk"],
        "A_wv": _A_in["wv"],
        "A_wo": _A_in["wo"],
        "B_x": _B_in["x"],
        "B_w_r": _B_in["w_r"],
        "B_w_gate": _B_in["w_gate"],
        "B_w_up": _B_in["w_up"],
        "B_w_down": _B_in["w_down"],
    }

def reference(A_x, A_wq, A_wk, A_wv, A_wo, B_x, B_w_r, B_w_gate, B_w_up, B_w_down):
    def _A_ref(x, wq, wk, wv, wo):
        B, S, D = x.shape
        H = 32
        Dh = D // H
        q = (lambda x, *d: x.permute(*d))((x @ wq).reshape(B, S, H, Dh), 0, 2, 1, 3)
        k = x @ wk
        v = x @ wv
        scores = torch.einsum("bhqd,bkd->bhqk", q, k) * (Dh ** -0.5)
        p = _softmax(scores, axis=-1)
        o = torch.einsum("bhqk,bkd->bhqd", p, v)
        return (lambda x, *d: x.permute(*d))(o, 0, 2, 1, 3).reshape(B, S, H * Dh) @ wo

    def _B_ref(x, w_r, w_gate, w_up, w_down):
        B, S, D = x.shape
        C = 2
        r = x @ w_r
        idx = torch.argsort(-r, axis=-1)[:, :C]
        idx_e = (lambda x, n, axis: torch.repeat_interleave(x, n, dim=axis))(idx.reshape(B, C, 1), D, axis=2)
        x_sel = (lambda x, i, axis: torch.take_along_dim(x, i, dim=axis))(x, idx_e, axis=1)
        g = _silu(x_sel @ w_gate)
        u = x_sel @ w_up
        y = (g * u) @ w_down
        r_sel = _sigmoid((lambda x, i, axis: torch.take_along_dim(x, i, dim=axis))(r, idx, axis=1))
        y = y * r_sel.reshape(B, C, 1)
        b_off = (torch.arange(B) * S).reshape(B, 1)
        flat_idx = (idx + b_off).reshape(B * C)
        zero = (x * 0.0).reshape(B * S, D)
        upd = _scatter_add(zero, flat_idx, y.reshape(B * C, D), axis=0)
        return x + upd.reshape(B, S, D)

    x = A_x
    x = x + _A_ref(_layernorm(x, axis=-1), A_wq, A_wk, A_wv, A_wo)
    x = x + _B_ref(_layernorm(x, axis=-1), B_w_r, B_w_gate, B_w_up, B_w_down)
    x = x + _A_ref(_layernorm(x, axis=-1), A_wq, A_wk, A_wv, A_wo)
    x = x + _B_ref(_layernorm(x, axis=-1), B_w_r, B_w_gate, B_w_up, B_w_down)
    return x
```

```asm
; @launch grid=(256,1,1) block=(512,1,1) lds=163840
.amdgcn_target "amdgcn-amd-amdhsa--gfx950"
.text
.globl interleave_layers__grouped_kv_mqa__moe_arch_mod__prompt_kernel
.p2align 8
.type interleave_layers__grouped_kv_mqa__moe_arch_mod__prompt_kernel,@function
interleave_layers__grouped_kv_mqa__moe_arch_mod__prompt_kernel:
  s_cmp_ge_u32 s2, 256
  s_cbranch_scc1 L_EXIT
  s_load_dwordx16 s[36:51], s[0:1], 0
  s_load_dwordx8 s[52:59], s[0:1], 64
  s_load_dwordx2 s[60:61], s[0:1], 96
  v_lshrrev_b32 v6, 6, v0
  v_and_b32 v1, 63, v0
  v_readfirstlane_b32 s6, v6
  s_and_b32 s20, s2, 7
  s_lshl_b32 s20, s20, 5
  s_lshr_b32 s21, s2, 3
  s_add_u32 s3, s20, s21
  s_lshr_b32 s4, s3, 3
  s_and_b32 s5, s3, 7
  s_mov_b32 s8, 0
  v_lshlrev_b32 v0, 4, v1
  s_lshl_b32 s20, s6, 2
  v_lshrrev_b32 v6, 4, v1
  v_add_u32 v6, s20, v6
  v_xor_b32 v7, v6, v1
  v_and_b32 v7, 15, v7
  v_mul_u32_u24 v6, 1280, v6
  v_lshl_add_u32 v10, v7, 4, v6
  s_mul_i32 s23, s4, 81920
  s_lshl_b32 s22, s6, 10
  s_mul_i32 s24, s6, 3200
  s_waitcnt lgkmcnt(0)
  s_lshl_b32 s20, s3, 3
  s_add_u32 s20, s20, s6
  s_cmp_eq_u32 s20, 4
  s_cbranch_scc0 L_nononce
  s_memrealtime s[20:21]
  s_waitcnt lgkmcnt(0)
  s_or_b32 s20, s20, 1
  v_mov_b32 v6, s20
  v_mov_b32 v7, 0
  global_store_dword v7, v6, s[58:59] sc1
  s_nop 0
L_nononce:
  s_add_u32 s66, s36, s23
  s_addc_u32 s67, s37, 0
  s_add_u32 s64, s66, 0
  s_addc_u32 s65, s67, 0
  s_add_u32 m0, s22, 71680
  s_nop 0
  global_load_lds_dwordx4 v10, s[64:65]
  s_add_u32 s64, s66, 40960
  s_addc_u32 s65, s67, 0
  s_add_u32 m0, s22, 112640
  s_nop 0
  global_load_lds_dwordx4 v10, s[64:65]
  s_add_u32 s64, s66, 256
  s_addc_u32 s65, s67, 0
  s_add_u32 m0, s22, 79872
  s_nop 0
  global_load_lds_dwordx4 v10, s[64:65]
  s_add_u32 s64, s66, 41216
  s_addc_u32 s65, s67, 0
  s_add_u32 m0, s22, 120832
  s_nop 0
  global_load_lds_dwordx4 v10, s[64:65]
  s_add_u32 s64, s66, 512
  s_addc_u32 s65, s67, 0
  s_add_u32 m0, s22, 88064
  s_nop 0
  global_load_lds_dwordx4 v10, s[64:65]
  s_add_u32 s64, s66, 41472
  s_addc_u32 s65, s67, 0
  s_add_u32 m0, s22, 129024
  s_nop 0
  global_load_lds_dwordx4 v10, s[64:65]
  s_add_u32 s64, s66, 768
  s_addc_u32 s65, s67, 0
  s_add_u32 m0, s22, 96256
  s_nop 0
  global_load_lds_dwordx4 v10, s[64:65]
  s_add_u32 s64, s66, 41728
  s_addc_u32 s65, s67, 0
  s_add_u32 m0, s22, 137216
  s_nop 0
  global_load_lds_dwordx4 v10, s[64:65]
  s_add_u32 s64, s66, 1024
  s_addc_u32 s65, s67, 0
  s_add_u32 m0, s22, 104448
  s_nop 0
  global_load_lds_dwordx4 v10, s[64:65]
  s_add_u32 s64, s66, 41984
  s_addc_u32 s65, s67, 0
  s_add_u32 m0, s22, 145408
  s_nop 0
  global_load_lds_dwordx4 v10, s[64:65]
  s_bitcmp1_b32 s5, 0
  s_cselect_b32 s70, s42, s40
  s_cselect_b32 s71, s43, s41
  s_add_u32 s64, s70, s24
  s_addc_u32 s65, s71, 0
  s_add_u32 m0, s24, 0
  s_nop 0
  global_load_lds_dwordx4 v0, s[64:65] offset:0
  global_load_lds_dwordx4 v0, s[64:65] offset:1024
  global_load_lds_dwordx4 v0, s[64:65] offset:2048
  s_mov_b64 exec, 0xff
  global_load_lds_dwordx4 v0, s[64:65] offset:3072
  s_mov_b64 exec, -1
  s_and_b32 s25, s3, 31
  s_cmp_lt_u32 s6, 4
  s_cbranch_scc0 L_t_hi
  s_mul_i32 s20, s25, 200
  s_mul_i32 s21, s6, 50
  s_add_u32 s20, s20, s21
  v_min_u32 v6, 49, v1
  v_add_u32 v6, s20, v6
  v_lshlrev_b32 v6, 7, v6
  global_load_dword v255, v6, s[38:39]
  s_nop 0
  s_branch L_t_done
L_t_hi:
  s_getpc_b64 s[20:21]
SK_pc:
  s_sub_u32 s20, s20, SK_pc-interleave_layers__grouped_kv_mqa__moe_arch_mod__prompt_kernel
  s_subb_u32 s21, s21, 0
  s_cmp_lt_u32 s6, 6
  s_cbranch_scc0 L_t_67
  s_mul_i32 s26, s25, 7
  v_and_b32 v6, 7, v1
  v_add_u32 v6, s26, v6
  v_min_u32 v6, 199, v6
  v_lshlrev_b32 v6, 7, v6
  s_cmp_eq_u32 s6, 4
  s_cselect_b32 s26, s40, s42
  s_cselect_b32 s27, s41, s43
  global_load_dword v255, v6, s[26:27]
  s_branch L_t_done
L_t_67:
  s_cmp_eq_u32 s6, 6
  s_cbranch_scc0 L_t_7
  s_lshl_b32 s26, s25, 4
  v_and_b32 v6, 15, v1
  v_add_u32 v6, s26, v6
  v_lshlrev_b32 v6, 7, v6
  v_min_u32 v6, L_CODE_END-interleave_layers__grouped_kv_mqa__moe_arch_mod__prompt_kernel-4, v6
  global_load_dword v255, v6, s[20:21]
  s_nop 0
  s_branch L_t_done
L_t_7:
  s_mul_i32 s20, s4, 0x54400
  s_add_u32 s20, s20, 1392640
  v_mov_b32 v6, s20
  v_mov_b32 v7, 782336
  v_cmp_eq_u32 vcc, 0, v1
  s_nop 1
  v_cndmask_b32 v6, v6, v7, vcc
  global_load_dword v255, v6, s[60:61]
  s_nop 0
L_t_done:
  s_lshr_b32 s19, s5, 1
  s_mov_b32 s9, 0x40000
  s_mov_b32 s15, 0
  s_mov_b32 s14, 0
  s_lshr_b32 s20, s3, 5
  s_and_b32 s21, s3, 31
  s_mul_i32 s74, s20, 27
  s_add_u32 s74, s74, s21
  s_mul_i32 s75, s20, 5
  s_add_u32 s75, s75, s21
  s_sub_u32 s75, s75, 27
  s_cmp_lt_u32 s21, 27
  s_cselect_b32 s74, s74, 255
  s_cselect_b32 s75, 63, s75
  s_mov_b32 s12, 0
  s_mov_b32 s13, 0
  s_cmp_ge_u32 s6, 3
  s_cselect_b32 s18, 1, 0
  s_mul_i32 s20, s18, 3
  s_sub_u32 s17, s6, s20
  s_and_b32 s46, s6, 1
  s_lshr_b32 s47, s6, 1
  s_cmp_ge_u32 s6, 4
  s_cselect_b32 s47, s46, s47
  s_cselect_b32 s46, 2, s46
  v_lshlrev_b32 v2, 3, v1
  v_add_u32 v2, 1024, v2
  v_mov_b32 v3, 0xdddddddd
  v_min_u32 v5, 1280, v2
  v_and_b32 v4, 31, v1
  v_min_u32 v4, 21, v4
  v_and_b32 v6, 32, v1
  v_add_u32 v4, v4, v6
  v_lshlrev_b32 v4, 4, v4
  s_mul_i32 s20, s5, 160
  s_add_u32 s38, s38, s20
  s_addc_u32 s39, s39, 0
  s_add_u32 s44, s44, s20
  s_addc_u32 s45, s45, 0
  s_mul_i32 s20, s4, 0x54400
  s_add_u32 s40, s60, s20
  s_addc_u32 s41, s61, 0
  s_add_u32 s40, s40, 1048576
  s_addc_u32 s41, s41, 0
  v_add_u32 v6, 0, v1
  v_mul_u32_u24 v7, 205, v6
  v_lshrrev_b32 v7, 11, v7
  v_mul_u32_u24 v8, 10, v7
  v_sub_u32 v8, v6, v8
  v_and_b32 v9, 1, v7
  v_and_b32 v6, 24, v7
  v_lshl_add_u32 v6, v9, 2, v6
  v_bfe_u32 v7, v7, 1, 2
  v_add_u32 v7, v7, v6
  v_mul_u32_u24 v7, 1280, v7
  v_lshl_add_u32 v250, v8, 4, v7
  v_add_u32 v6, 64, v1
  v_mul_u32_u24 v7, 205, v6
  v_lshrrev_b32 v7, 11, v7
  v_mul_u32_u24 v8, 10, v7
  v_sub_u32 v8, v6, v8
  v_and_b32 v9, 1, v7
  v_and_b32 v6, 24, v7
  v_lshl_add_u32 v6, v9, 2, v6
  v_bfe_u32 v7, v7, 1, 2
  v_add_u32 v7, v7, v6
  v_mul_u32_u24 v7, 1280, v7
  v_lshl_add_u32 v251, v8, 4, v7
  v_subrev_u32 v251, 1024, v251
  v_add_u32 v6, 128, v1
  v_mul_u32_u24 v7, 205, v6
  v_lshrrev_b32 v7, 11, v7
  v_mul_u32_u24 v8, 10, v7
  v_sub_u32 v8, v6, v8
  v_and_b32 v9, 1, v7
  v_and_b32 v6, 24, v7
  v_lshl_add_u32 v6, v9, 2, v6
  v_bfe_u32 v7, v7, 1, 2
  v_add_u32 v7, v7, v6
  v_mul_u32_u24 v7, 1280, v7
  v_lshl_add_u32 v252, v8, 4, v7
  v_subrev_u32 v252, 2048, v252
  v_add_u32 v6, 192, v1
  v_mul_u32_u24 v7, 205, v6
  v_lshrrev_b32 v7, 11, v7
  v_mul_u32_u24 v8, 10, v7
  v_sub_u32 v8, v6, v8
  v_and_b32 v9, 1, v7
  v_and_b32 v6, 24, v7
  v_lshl_add_u32 v6, v9, 2, v6
  v_bfe_u32 v7, v7, 1, 2
  v_add_u32 v7, v7, v6
  v_mul_u32_u24 v7, 1280, v7
  v_lshl_add_u32 v253, v8, 4, v7
  v_subrev_u32 v253, 3072, v253
  v_add_u32 v6, 256, v1
  v_mul_u32_u24 v7, 205, v6
  v_lshrrev_b32 v7, 11, v7
  v_mul_u32_u24 v8, 10, v7
  v_sub_u32 v8, v6, v8
  v_and_b32 v9, 1, v7
  v_and_b32 v6, 24, v7
  v_lshl_add_u32 v6, v9, 2, v6
  v_bfe_u32 v7, v7, 1, 2
  v_add_u32 v7, v7, v6
  v_mul_u32_u24 v7, 1280, v7
  v_lshl_add_u32 v254, v8, 4, v7
  s_cmp_eq_u32 s6, 4
  s_nop 0
  s_cbranch_scc0 L_p_n4
  v_min_u32 v6, 39, v1
  v_lshlrev_b32 v6, 5, v6
  global_load_dwordx4 v[60:63], v6, s[48:49]
  global_load_dwordx4 v[64:67], v6, s[48:49] offset:16
  s_mul_i32 s20, s5, 160
  v_min_u32 v73, 9, v1
  v_lshlrev_b32 v73, 4, v73
  v_add_u32 v8, s20, v73
  global_load_dwordx4 v[68:71], v8, s[48:49]
  s_nop 0
L_p_n4:
  s_cmp_eq_u32 s6, 5
  s_cbranch_scc0 L_p_n5
  v_mov_b32 v7, 0
  s_mov_b32 s20, 0
  s_nop 0
PL_1:
  global_load_dword v6, v7, s[58:59] sc1
  s_waitcnt vmcnt(0)
  v_cmp_eq_u32 vcc, 0, v6
  s_nop 4
  s_cbranch_vccz PD_2
  s_add_u32 s20, s20, 1
  s_cmp_lt_u32 s20, s9
  s_cbranch_scc1 PL_1
  s_mov_b32 s9, 0
PD_2:
  v_mov_b32 v7, 163200
  ds_write_b32 v7, v6
  s_nop 0
L_p_n5:
  s_cmp_ge_u32 s6, 6
  s_cbranch_scc1 L_kv_a
  v_lshrrev_b32 v6, 4, v1
  v_and_b32 v6, 1, v6
  v_lshlrev_b32 v6, 2, v6
  v_and_b32 v7, 3, v1
  v_add_u32 v7, v7, v6
  s_mov_b32 s30, 0x75643120
  s_cmp_eq_u32 s17, 1
  s_cselect_b32 s30, 0x75641320, s30
  s_cmp_eq_u32 s17, 2
  s_cselect_b32 s30, 0x17645302, s30
  s_mul_i32 s21, s17, 6
  v_lshlrev_b32 v7, 2, v7
  v_lshrrev_b32 v8, v7, s30
  v_and_b32 v8, 15, v8
  v_add_u32 v8, s21, v8
  v_lshrrev_b32 v6, 5, v1
  v_lshlrev_b32 v6, 3, v6
  v_bfe_u32 v7, v1, 2, 2
  v_lshl_add_u32 v6, v7, 1, v6
  v_mul_u32_u24 v6, 160, v6
  v_lshl_add_u32 v100, v8, 3, v6
  v_add_u32 v101, 40960, v100
  s_mul_i32 s20, s18, 40960
  s_add_u32 s20, s20, 71680
  v_and_b32 v6, 31, v1
  v_lshrrev_b32 v7, 5, v1
  v_xor_b32 v7, v7, v6
  v_and_b32 v7, 15, v7
  v_lshlrev_b32 v7, 4, v7
  v_lshl_add_u32 v7, v6, 8, v7
  v_add_u32 v102, s20, v7
  v_xor_b32 v103, 32, v102
  v_xor_b32 v104, 64, v102
  v_xor_b32 v105, 96, v102
  v_xor_b32 v106, 128, v102
  v_xor_b32 v107, 160, v102
  v_xor_b32 v108, 192, v102
  v_xor_b32 v109, 224, v102
  v_and_b32 v6, 31, v1
  s_lshl_b32 s20, s18, 8
  s_add_u32 s20, s20, 161792
  v_lshl_add_u32 v84, v6, 3, s20
  v_lshrrev_b32 v7, 5, v1
  s_mul_i32 s21, s17, 96
  s_add_u32 s21, s21, 162816
  v_lshlrev_b32 v10, 2, v7
  v_lshrrev_b32 v10, v10, s30
  v_subrev_u32 v7, 1, v7
  s_mul_i32 s22, s18, 6144
  s_add_u32 s22, s22, 141312
  v_bfe_u32 v11, v10, 0, 4
  v_lshl_add_u32 v85, v11, 4, s21
  s_lshl_b32 s20, s17, 2
  s_add_u32 s20, s20, 0
  s_mul_i32 s23, s20, 11
  s_lshr_b32 s23, s23, 5
  s_mul_i32 s24, s23, 3
  s_sub_u32 s24, s20, s24
  s_mul_i32 s23, s23, 1536
  s_add_u32 s23, s23, s22
  s_lshl_b32 s25, s24, 3
  s_add_u32 s25, s25, s23
  v_add_u32 v89, s25, v0
  v_add_u32 v11, s23, v2
  s_cmp_eq_u32 s24, 2
  s_cselect_b64 vcc, -1, 0
  v_cndmask_b32 v89, v89, v11, vcc
  v_cndmask_b32 v93, -1, v7, vcc
  v_bfe_u32 v11, v10, 8, 4
  v_lshl_add_u32 v86, v11, 4, s21
  s_lshl_b32 s20, s17, 2
  s_add_u32 s20, s20, 1
  s_mul_i32 s23, s20, 11
  s_lshr_b32 s23, s23, 5
  s_mul_i32 s24, s23, 3
  s_sub_u32 s24, s20, s24
  s_mul_i32 s23, s23, 1536
  s_add_u32 s23, s23, s22
  s_lshl_b32 s25, s24, 3
  s_add_u32 s25, s25, s23
  v_add_u32 v90, s25, v0
  v_add_u32 v11, s23, v2
  s_cmp_eq_u32 s24, 2
  s_cselect_b64 vcc, -1, 0
  v_cndmask_b32 v90, v90, v11, vcc
  v_cndmask_b32 v94, -1, v7, vcc
  v_bfe_u32 v11, v10, 16, 4
  v_lshl_add_u32 v87, v11, 4, s21
  s_lshl_b32 s20, s17, 2
  s_add_u32 s20, s20, 2
  s_mul_i32 s23, s20, 11
  s_lshr_b32 s23, s23, 5
  s_mul_i32 s24, s23, 3
  s_sub_u32 s24, s20, s24
  s_mul_i32 s23, s23, 1536
  s_add_u32 s23, s23, s22
  s_lshl_b32 s25, s24, 3
  s_add_u32 s25, s25, s23
  v_add_u32 v91, s25, v0
  v_add_u32 v11, s23, v2
  s_cmp_eq_u32 s24, 2
  s_cselect_b64 vcc, -1, 0
  v_cndmask_b32 v91, v91, v11, vcc
  v_cndmask_b32 v95, -1, v7, vcc
  v_bfe_u32 v11, v10, 24, 4
  v_lshl_add_u32 v88, v11, 4, s21
  s_lshl_b32 s20, s17, 2
  s_add_u32 s20, s20, 3
  s_mul_i32 s23, s20, 11
  s_lshr_b32 s23, s23, 5
  s_mul_i32 s24, s23, 3
  s_sub_u32 s24, s20, s24
  s_mul_i32 s23, s23, 1536
  s_add_u32 s23, s23, s22
  s_lshl_b32 s25, s24, 3
  s_add_u32 s25, s25, s23
  v_add_u32 v92, s25, v0
  v_add_u32 v11, s23, v2
  s_cmp_eq_u32 s24, 2
  s_cselect_b64 vcc, -1, 0
  v_cndmask_b32 v92, v92, v11, vcc
  v_cndmask_b32 v96, -1, v7, vcc
  s_cmp_lt_u32 s6, 4
  s_nop 0
  s_cbranch_scc0 L_s1_w45
  s_add_u32 s31, s19, s6
  s_and_b32 s31, s31, 3
  v_and_b32 v6, 15, v1
  v_lshrrev_b32 v7, 4, v1
  s_lshr_b32 s20, s31, 1
  s_mul_i32 s20, s20, 40960
  s_add_u32 s20, s20, 71680
  s_and_b32 s21, s31, 1
  s_lshl_b32 s21, s21, 4
  v_add_u32 v8, s21, v6
  v_xor_b32 v9, v7, v6
  v_lshlrev_b32 v9, 4, v9
  v_lshl_add_u32 v9, v8, 8, v9
  v_add_u32 v60, s20, v9
  v_xor_b32 v61, 64, v60
  v_xor_b32 v62, 128, v60
  v_xor_b32 v63, 192, v60
  v_mov_b32 v64, 0x3f803f80
  v_mov_b32 v65, 0x3f803f80
  v_mov_b32 v66, 0x3f803f80
  v_mov_b32 v67, 0x3f803f80
  s_nop 1
L_s1_w45:
  s_mul_i32 s20, s5, 5
  s_lshl_b32 s21, s46, 1
  s_add_u32 s20, s20, s21
  s_mul_i32 s22, s47, 40960
  v_and_b32 v9, 31, v1
  v_lshrrev_b32 v10, 5, v1
  s_lshr_b32 s21, s20, 3
  s_lshl_b32 s21, s21, 13
  s_add_u32 s21, s21, s22
  s_add_u32 s21, s21, 71680
  s_and_b32 s23, s20, 7
  s_lshl_b32 s23, s23, 1
  v_add_u32 v11, s23, v10
  v_xor_b32 v11, v11, v9
  v_and_b32 v11, 15, v11
  v_lshlrev_b32 v11, 4, v11
  v_lshl_add_u32 v11, v9, 8, v11
  v_add_u32 v98, s21, v11
  s_cmp_lt_u32 s46, 2
  s_addc_u32 s20, s20, 0
  s_lshr_b32 s21, s20, 3
  s_lshl_b32 s21, s21, 13
  s_add_u32 s21, s21, s22
  s_add_u32 s21, s21, 71680
  s_and_b32 s23, s20, 7
  s_lshl_b32 s23, s23, 1
  v_add_u32 v11, s23, v10
  v_xor_b32 v11, v11, v9
  v_and_b32 v11, 15, v11
  v_lshlrev_b32 v11, 4, v11
  v_lshl_add_u32 v11, v9, 8, v11
  v_add_u32 v99, s21, v11
  s_waitcnt vmcnt(0) lgkmcnt(0)
  s_barrier
  s_cmp_lt_u32 s6, 2
  s_cbranch_scc1 L_s1_stat
  s_and_b32 s27, s6, 1
  s_lshr_b32 s28, s6, 1
  s_sub_u32 s28, s28, 1
  s_add_u32 s29, s28, 3
  s_mul_i32 s21, s27, 40960
  s_mul_i32 s22, s28, 81920
  s_add_u32 s21, s21, s22
  s_add_u32 s64, s38, s21
  s_addc_u32 s65, s39, 0
  s_mul_i32 s76, s27, 5120
  s_mul_i32 s22, s29, 10240
  s_add_u32 s76, s76, s22
  s_mov_b32 m0, s76
  s_nop 0
  global_load_lds_dwordx4 v250, s[64:65] offset:0
  s_mov_b32 m0, s76
  s_nop 0
  global_load_lds_dwordx4 v251, s[64:65] offset:1024
  s_mov_b32 m0, s76
  s_nop 0
  global_load_lds_dwordx4 v252, s[64:65] offset:2048
  s_mov_b32 m0, s76
  s_nop 0
  global_load_lds_dwordx4 v253, s[64:65] offset:3072
  s_add_u32 m0, s76, 4096
  s_nop 0
  global_load_lds_dwordx4 v254, s[64:65]
  s_add_u32 s28, s28, 2
  s_add_u32 s29, s29, 2
  s_mul_i32 s21, s27, 40960
  s_mul_i32 s22, s28, 81920
  s_add_u32 s21, s21, s22
  s_add_u32 s64, s38, s21
  s_addc_u32 s65, s39, 0
  s_mul_i32 s76, s27, 5120
  s_mul_i32 s22, s29, 10240
  s_add_u32 s76, s76, s22
  s_mov_b32 m0, s76
  s_nop 0
  global_load_lds_dwordx4 v250, s[64:65] offset:0
  s_mov_b32 m0, s76
  s_nop 0
  global_load_lds_dwordx4 v251, s[64:65] offset:1024
  s_mov_b32 m0, s76
  s_nop 0
  global_load_lds_dwordx4 v252, s[64:65] offset:2048
  s_mov_b32 m0, s76
  s_nop 0
  global_load_lds_dwordx4 v253, s[64:65] offset:3072
  s_add_u32 m0, s76, 4096
  s_nop 0
  global_load_lds_dwordx4 v254, s[64:65]
  s_barrier
  s_cmp_lt_u32 s6, 4
  s_cbranch_scc0 L_s1_nostat
L_s1_stat:
  ds_read_b128 v[140:143], v60 offset:0
  ds_read_b128 v[144:147], v61 offset:0
  ds_read_b128 v[148:151], v62 offset:0
  ds_read_b128 v[152:155], v63 offset:0
  ds_read_b128 v[156:159], v60 offset:8192
  ds_read_b128 v[160:163], v61 offset:8192
  ds_read_b128 v[164:167], v62 offset:8192
  ds_read_b128 v[168:171], v63 offset:8192
  ds_read_b128 v[172:175], v60 offset:16384
  ds_read_b128 v[176:179], v61 offset:16384
  ds_read_b128 v[180:183], v62 offset:16384
  ds_read_b128 v[184:187], v63 offset:16384
  ds_read_b128 v[188:191], v60 offset:24576
  ds_read_b128 v[192:195], v61 offset:24576
  ds_read_b128 v[196:199], v62 offset:24576
  ds_read_b128 v[200:203], v63 offset:24576
  ds_read_b128 v[204:207], v60 offset:32768
  ds_read_b128 v[208:211], v61 offset:32768
  ds_read_b128 v[212:215], v62 offset:32768
  ds_read_b128 v[216:219], v63 offset:32768
  s_waitcnt lgkmcnt(15)
  v_mfma_f32_16x16x32_bf16 v[68:71], v[140:143], v[140:143], 0
  v_mfma_f32_16x16x32_bf16 v[72:75], v[64:67], v[140:143], 0
  s_waitcnt lgkmcnt(15)
  v_mfma_f32_16x16x32_bf16 v[68:71], v[144:147], v[144:147], v[68:71]
  v_mfma_f32_16x16x32_bf16 v[72:75], v[64:67], v[144:147], v[72:75]
  s_waitcnt lgkmcnt(15)
  v_mfma_f32_16x16x32_bf16 v[68:71], v[148:151], v[148:151], v[68:71]
  v_mfma_f32_16x16x32_bf16 v[72:75], v[64:67], v[148:151], v[72:75]
  s_waitcnt lgkmcnt(15)
  v_mfma_f32_16x16x32_bf16 v[68:71], v[152:155], v[152:155], v[68:71]
  v_mfma_f32_16x16x32_bf16 v[72:75], v[64:67], v[152:155], v[72:75]
  s_waitcnt lgkmcnt(15)
  v_mfma_f32_16x16x32_bf16 v[68:71], v[156:159], v[156:159], v[68:71]
  v_mfma_f32_16x16x32_bf16 v[72:75], v[64:67], v[156:159], v[72:75]
  s_waitcnt lgkmcnt(14)
  v_mfma_f32_16x16x32_bf16 v[68:71], v[160:163], v[160:163], v[68:71]
  v_mfma_f32_16x16x32_bf16 v[72:75], v[64:67], v[160:163], v[72:75]
  s_waitcnt lgkmcnt(13)
  v_mfma_f32_16x16x32_bf16 v[68:71], v[164:167], v[164:167], v[68:71]
  v_mfma_f32_16x16x32_bf16 v[72:75], v[64:67], v[164:167], v[72:75]
  s_waitcnt lgkmcnt(12)
  v_mfma_f32_16x16x32_bf16 v[68:71], v[168:171], v[168:171], v[68:71]
  v_mfma_f32_16x16x32_bf16 v[72:75], v[64:67], v[168:171], v[72:75]
  s_waitcnt lgkmcnt(11)
  v_mfma_f32_16x16x32_bf16 v[68:71], v[172:175], v[172:175], v[68:71]
  v_mfma_f32_16x16x32_bf16 v[72:75], v[64:67], v[172:175], v[72:75]
  s_waitcnt lgkmcnt(10)
  v_mfma_f32_16x16x32_bf16 v[68:71], v[176:179], v[176:179], v[68:71]
  v_mfma_f32_16x16x32_bf16 v[72:75], v[64:67], v[176:179], v[72:75]
  s_waitcnt lgkmcnt(9)
  v_mfma_f32_16x16x32_bf16 v[68:71], v[180:183], v[180:183], v[68:71]
  v_mfma_f32_16x16x32_bf16 v[72:75], v[64:67], v[180:183], v[72:75]
  s_waitcnt lgkmcnt(8)
  v_mfma_f32_16x16x32_bf16 v[68:71], v[184:187], v[184:187], v[68:71]
  v_mfma_f32_16x16x32_bf16 v[72:75], v[64:67], v[184:187], v[72:75]
  s_waitcnt lgkmcnt(7)
  v_mfma_f32_16x16x32_bf16 v[68:71], v[188:191], v[188:191], v[68:71]
  v_mfma_f32_16x16x32_bf16 v[72:75], v[64:67], v[188:191], v[72:75]
  s_waitcnt lgkmcnt(6)
  v_mfma_f32_16x16x32_bf16 v[68:71], v[192:195], v[192:195], v[68:71]
  v_mfma_f32_16x16x32_bf16 v[72:75], v[64:67], v[192:195], v[72:75]
  s_waitcnt lgkmcnt(5)
  v_mfma_f32_16x16x32_bf16 v[68:71], v[196:199], v[196:199], v[68:71]
  v_mfma_f32_16x16x32_bf16 v[72:75], v[64:67], v[196:199], v[72:75]
  s_waitcnt lgkmcnt(4)
  v_mfma_f32_16x16x32_bf16 v[68:71], v[200:203], v[200:203], v[68:71]
  v_mfma_f32_16x16x32_bf16 v[72:75], v[64:67], v[200:203], v[72:75]
  s_waitcnt lgkmcnt(3)
  v_mfma_f32_16x16x32_bf16 v[68:71], v[204:207], v[204:207], v[68:71]
  v_mfma_f32_16x16x32_bf16 v[72:75], v[64:67], v[204:207], v[72:75]
  s_waitcnt lgkmcnt(2)
  v_mfma_f32_16x16x32_bf16 v[68:71], v[208:211], v[208:211], v[68:71]
  v_mfma_f32_16x16x32_bf16 v[72:75], v[64:67], v[208:211], v[72:75]
  s_waitcnt lgkmcnt(1)
  v_mfma_f32_16x16x32_bf16 v[68:71], v[212:215], v[212:215], v[68:71]
  v_mfma_f32_16x16x32_bf16 v[72:75], v[64:67], v[212:215], v[72:75]
  s_waitcnt lgkmcnt(0)
  v_mfma_f32_16x16x32_bf16 v[68:71], v[216:219], v[216:219], v[68:71]
  v_mfma_f32_16x16x32_bf16 v[72:75], v[64:67], v[216:219], v[72:75]
  ds_read_b128 v[12:15], v98
  ds_read_b128 v[16:19], v99
  v_and_b32 v9, 1, v6
  v_cmp_eq_u32 vcc, 1, v9
  v_and_b32 v9, 2, v6
  v_cmp_eq_u32 s[24:25], 2, v9
  v_lshrrev_b32 v9, 2, v6
  v_cmp_eq_u32 s[26:27], v9, v7
  s_lshl_b32 s20, s31, 7
  s_add_u32 s20, s20, 161792
  v_lshl_add_u32 v9, v6, 3, s20
  v_cndmask_b32 v68, v68, v69, vcc
  v_cndmask_b32 v70, v70, v71, vcc
  v_cndmask_b32 v68, v68, v70, s[24:25]
  v_mul_f32 v73, 0x3acccccd, v72
  v_mul_f32 v74, 0x3acccccd, v68
  v_fma_f32 v74, -v73, v73, v74
  v_cvt_pk_bf16_f32 v75, v73, v73
  v_lshlrev_b32 v75, 16, v75
  v_max_f32 v76, 0, v74
  v_cvt_pk_bf16_f32 v76, v76, v76
  v_lshlrev_b32 v76, 16, v76
  v_add_f32 v76, 0x3727c5ac, v76
  v_cvt_pk_bf16_f32 v76, v76, v76
  v_lshlrev_b32 v76, 16, v76
  v_sqrt_f32 v76, v76
  s_nop 0
  v_cvt_pk_bf16_f32 v69, v76, v76
  v_lshlrev_b32 v69, 16, v69
  v_rcp_f32 v70, v69
  s_nop 0
  v_mul_f32 v71, v75, v70
  s_mov_b64 exec, s[26:27]
  ds_write_b64 v9, v[70:71]
  s_mov_b64 exec, -1
  s_cmp_lt_u32 s6, 2
  s_cbranch_scc1 L_s1_b2
  s_branch L_s1_pastb2
L_s1_nostat:
  ds_read_b128 v[12:15], v98
  ds_read_b128 v[16:19], v99
  s_cmp_eq_u32 s6, 4
  s_cbranch_scc0 L_s1_pastb2
  v_mov_b32 v9, 0x3f803f80
  v_mov_b32 v72, 0
  v_dot2_f32_bf16 v72, v60, v9, v72
  v_dot2_f32_bf16 v72, v61, v9, v72
  v_dot2_f32_bf16 v72, v62, v9, v72
  v_dot2_f32_bf16 v72, v63, v9, v72
  v_dot2_f32_bf16 v72, v64, v9, v72
  v_dot2_f32_bf16 v72, v65, v9, v72
  v_dot2_f32_bf16 v72, v66, v9, v72
  v_dot2_f32_bf16 v72, v67, v9, v72
  v_cmp_gt_u32 vcc, 40, v1
  s_nop 1
  v_cndmask_b32 v72, 0, v72, vcc
  s_nop 1
  v_add_f32_dpp v72, v72, v72 row_ror:1 row_mask:0xf bank_mask:0xf
  s_nop 1
  v_add_f32_dpp v72, v72, v72 row_ror:2 row_mask:0xf bank_mask:0xf
  s_nop 1
  v_add_f32_dpp v72, v72, v72 row_ror:4 row_mask:0xf bank_mask:0xf
  s_nop 1
  v_add_f32_dpp v72, v72, v72 row_ror:8 row_mask:0xf bank_mask:0xf
  s_nop 0
  v_readlane_b32 s20, v72, 0
  v_readlane_b32 s21, v72, 16
  v_readlane_b32 s22, v72, 32
  v_mov_b32 v75, s20
  v_add_f32 v75, s21, v75
  v_add_f32 v75, s22, v75
  v_mov_b32 v74, 163204
  ds_write_b32 v74, v75
  v_add_u32 v7, 163264, v73
  ds_write_b128 v7, v[68:71]
  v_mov_b32 v75, 0
  ds_write_b32 v74, v75 offset:4
  ds_write_b32 v74, v75 offset:28
  s_branch L_s1_pastb2
L_s1_b2:
  s_waitcnt lgkmcnt(0)
  s_barrier
L_s1_pastb2:
  v_mov_b32 v6, 163200
  ds_read_b32 v6, v6
  s_waitcnt vmcnt(0) lgkmcnt(0)
  v_readfirstlane_b32 s7, v6
  s_barrier
  s_and_b32 s20, s6, 6
  s_cmp_eq_u32 s20, 2
  s_nop 1
  s_cbranch_scc1 L_q_r_a
  ds_read_b128 v[132:135], v102 offset:0
  ds_read_b64_tr_b16 v[128:129], v100 offset:30720
  ds_read_b64_tr_b16 v[130:131], v100 offset:30880
  ds_read_b128 v[140:143], v103 offset:0
  ds_read_b64_tr_b16 v[136:137], v100 offset:33280
  ds_read_b64_tr_b16 v[138:139], v100 offset:33440
  ds_read_b128 v[148:151], v104 offset:0
  ds_read_b64_tr_b16 v[144:145], v100 offset:35840
  ds_read_b64_tr_b16 v[146:147], v100 offset:36000
  ds_read_b128 v[156:159], v105 offset:0
  ds_read_b64_tr_b16 v[152:153], v100 offset:38400
  ds_read_b64_tr_b16 v[154:155], v100 offset:38560
  s_waitcnt lgkmcnt(9)
  v_mfma_f32_32x32x16_bf16 v[112:127], v[128:131], v[132:135], 0
  ds_read_b128 v[132:135], v106 offset:0
  ds_read_b64_tr_b16 v[128:129], v101 offset:0
  ds_read_b64_tr_b16 v[130:131], v101 offset:160
  s_waitcnt lgkmcnt(9)
  v_mfma_f32_32x32x16_bf16 v[112:127], v[136:139], v[140:143], v[112:127]
  ds_read_b128 v[140:143], v107 offset:0
  ds_read_b64_tr_b16 v[136:137], v101 offset:2560
  ds_read_b64_tr_b16 v[138:139], v101 offset:2720
  s_waitcnt lgkmcnt(9)
  v_mfma_f32_32x32x16_bf16 v[112:127], v[144:147], v[148:151], v[112:127]
  ds_read_b128 v[148:151], v108 offset:0
  ds_read_b64_tr_b16 v[144:145], v101 offset:5120
  ds_read_b64_tr_b16 v[146:147], v101 offset:5280
  s_waitcnt lgkmcnt(9)
  v_mfma_f32_32x32x16_bf16 v[112:127], v[152:155], v[156:159], v[112:127]
  ds_read_b128 v[156:159], v109 offset:0
  ds_read_b64_tr_b16 v[152:153], v101 offset:7680
  ds_read_b64_tr_b16 v[154:155], v101 offset:7840
  s_waitcnt lgkmcnt(9)
  v_mfma_f32_32x32x16_bf16 v[112:127], v[128:131], v[132:135], v[112:127]
  ds_read_b128 v[132:135], v102 offset:8192
  ds_read_b64_tr_b16 v[128:129], v101 offset:10240
  ds_read_b64_tr_b16 v[130:131], v101 offset:10400
  s_waitcnt lgkmcnt(9)
  v_mfma_f32_32x32x16_bf16 v[112:127], v[136:139], v[140:143], v[112:127]
  ds_read_b128 v[140:143], v103 offset:8192
  ds_read_b64_tr_b16 v[136:137], v101 offset:12800
  ds_read_b64_tr_b16 v[138:139], v101 offset:12960
  s_waitcnt lgkmcnt(9)
  v_mfma_f32_32x32x16_bf16 v[112:127], v[144:147], v[148:151], v[112:127]
  ds_read_b128 v[148:151], v104 offset:8192
  ds_read_b64_tr_b16 v[144:145], v101 offset:15360
  ds_read_b64_tr_b16 v[146:147], v101 offset:15520
  s_waitcnt lgkmcnt(9)
  v_mfma_f32_32x32x16_bf16 v[112:127], v[152:155], v[156:159], v[112:127]
  ds_read_b128 v[156:159], v105 offset:8192
  ds_read_b64_tr_b16 v[152:153], v101 offset:17920
  ds_read_b64_tr_b16 v[154:155], v101 offset:18080
  s_waitcnt lgkmcnt(9)
  v_mfma_f32_32x32x16_bf16 v[112:127], v[128:131], v[132:135], v[112:127]
  ds_read_b128 v[132:135], v106 offset:8192
  ds_read_b64_tr_b16 v[128:129], v101 offset:20480
  ds_read_b64_tr_b16 v[130:131], v101 offset:20640
  s_waitcnt lgkmcnt(9)
  v_mfma_f32_32x32x16_bf16 v[112:127], v[136:139], v[140:143], v[112:127]
  ds_read_b128 v[140:143], v107 offset:8192
  ds_read_b64_tr_b16 v[136:137], v101 offset:23040
  ds_read_b64_tr_b16 v[138:139], v101 offset:23200
  s_waitcnt lgkmcnt(9)
  v_mfma_f32_32x32x16_bf16 v[112:127], v[144:147], v[148:151], v[112:127]
  ds_read_b128 v[148:151], v108 offset:8192
  ds_read_b64_tr_b16 v[144:145], v101 offset:25600
  ds_read_b64_tr_b16 v[146:147], v101 offset:25760
  s_waitcnt lgkmcnt(9)
  v_mfma_f32_32x32x16_bf16 v[112:127], v[152:155], v[156:159], v[112:127]
  s_barrier
  ds_read_b128 v[156:159], v109 offset:8192
  ds_read_b64_tr_b16 v[152:153], v101 offset:28160
  ds_read_b64_tr_b16 v[154:155], v101 offset:28320
  s_waitcnt lgkmcnt(9)
  v_mfma_f32_32x32x16_bf16 v[112:127], v[128:131], v[132:135], v[112:127]
  s_waitcnt lgkmcnt(6)
  v_mfma_f32_32x32x16_bf16 v[112:127], v[136:139], v[140:143], v[112:127]
  s_waitcnt lgkmcnt(3)
  v_mfma_f32_32x32x16_bf16 v[112:127], v[144:147], v[148:151], v[112:127]
  s_waitcnt lgkmcnt(0)
  v_mfma_f32_32x32x16_bf16 v[112:127], v[152:155], v[156:159], v[112:127]
  s_barrier
  ds_read_b128 v[132:135], v102 offset:16384
  ds_read_b64_tr_b16 v[128:129], v100 offset:0
  ds_read_b64_tr_b16 v[130:131], v100 offset:160
  ds_read_b128 v[140:143], v103 offset:16384
  ds_read_b64_tr_b16 v[136:137], v100 offset:2560
  ds_read_b64_tr_b16 v[138:139], v100 offset:2720
  ds_read_b128 v[148:151], v104 offset:16384
  ds_read_b64_tr_b16 v[144:145], v100 offset:5120
  ds_read_b64_tr_b16 v[146:147], v100 offset:5280
  ds_read_b128 v[156:159], v105 offset:16384
  ds_read_b64_tr_b16 v[152:153], v100 offset:7680
  ds_read_b64_tr_b16 v[154:155], v100 offset:7840
  s_waitcnt lgkmcnt(9)
  v_mfma_f32_32x32x16_bf16 v[112:127], v[128:131], v[132:135], v[112:127]
  ds_read_b128 v[132:135], v106 offset:16384
  ds_read_b64_tr_b16 v[128:129], v100 offset:10240
  ds_read_b64_tr_b16 v[130:131], v100 offset:10400
  s_waitcnt lgkmcnt(9)
  v_mfma_f32_32x32x16_bf16 v[112:127], v[136:139], v[140:143], v[112:127]
  ds_read_b128 v[140:143], v107 offset:16384
  ds_read_b64_tr_b16 v[136:137], v100 offset:12800
  ds_read_b64_tr_b16 v[138:139], v100 offset:12960
  s_waitcnt lgkmcnt(9)
  v_mfma_f32_32x32x16_bf16 v[112:127], v[144:147], v[148:151], v[112:127]
  ds_read_b128 v[148:151], v108 offset:16384
  ds_read_b64_tr_b16 v[144:145], v100 offset:15360
  ds_read_b64_tr_b16 v[146:147], v100 offset:15520
  s_waitcnt lgkmcnt(9)
  v_mfma_f32_32x32x16_bf16 v[112:127], v[152:155], v[156:159], v[112:127]
  ds_read_b128 v[156:159], v109 offset:16384
  ds_read_b64_tr_b16 v[152:153], v100 offset:17920
  ds_read_b64_tr_b16 v[154:155], v100 offset:18080
  s_waitcnt lgkmcnt(9)
  v_mfma_f32_32x32x16_bf16 v[112:127], v[128:131], v[132:135], v[112:127]
  ds_read_b128 v[132:135], v102 offset:24576
  ds_read_b64_tr_b16 v[128:129], v100 offset:20480
  ds_read_b64_tr_b16 v[130:131], v100 offset:20640
  s_waitcnt lgkmcnt(9)
  v_mfma_f32_32x32x16_bf16 v[112:127], v[136:139], v[140:143], v[112:127]
  ds_read_b128 v[140:143], v103 offset:24576
  ds_read_b64_tr_b16 v[136:137], v100 offset:23040
  ds_read_b64_tr_b16 v[138:139], v100 offset:23200
  s_waitcnt lgkmcnt(9)
  v_mfma_f32_32x32x16_bf16 v[112:127], v[144:147], v[148:151], v[112:127]
  ds_read_b128 v[148:151], v104 offset:24576
  ds_read_b64_tr_b16 v[144:145], v100 offset:25600
  ds_read_b64_tr_b16 v[146:147], v100 offset:25760
  s_waitcnt lgkmcnt(9)
  v_mfma_f32_32x32x16_bf16 v[112:127], v[152:155], v[156:159], v[112:127]
  ds_read_b128 v[156:159], v105 offset:24576
  ds_read_b64_tr_b16 v[152:153], v100 offset:28160
  ds_read_b64_tr_b16 v[154:155], v100 offset:28320
  s_waitcnt lgkmcnt(9)
  v_mfma_f32_32x32x16_bf16 v[112:127], v[128:131], v[132:135], v[112:127]
  s_waitcnt lgkmcnt(6)
  v_mfma_f32_32x32x16_bf16 v[112:127], v[136:139], v[140:143], v[112:127]
  s_waitcnt lgkmcnt(3)
  v_mfma_f32_32x32x16_bf16 v[112:127], v[144:147], v[148:151], v[112:127]
  s_waitcnt lgkmcnt(0)
  v_mfma_f32_32x32x16_bf16 v[112:127], v[152:155], v[156:159], v[112:127]
  s_nop 11
  s_branch L_q_s2e_a
L_q_r_a:
  s_and_b32 s27, s6, 1
  ds_read_b128 v[132:135], v102 offset:0
  ds_read_b64_tr_b16 v[128:129], v100 offset:30720
  ds_read_b64_tr_b16 v[130:131], v100 offset:30880
  ds_read_b128 v[140:143], v103 offset:0
  ds_read_b64_tr_b16 v[136:137], v100 offset:33280
  ds_read_b64_tr_b16 v[138:139], v100 offset:33440
  ds_read_b128 v[148:151], v104 offset:0
  ds_read_b64_tr_b16 v[144:145], v100 offset:35840
  ds_read_b64_tr_b16 v[146:147], v100 offset:36000
  ds_read_b128 v[156:159], v105 offset:0
  ds_read_b64_tr_b16 v[152:153], v100 offset:38400
  ds_read_b64_tr_b16 v[154:155], v100 offset:38560
  s_waitcnt lgkmcnt(9)
  v_mfma_f32_32x32x16_bf16 v[112:127], v[128:131], v[132:135], 0
  s_mul_i32 s21, s27, 40960
  s_add_u32 s21, s21, 327680
  s_add_u32 s64, s38, s21
  s_addc_u32 s65, s39, 0
  s_mul_i32 s76, s27, 5120
  s_add_u32 s76, s76, 0
  s_mov_b32 m0, s76
  s_nop 0
  global_load_lds_dwordx4 v250, s[64:65] offset:0
  ds_read_b128 v[132:135], v106 offset:0
  ds_read_b64_tr_b16 v[128:129], v101 offset:0
  ds_read_b64_tr_b16 v[130:131], v101 offset:160
  s_waitcnt lgkmcnt(9)
  v_mfma_f32_32x32x16_bf16 v[112:127], v[136:139], v[140:143], v[112:127]
  s_mov_b32 m0, s76
  s_nop 0
  global_load_lds_dwordx4 v251, s[64:65] offset:1024
  ds_read_b128 v[140:143], v107 offset:0
  ds_read_b64_tr_b16 v[136:137], v101 offset:2560
  ds_read_b64_tr_b16 v[138:139], v101 offset:2720
  s_waitcnt lgkmcnt(9)
  v_mfma_f32_32x32x16_bf16 v[112:127], v[144:147], v[148:151], v[112:127]
  s_mov_b32 m0, s76
  s_nop 0
  global_load_lds_dwordx4 v252, s[64:65] offset:2048
  ds_read_b128 v[148:151], v108 offset:0
  ds_read_b64_tr_b16 v[144:145], v101 offset:5120
  ds_read_b64_tr_b16 v[146:147], v101 offset:5280
  s_waitcnt lgkmcnt(9)
  v_mfma_f32_32x32x16_bf16 v[112:127], v[152:155], v[156:159], v[112:127]
  s_mov_b32 m0, s76
  s_nop 0
  global_load_lds_dwordx4 v253, s[64:65] offset:3072
  ds_read_b128 v[156:159], v109 offset:0
  ds_read_b64_tr_b16 v[152:153], v101 offset:7680
  ds_read_b64_tr_b16 v[154:155], v101 offset:7840
  s_waitcnt lgkmcnt(9)
  v_mfma_f32_32x32x16_bf16 v[112:127], v[128:131], v[132:135], v[112:127]
  s_add_u32 m0, s76, 4096
  s_nop 0
  global_load_lds_dwordx4 v254, s[64:65]
  ds_read_b128 v[132:135], v102 offset:8192
  ds_read_b64_tr_b16 v[128:129], v101 offset:10240
  ds_read_b64_tr_b16 v[130:131], v101 offset:10400
  s_waitcnt lgkmcnt(9)
  v_mfma_f32_32x32x16_bf16 v[112:127], v[136:139], v[140:143], v[112:127]
  s_mul_i32 s21, s27, 40960
  s_add_u32 s21, s21, 409600
  s_add_u32 s64, s38, s21
  s_addc_u32 s65, s39, 0
  s_mul_i32 s76, s27, 5120
  s_add_u32 s76, s76, 10240
  s_mov_b32 m0, s76
  s_nop 0
  global_load_lds_dwordx4 v250, s[64:65] offset:0
  ds_read_b128 v[140:143], v103 offset:8192
  ds_read_b64_tr_b16 v[136:137], v101 offset:12800
  ds_read_b64_tr_b16 v[138:139], v101 offset:12960
  s_waitcnt lgkmcnt(9)
  v_mfma_f32_32x32x16_bf16 v[112:127], v[144:147], v[148:151], v[112:127]
  s_mov_b32 m0, s76
  s_nop 0
  global_load_lds_dwordx4 v251, s[64:65] offset:1024
  ds_read_b128 v[148:151], v104 offset:8192
  ds_read_b64_tr_b16 v[144:145], v101 offset:15360
  ds_read_b64_tr_b16 v[146:147], v101 offset:15520
  s_waitcnt lgkmcnt(9)
  v_mfma_f32_32x32x16_bf16 v[112:127], v[152:155], v[156:159], v[112:127]
  s_mov_b32 m0, s76
  s_nop 0
  global_load_lds_dwordx4 v252, s[64:65] offset:2048
  ds_read_b128 v[156:159], v105 offset:8192
  ds_read_b64_tr_b16 v[152:153], v101 offset:17920
  ds_read_b64_tr_b16 v[154:155], v101 offset:18080
  s_waitcnt lgkmcnt(9)
  v_mfma_f32_32x32x16_bf16 v[112:127], v[128:131], v[132:135], v[112:127]
  s_mov_b32 m0, s76
  s_nop 0
  global_load_lds_dwordx4 v253, s[64:65] offset:3072
  ds_read_b128 v[132:135], v106 offset:8192
  ds_read_b64_tr_b16 v[128:129], v101 offset:20480
  ds_read_b64_tr_b16 v[130:131], v101 offset:20640
  s_waitcnt lgkmcnt(9)
  v_mfma_f32_32x32x16_bf16 v[112:127], v[136:139], v[140:143], v[112:127]
  s_add_u32 m0, s76, 4096
  s_nop 0
  global_load_lds_dwordx4 v254, s[64:65]
  ds_read_b128 v[140:143], v107 offset:8192
  ds_read_b64_tr_b16 v[136:137], v101 offset:23040
  ds_read_b64_tr_b16 v[138:139], v101 offset:23200
  s_waitcnt lgkmcnt(9)
  v_mfma_f32_32x32x16_bf16 v[112:127], v[144:147], v[148:151], v[112:127]
  s_mul_i32 s21, s27, 40960
  s_add_u32 s21, s21, 491520
  s_add_u32 s64, s38, s21
  s_addc_u32 s65, s39, 0
  s_mul_i32 s76, s27, 5120
  s_add_u32 s76, s76, 20480
  s_mov_b32 m0, s76
  s_nop 0
  global_load_lds_dwordx4 v250, s[64:65] offset:0
  ds_read_b128 v[148:151], v108 offset:8192
  ds_read_b64_tr_b16 v[144:145], v101 offset:25600
  ds_read_b64_tr_b16 v[146:147], v101 offset:25760
  s_waitcnt lgkmcnt(9)
  v_mfma_f32_32x32x16_bf16 v[112:127], v[152:155], v[156:159], v[112:127]
  s_mov_b32 m0, s76
  s_nop 0
  global_load_lds_dwordx4 v251, s[64:65] offset:1024
  s_mov_b32 m0, s76
  s_nop 0
  global_load_lds_dwordx4 v252, s[64:65] offset:2048
  s_mov_b32 m0, s76
  s_nop 0
  global_load_lds_dwordx4 v253, s[64:65] offset:3072
  s_add_u32 m0, s76, 4096
  s_nop 0
  global_load_lds_dwordx4 v254, s[64:65]
  s_barrier
  ds_read_b128 v[156:159], v109 offset:8192
  ds_read_b64_tr_b16 v[152:153], v101 offset:28160
  ds_read_b64_tr_b16 v[154:155], v101 offset:28320
  s_waitcnt lgkmcnt(9)
  v_mfma_f32_32x32x16_bf16 v[112:127], v[128:131], v[132:135], v[112:127]
  s_mul_i32 s21, s27, 40960
  s_add_u32 s21, s21, 573440
  s_add_u32 s64, s38, s21
  s_addc_u32 s65, s39, 0
  s_mul_i32 s76, s27, 5120
  s_add_u32 s76, s76, 30720
  s_mov_b32 m0, s76
  s_nop 0
  global_load_lds_dwordx4 v250, s[64:65] offset:0
  s_waitcnt lgkmcnt(6)
  v_mfma_f32_32x32x16_bf16 v[112:127], v[136:139], v[140:143], v[112:127]
  s_mov_b32 m0, s76
  s_nop 0
  global_load_lds_dwordx4 v251, s[64:65] offset:1024
  s_waitcnt lgkmcnt(3)
  v_mfma_f32_32x32x16_bf16 v[112:127], v[144:147], v[148:151], v[112:127]
  s_mov_b32 m0, s76
  s_nop 0
  global_load_lds_dwordx4 v252, s[64:65] offset:2048
  s_waitcnt lgkmcnt(0)
  v_mfma_f32_32x32x16_bf16 v[112:127], v[152:155], v[156:159], v[112:127]
  s_mov_b32 m0, s76
  s_nop 0
  global_load_lds_dwordx4 v253, s[64:65] offset:3072
  s_waitcnt vmcnt(4)
  s_barrier
  ds_read_b128 v[132:135], v102 offset:16384
  ds_read_b64_tr_b16 v[128:129], v100 offset:0
  ds_read_b64_tr_b16 v[130:131], v100 offset:160
  ds_read_b128 v[140:143], v103 offset:16384
  ds_read_b64_tr_b16 v[136:137], v100 offset:2560
  ds_read_b64_tr_b16 v[138:139], v100 offset:2720
  ds_read_b128 v[148:151], v104 offset:16384
  ds_read_b64_tr_b16 v[144:145], v100 offset:5120
  ds_read_b64_tr_b16 v[146:147], v100 offset:5280
  ds_read_b128 v[156:159], v105 offset:16384
  ds_read_b64_tr_b16 v[152:153], v100 offset:7680
  ds_read_b64_tr_b16 v[154:155], v100 offset:7840
  s_waitcnt lgkmcnt(9)
  v_mfma_f32_32x32x16_bf16 v[112:127], v[128:131], v[132:135], v[112:127]
  s_add_u32 m0, s76, 4096
  s_nop 0
  global_load_lds_dwordx4 v254, s[64:65]
  ds_read_b128 v[132:135], v106 offset:16384
  ds_read_b64_tr_b16 v[128:129], v100 offset:10240
  ds_read_b64_tr_b16 v[130:131], v100 offset:10400
  s_waitcnt lgkmcnt(9)
  v_mfma_f32_32x32x16_bf16 v[112:127], v[136:139], v[140:143], v[112:127]
  s_mul_i32 s21, s27, 40960
  s_add_u32 s21, s21, 655360
  s_add_u32 s64, s38, s21
  s_addc_u32 s65, s39, 0
  s_mul_i32 s76, s27, 5120
  s_add_u32 s76, s76, 40960
  s_mov_b32 m0, s76
  s_nop 0
  global_load_lds_dwordx4 v250, s[64:65] offset:0
  ds_read_b128 v[140:143], v107 offset:16384
  ds_read_b64_tr_b16 v[136:137], v100 offset:12800
  ds_read_b64_tr_b16 v[138:139], v100 offset:12960
  s_waitcnt lgkmcnt(9)
  v_mfma_f32_32x32x16_bf16 v[112:127], v[144:147], v[148:151], v[112:127]
  s_mov_b32 m0, s76
  s_nop 0
  global_load_lds_dwordx4 v251, s[64:65] offset:1024
  ds_read_b128 v[148:151], v108 offset:16384
  ds_read_b64_tr_b16 v[144:145], v100 offset:15360
  ds_read_b64_tr_b16 v[146:147], v100 offset:15520
  s_waitcnt lgkmcnt(9)
  v_mfma_f32_32x32x16_bf16 v[112:127], v[152:155], v[156:159], v[112:127]
  s_mov_b32 m0, s76
  s_nop 0
  global_load_lds_dwordx4 v252, s[64:65] offset:2048
  ds_read_b128 v[156:159], v109 offset:16384
  ds_read_b64_tr_b16 v[152:153], v100 offset:17920
  ds_read_b64_tr_b16 v[154:155], v100 offset:18080
  s_waitcnt lgkmcnt(9)
  v_mfma_f32_32x32x16_bf16 v[112:127], v[128:131], v[132:135], v[112:127]
  s_mov_b32 m0, s76
  s_nop 0
  global_load_lds_dwordx4 v253, s[64:65] offset:3072
  ds_read_b128 v[132:135], v102 offset:24576
  ds_read_b64_tr_b16 v[128:129], v100 offset:20480
  ds_read_b64_tr_b16 v[130:131], v100 offset:20640
  s_waitcnt lgkmcnt(9)
  v_mfma_f32_32x32x16_bf16 v[112:127], v[136:139], v[140:143], v[112:127]
  s_add_u32 m0, s76, 4096
  s_nop 0
  global_load_lds_dwordx4 v254, s[64:65]
  ds_read_b128 v[140:143], v103 offset:24576
  ds_read_b64_tr_b16 v[136:137], v100 offset:23040
  ds_read_b64_tr_b16 v[138:139], v100 offset:23200
  s_waitcnt lgkmcnt(9)
  v_mfma_f32_32x32x16_bf16 v[112:127], v[144:147], v[148:151], v[112:127]
  s_mul_i32 s21, s27, 40960
  s_add_u32 s21, s21, 737280
  s_add_u32 s64, s38, s21
  s_addc_u32 s65, s39, 0
  s_mul_i32 s76, s27, 5120
  s_add_u32 s76, s76, 51200
  s_mov_b32 m0, s76
  s_nop 0
  global_load_lds_dwordx4 v250, s[64:65] offset:0
  ds_read_b128 v[148:151], v104 offset:24576
  ds_read_b64_tr_b16 v[144:145], v100 offset:25600
  ds_read_b64_tr_b16 v[146:147], v100 offset:25760
  s_waitcnt lgkmcnt(9)
  v_mfma_f32_32x32x16_bf16 v[112:127], v[152:155], v[156:159], v[112:127]
  s_mov_b32 m0, s76
  s_nop 0
  global_load_lds_dwordx4 v251, s[64:65] offset:1024
  ds_read_b128 v[156:159], v105 offset:24576
  ds_read_b64_tr_b16 v[152:153], v100 offset:28160
  ds_read_b64_tr_b16 v[154:155], v100 offset:28320
  s_waitcnt lgkmcnt(9)
  v_mfma_f32_32x32x16_bf16 v[112:127], v[128:131], v[132:135], v[112:127]
  s_mov_b32 m0, s76
  s_nop 0
  global_load_lds_dwordx4 v252, s[64:65] offset:2048
  s_waitcnt lgkmcnt(6)
  v_mfma_f32_32x32x16_bf16 v[112:127], v[136:139], v[140:143], v[112:127]
  s_mov_b32 m0, s76
  s_nop 0
  global_load_lds_dwordx4 v253, s[64:65] offset:3072
  s_waitcnt lgkmcnt(3)
  v_mfma_f32_32x32x16_bf16 v[112:127], v[144:147], v[148:151], v[112:127]
  s_add_u32 m0, s76, 4096
  s_nop 0
  global_load_lds_dwordx4 v254, s[64:65]
  s_waitcnt lgkmcnt(0)
  v_mfma_f32_32x32x16_bf16 v[112:127], v[152:155], v[156:159], v[112:127]
  s_waitcnt vmcnt(0)
  s_nop 10
L_q_s2e_a:
  s_barrier
  s_and_b32 s22, s6, 3
  s_mul_i32 s20, s22, 7168
  s_add_u32 s62, s60, s20
  s_addc_u32 s63, s61, 0
  s_lshl_b32 s20, s22, 10
  s_add_u32 s20, s20, 524288
  v_lshrrev_b32 v248, 3, v1
  v_lshlrev_b32 v248, 12, v248
  v_and_b32 v249, 7, v1
  v_lshl_add_u32 v248, v249, 7, v248
  v_add_u32 v248, s20, v248
  s_mov_b32 s34, 0x01010101
  s_mov_b32 s35, 0x01010101
  v_mov_b32 v249, s7
  s_mov_b32 s10, 0
  s_mov_b64 s[100:101], 0
  global_load_dwordx2 v[240:241], v248, s[60:61] sc1
  ds_read_b128 v[132:135], v106 offset:24576
  ds_read_b64_tr_b16 v[128:129], v100 offset:30720
  ds_read_b64_tr_b16 v[130:131], v100 offset:30880
  ds_read_b128 v[140:143], v107 offset:24576
  ds_read_b64_tr_b16 v[136:137], v100 offset:33280
  ds_read_b64_tr_b16 v[138:139], v100 offset:33440
  ds_read_b128 v[148:151], v108 offset:24576
  ds_read_b64_tr_b16 v[144:145], v100 offset:35840
  ds_read_b64_tr_b16 v[146:147], v100 offset:36000
  ds_read_b128 v[156:159], v109 offset:24576
  ds_read_b64_tr_b16 v[152:153], v100 offset:38400
  ds_read_b64_tr_b16 v[154:155], v100 offset:38560
  s_waitcnt lgkmcnt(9)
  v_mfma_f32_32x32x16_bf16 v[112:127], v[128:131], v[132:135], v[112:127]
  ds_read_b128 v[132:135], v102 offset:32768
  ds_read_b64_tr_b16 v[128:129], v101 offset:0
  ds_read_b64_tr_b16 v[130:131], v101 offset:160
  s_waitcnt lgkmcnt(9)
  v_mfma_f32_32x32x16_bf16 v[112:127], v[136:139], v[140:143], v[112:127]
  ds_read_b128 v[140:143], v103 offset:32768
  ds_read_b64_tr_b16 v[136:137], v101 offset:2560
  ds_read_b64_tr_b16 v[138:139], v101 offset:2720
  s_waitcnt lgkmcnt(9)
  v_mfma_f32_32x32x16_bf16 v[112:127], v[144:147], v[148:151], v[112:127]
  ds_read_b128 v[148:151], v104 offset:32768
  ds_read_b64_tr_b16 v[144:145], v101 offset:5120
  ds_read_b64_tr_b16 v[146:147], v101 offset:5280
  s_waitcnt lgkmcnt(9)
  v_mfma_f32_32x32x16_bf16 v[112:127], v[152:155], v[156:159], v[112:127]
  ds_read_b128 v[156:159], v105 offset:32768
  ds_read_b64_tr_b16 v[152:153], v101 offset:7680
  ds_read_b64_tr_b16 v[154:155], v101 offset:7840
  s_waitcnt lgkmcnt(9)
  v_mfma_f32_32x32x16_bf16 v[112:127], v[128:131], v[132:135], v[112:127]
  ds_read_b128 v[132:135], v106 offset:32768
  ds_read_b64_tr_b16 v[128:129], v101 offset:10240
  ds_read_b64_tr_b16 v[130:131], v101 offset:10400
  s_waitcnt lgkmcnt(9)
  v_mfma_f32_32x32x16_bf16 v[112:127], v[136:139], v[140:143], v[112:127]
  ds_read_b128 v[140:143], v107 offset:32768
  ds_read_b64_tr_b16 v[136:137], v101 offset:12800
  ds_read_b64_tr_b16 v[138:139], v101 offset:12960
  s_waitcnt lgkmcnt(9)
  v_mfma_f32_32x32x16_bf16 v[112:127], v[144:147], v[148:151], v[112:127]
  ds_read_b128 v[148:151], v108 offset:32768
  ds_read_b64_tr_b16 v[144:145], v101 offset:15360
  ds_read_b64_tr_b16 v[146:147], v101 offset:15520
  s_waitcnt lgkmcnt(9)
  v_mfma_f32_32x32x16_bf16 v[112:127], v[152:155], v[156:159], v[112:127]
  ds_read_b128 v[156:159], v109 offset:32768
  ds_read_b64_tr_b16 v[152:153], v101 offset:17920
  ds_read_b64_tr_b16 v[154:155], v101 offset:18080
  s_waitcnt lgkmcnt(9)
  v_mfma_f32_32x32x16_bf16 v[112:127], v[128:131], v[132:135], v[112:127]
  s_waitcnt lgkmcnt(6)
  v_mfma_f32_32x32x16_bf16 v[112:127], v[136:139], v[140:143], v[112:127]
  s_waitcnt lgkmcnt(3)
  v_mfma_f32_32x32x16_bf16 v[112:127], v[144:147], v[148:151], v[112:127]
  s_waitcnt lgkmcnt(0)
  v_mfma_f32_32x32x16_bf16 v[112:127], v[152:155], v[156:159], v[112:127]
  ds_read_b64 v[8:9], v84
  s_barrier
  ds_read_b128 v[128:131], v85
  ds_read_b128 v[132:135], v86
  ds_read_b128 v[136:139], v87
  ds_read_b128 v[140:143], v88
  s_mov_b32 s10, 0
  s_waitcnt vmcnt(0)
  v_cmp_eq_u32 vcc, v249, v240
  v_cmp_eq_u32 s[24:25], v249, v241
  s_nop 0
  s_and_b64 s[24:25], s[24:25], vcc
  s_lshr_b64 s[26:27], s[24:25], 4
  s_and_b64 s[24:25], s[24:25], s[26:27]
  s_lshr_b64 s[26:27], s[24:25], 2
  s_and_b64 s[24:25], s[24:25], s[26:27]
  s_lshr_b64 s[26:27], s[24:25], 1
  s_and_b64 s[24:25], s[24:25], s[26:27]
  s_mov_b64 s[100:101], s[24:25]
  s_and_b64 s[24:25], s[24:25], s[34:35]
  s_cbranch_scc0 L_try_4
  s_ff1_i32_b64 s20, s[24:25]
  s_bitset0_b64 s[34:35], s20
  s_mul_i32 s20, s20, 3584
  s_add_u32 s66, s62, s20
  s_addc_u32 s67, s63, 0
  global_load_dwordx4 v[212:215], v0, s[66:67] sc1
  global_load_dwordx2 v[216:217], v5, s[66:67] sc1
  global_load_dwordx4 v[218:221], v4, s[66:67] offset:1536 sc1
  global_load_dwordx4 v[222:225], v4, s[66:67] offset:2560 sc1
  s_mov_b32 s10, 1
L_try_4:
  s_waitcnt lgkmcnt(0)
  v_mul_f32 v8, 0x3ea52b5c, v8
  v_mul_f32 v9, 0x3ea52b5c, v9
  v_mul_f32 v128, v9, v128
  v_mul_f32 v129, v9, v129
  v_mul_f32 v130, v9, v130
  v_mul_f32 v131, v9, v131
  v_mul_f32 v132, v9, v132
  v_mul_f32 v133, v9, v133
  v_mul_f32 v134, v9, v134
  v_mul_f32 v135, v9, v135
  v_mul_f32 v136, v9, v136
  v_mul_f32 v137, v9, v137
  v_mul_f32 v138, v9, v138
  v_mul_f32 v139, v9, v139
  v_mul_f32 v140, v9, v140
  v_mul_f32 v141, v9, v141
  v_mul_f32 v142, v9, v142
  v_mul_f32 v143, v9, v143
  v_fma_f32 v112, v8, v112, -v128
  v_fma_f32 v113, v8, v113, -v129
  v_fma_f32 v114, v8, v114, -v130
  v_fma_f32 v115, v8, v115, -v131
  v_fma_f32 v116, v8, v116, -v132
  v_fma_f32 v117, v8, v117, -v133
  v_fma_f32 v118, v8, v118, -v134
  v_fma_f32 v119, v8, v119, -v135
  v_fma_f32 v120, v8, v120, -v136
  v_fma_f32 v121, v8, v121, -v137
  v_fma_f32 v122, v8, v122, -v138
  v_fma_f32 v123, v8, v123, -v139
  v_fma_f32 v124, v8, v124, -v140
  v_fma_f32 v125, v8, v125, -v141
  v_fma_f32 v126, v8, v126, -v142
  v_fma_f32 v127, v8, v127, -v143
  v_cvt_pk_bf16_f32 v112, v112, v113
  v_cvt_pk_bf16_f32 v113, v114, v115
  v_cvt_pk_bf16_f32 v114, v116, v117
  v_cvt_pk_bf16_f32 v115, v118, v119
  v_cvt_pk_bf16_f32 v116, v120, v121
  v_cvt_pk_bf16_f32 v117, v122, v123
  v_cvt_pk_bf16_f32 v118, v124, v125
  v_cvt_pk_bf16_f32 v119, v126, v127
  v_and_b32 v112, v112, v93
  v_and_b32 v113, v113, v93
  v_and_b32 v114, v114, v94
  v_and_b32 v115, v115, v94
  v_and_b32 v116, v116, v95
  v_and_b32 v117, v117, v95
  v_and_b32 v118, v118, v96
  v_and_b32 v119, v119, v96
  ds_write_b64 v89, v[112:113]
  ds_write_b64 v90, v[114:115]
  ds_write_b64 v91, v[116:117]
  ds_write_b64 v92, v[118:119]
  s_cmp_eq_u32 s10, 0
  s_cbranch_scc0 L_must_5
  global_load_dwordx2 v[240:241], v248, s[60:61] sc1
  s_waitcnt vmcnt(0)
  s_and_b64 s[24:25], s[100:101], s[34:35]
  s_cmp_eq_u64 s[24:25], s[34:35]
  s_cbranch_scc1 SK_nbp_6
  v_cmp_eq_u32 vcc, v249, v240
  v_cmp_eq_u32 s[24:25], v249, v241
  s_nop 0
  s_and_b64 s[24:25], s[24:25], vcc
  s_lshr_b64 s[26:27], s[24:25], 4
  s_and_b64 s[24:25], s[24:25], s[26:27]
  s_lshr_b64 s[26:27], s[24:25], 2
  s_and_b64 s[24:25], s[24:25], s[26:27]
  s_lshr_b64 s[26:27], s[24:25], 1
  s_and_b64 s[24:25], s[24:25], s[26:27]
  s_mov_b64 s[100:101], s[24:25]
  s_and_b64 s[24:25], s[24:25], s[34:35]
  s_cbranch_scc1 SK_nbp_6
  s_mov_b32 s20, 0
L_nbpp_6:
  global_load_dwordx2 v[240:241], v248, s[60:61] sc1
  s_waitcnt vmcnt(0)
  v_cmp_eq_u32 vcc, v249, v240
  v_cmp_eq_u32 s[24:25], v249, v241
  s_nop 0
  s_and_b64 s[24:25], s[24:25], vcc
  s_lshr_b64 s[26:27], s[24:25], 4
  s_and_b64 s[24:25], s[24:25], s[26:27]
  s_lshr_b64 s[26:27], s[24:25], 2
  s_and_b64 s[24:25], s[24:25], s[26:27]
  s_lshr_b64 s[26:27], s[24:25], 1
  s_and_b64 s[24:25], s[24:25], s[26:27]
  s_mov_b64 s[100:101], s[24:25]
  s_and_b64 s[24:25], s[24:25], s[34:35]
  s_cbranch_scc1 SK_nbp_6
  s_add_u32 s20, s20, 1
  s_cmp_lt_u32 s20, s9
  s_cbranch_scc1 L_nbpp_6
  s_mov_b32 s9, 0
  s_mov_b64 s[24:25], s[34:35]
SK_nbp_6:
  s_ff1_i32_b64 s20, s[24:25]
  s_bitset0_b64 s[34:35], s20
  s_mul_i32 s20, s20, 3584
  s_add_u32 s66, s62, s20
  s_addc_u32 s67, s63, 0
  global_load_dwordx4 v[212:215], v0, s[66:67] sc1
  global_load_dwordx2 v[216:217], v5, s[66:67] sc1
  global_load_dwordx4 v[218:221], v4, s[66:67] offset:1536 sc1
  global_load_dwordx4 v[222:225], v4, s[66:67] offset:2560 sc1
L_must_5:
  s_branch L_q_done_a
L_kv_a:
  v_and_b32 v6, 15, v1
  v_lshrrev_b32 v7, 4, v1
  s_lshr_b32 s20, s19, 1
  s_mul_i32 s20, s20, 40960
  s_add_u32 s20, s20, 71680
  s_and_b32 s21, s19, 1
  s_lshl_b32 s21, s21, 4
  v_add_u32 v8, s21, v6
  v_xor_b32 v9, v7, v6
  v_lshlrev_b32 v9, 4, v9
  v_lshl_add_u32 v9, v8, 8, v9
  v_add_u32 v60, s20, v9
  v_xor_b32 v61, 64, v60
  v_xor_b32 v62, 128, v60
  v_xor_b32 v63, 192, v60
  v_bfe_u32 v9, v1, 2, 2
  v_lshl_add_u32 v9, v7, 3, v9
  v_mul_u32_u24 v9, 40, v9
  v_and_b32 v10, 3, v1
  s_cmp_eq_u32 s6, 6
  s_cselect_b32 s22, 0, 4
  s_cselect_b32 s23, 3, 0
  v_and_b32 v10, s23, v10
  v_add_u32 v10, s22, v10
  v_lshl_add_u32 v64, v10, 3, v9
  v_mov_b32 v116, 0x3f803f80
  v_mov_b32 v117, 0x3f803f80
  v_mov_b32 v118, 0x3f803f80
  v_mov_b32 v119, 0x3f803f80
  s_lshr_b32 s20, s19, 1
  s_lshl_b32 s21, s4, 1
  s_add_u32 s20, s20, s21
  s_mul_i32 s20, s20, 3584
  s_add_u32 s68, s60, s20
  s_addc_u32 s69, s61, 0
  s_lshl_b32 s20, s19, 7
  s_add_u32 s20, s20, 161792
  v_lshrrev_b32 v10, 1, v7
  v_and_b32 v11, 1, v7
  s_bitcmp1_b32 s5, 0
  s_nop 0
  s_cbranch_scc1 L_kvV0_a
  v_lshl_add_u32 v66, v6, 3, s20
  v_lshl_add_u32 v65, v10, 5, v8
  v_lshlrev_b32 v65, 4, v65
  v_lshl_add_u32 v65, v11, 3, v65
  v_lshl_add_u32 v9, v7, 5, v8
  v_lshlrev_b32 v9, 3, v9
  v_add_u32 v9, 1024, v9
  s_cmp_eq_u32 s6, 6
  s_nop 0
  s_cbranch_scc1 L_kvA_a
  v_mov_b32 v65, v9
  s_nop 1
  s_branch L_kvA_a
L_kvV0_a:
  v_lshl_add_u32 v66, v7, 5, s20
  v_and_b32 v65, 3, v6
  v_bfe_u32 v9, v6, 2, 1
  v_lshl_add_u32 v65, v9, 3, v65
  v_bfe_u32 v9, v6, 3, 1
  v_lshl_add_u32 v65, v9, 2, v65
  s_cmp_eq_u32 s6, 6
  s_nop 0
  s_cbranch_scc1 L_kvV1_a
  v_add_u32 v65, 16, v6
  s_nop 1
L_kvV1_a:
  v_lshl_add_u32 v65, v10, 5, v65
  v_lshlrev_b32 v65, 4, v65
  v_lshl_add_u32 v65, v11, 3, v65
  s_and_b32 s20, s19, 1
  s_lshl_b32 s20, s20, 10
  s_add_u32 s20, s20, 1536
  v_add_u32 v65, s20, v65
  s_nop 1
L_kvA_a:
  s_lshl_b32 s20, s3, 7
  s_lshl_b32 s21, s6, 2
  s_add_u32 s20, s20, s21
  s_add_u32 s20, s20, 524264
  v_mov_b32 v114, s20
  s_sub_u32 s27, s6, 6
  s_waitcnt vmcnt(0)
  s_barrier
  s_bitcmp1_b32 s5, 0
  s_cbranch_scc1 L_kvV_a
  ds_read_b128 v[76:79], v60 offset:0
  ds_read_b64_tr_b16 v[72:73], v64 offset:0
  ds_read_b64_tr_b16 v[74:75], v64 offset:160
  ds_read_b128 v[84:87], v61 offset:0
  ds_read_b64_tr_b16 v[80:81], v64 offset:1280
  ds_read_b64_tr_b16 v[82:83], v64 offset:1440
  ds_read_b128 v[92:95], v62 offset:0
  ds_read_b64_tr_b16 v[88:89], v64 offset:2560
  ds_read_b64_tr_b16 v[90:91], v64 offset:2720
  ds_read_b128 v[100:103], v63 offset:0
  ds_read_b64_tr_b16 v[96:97], v64 offset:3840
  ds_read_b64_tr_b16 v[98:99], v64 offset:4000
  ds_read_b128 v[108:111], v60 offset:8192
  ds_read_b64_tr_b16 v[104:105], v64 offset:5120
  ds_read_b64_tr_b16 v[106:107], v64 offset:5280
  s_waitcnt lgkmcnt(12)
  v_mfma_f32_16x16x32_bf16 v[68:71], v[72:75], v[76:79], 0
  v_mfma_f32_16x16x32_bf16 v[12:15], v[72:75], v[116:119], 0
  ds_read_b128 v[76:79], v61 offset:8192
  ds_read_b64_tr_b16 v[72:73], v64 offset:6400
  ds_read_b64_tr_b16 v[74:75], v64 offset:6560
  s_waitcnt lgkmcnt(12)
  v_mfma_f32_16x16x32_bf16 v[68:71], v[80:83], v[84:87], v[68:71]
  v_mfma_f32_16x16x32_bf16 v[12:15], v[80:83], v[116:119], v[12:15]
  ds_read_b128 v[84:87], v62 offset:8192
  ds_read_b64_tr_b16 v[80:81], v64 offset:7680
  ds_read_b64_tr_b16 v[82:83], v64 offset:7840
  s_waitcnt lgkmcnt(12)
  v_mfma_f32_16x16x32_bf16 v[68:71], v[88:91], v[92:95], v[68:71]
  v_mfma_f32_16x16x32_bf16 v[12:15], v[88:91], v[116:119], v[12:15]
  ds_read_b128 v[92:95], v63 offset:8192
  ds_read_b64_tr_b16 v[88:89], v64 offset:8960
  ds_read_b64_tr_b16 v[90:91], v64 offset:9120
  s_waitcnt lgkmcnt(12)
  v_mfma_f32_16x16x32_bf16 v[68:71], v[96:99], v[100:103], v[68:71]
  v_mfma_f32_16x16x32_bf16 v[12:15], v[96:99], v[116:119], v[12:15]
  ds_read_b128 v[100:103], v60 offset:16384
  ds_read_b64_tr_b16 v[96:97], v64 offset:10240
  ds_read_b64_tr_b16 v[98:99], v64 offset:10400
  s_waitcnt lgkmcnt(12)
  v_mfma_f32_16x16x32_bf16 v[68:71], v[104:107], v[108:111], v[68:71]
  v_mfma_f32_16x16x32_bf16 v[12:15], v[104:107], v[116:119], v[12:15]
  ds_read_b128 v[108:111], v61 offset:16384
  ds_read_b64_tr_b16 v[104:105], v64 offset:11520
  ds_read_b64_tr_b16 v[106:107], v64 offset:11680
  s_waitcnt lgkmcnt(12)
  v_mfma_f32_16x16x32_bf16 v[68:71], v[72:75], v[76:79], v[68:71]
  v_mfma_f32_16x16x32_bf16 v[12:15], v[72:75], v[116:119], v[12:15]
  ds_read_b128 v[76:79], v62 offset:16384
  ds_read_b64_tr_b16 v[72:73], v64 offset:12800
  ds_read_b64_tr_b16 v[74:75], v64 offset:12960
  s_waitcnt lgkmcnt(12)
  v_mfma_f32_16x16x32_bf16 v[68:71], v[80:83], v[84:87], v[68:71]
  v_mfma_f32_16x16x32_bf16 v[12:15], v[80:83], v[116:119], v[12:15]
  ds_read_b128 v[84:87], v63 offset:16384
  ds_read_b64_tr_b16 v[80:81], v64 offset:14080
  ds_read_b64_tr_b16 v[82:83], v64 offset:14240
  s_waitcnt lgkmcnt(12)
  v_mfma_f32_16x16x32_bf16 v[68:71], v[88:91], v[92:95], v[68:71]
  v_mfma_f32_16x16x32_bf16 v[12:15], v[88:91], v[116:119], v[12:15]
  ds_read_b128 v[92:95], v60 offset:24576
  ds_read_b64_tr_b16 v[88:89], v64 offset:15360
  ds_read_b64_tr_b16 v[90:91], v64 offset:15520
  s_waitcnt lgkmcnt(12)
  v_mfma_f32_16x16x32_bf16 v[68:71], v[96:99], v[100:103], v[68:71]
  v_mfma_f32_16x16x32_bf16 v[12:15], v[96:99], v[116:119], v[12:15]
  ds_read_b128 v[100:103], v61 offset:24576
  ds_read_b64_tr_b16 v[96:97], v64 offset:16640
  ds_read_b64_tr_b16 v[98:99], v64 offset:16800
  s_waitcnt lgkmcnt(12)
  v_mfma_f32_16x16x32_bf16 v[68:71], v[104:107], v[108:111], v[68:71]
  v_mfma_f32_16x16x32_bf16 v[12:15], v[104:107], v[116:119], v[12:15]
  ds_read_b128 v[108:111], v62 offset:24576
  ds_read_b64_tr_b16 v[104:105], v64 offset:17920
  ds_read_b64_tr_b16 v[106:107], v64 offset:18080
  s_waitcnt lgkmcnt(12)
  v_mfma_f32_16x16x32_bf16 v[68:71], v[72:75], v[76:79], v[68:71]
  v_mfma_f32_16x16x32_bf16 v[12:15], v[72:75], v[116:119], v[12:15]
  ds_read_b128 v[76:79], v63 offset:24576
  ds_read_b64_tr_b16 v[72:73], v64 offset:19200
  ds_read_b64_tr_b16 v[74:75], v64 offset:19360
  s_waitcnt lgkmcnt(12)
  v_mfma_f32_16x16x32_bf16 v[68:71], v[80:83], v[84:87], v[68:71]
  v_mfma_f32_16x16x32_bf16 v[12:15], v[80:83], v[116:119], v[12:15]
  ds_read_b128 v[84:87], v60 offset:32768
  ds_read_b64_tr_b16 v[80:81], v64 offset:20480
  ds_read_b64_tr_b16 v[82:83], v64 offset:20640
  s_waitcnt lgkmcnt(12)
  v_mfma_f32_16x16x32_bf16 v[68:71], v[88:91], v[92:95], v[68:71]
  v_mfma_f32_16x16x32_bf16 v[12:15], v[88:91], v[116:119], v[12:15]
  ds_read_b128 v[92:95], v61 offset:32768
  ds_read_b64_tr_b16 v[88:89], v64 offset:21760
  ds_read_b64_tr_b16 v[90:91], v64 offset:21920
  s_waitcnt lgkmcnt(12)
  v_mfma_f32_16x16x32_bf16 v[68:71], v[96:99], v[100:103], v[68:71]
  v_mfma_f32_16x16x32_bf16 v[12:15], v[96:99], v[116:119], v[12:15]
  ds_read_b128 v[100:103], v62 offset:32768
  ds_read_b64_tr_b16 v[96:97], v64 offset:23040
  ds_read_b64_tr_b16 v[98:99], v64 offset:23200
  s_waitcnt lgkmcnt(12)
  v_mfma_f32_16x16x32_bf16 v[68:71], v[104:107], v[108:111], v[68:71]
  v_mfma_f32_16x16x32_bf16 v[12:15], v[104:107], v[116:119], v[12:15]
  ds_read_b128 v[108:111], v63 offset:32768
  ds_read_b64_tr_b16 v[104:105], v64 offset:24320
  ds_read_b64_tr_b16 v[106:107], v64 offset:24480
  s_waitcnt lgkmcnt(12)
  v_mfma_f32_16x16x32_bf16 v[68:71], v[72:75], v[76:79], v[68:71]
  v_mfma_f32_16x16x32_bf16 v[12:15], v[72:75], v[116:119], v[12:15]
  s_waitcnt lgkmcnt(9)
  v_mfma_f32_16x16x32_bf16 v[68:71], v[80:83], v[84:87], v[68:71]
  v_mfma_f32_16x16x32_bf16 v[12:15], v[80:83], v[116:119], v[12:15]
  s_waitcnt lgkmcnt(6)
  v_mfma_f32_16x16x32_bf16 v[68:71], v[88:91], v[92:95], v[68:71]
  v_mfma_f32_16x16x32_bf16 v[12:15], v[88:91], v[116:119], v[12:15]
  s_waitcnt lgkmcnt(3)
  v_mfma_f32_16x16x32_bf16 v[68:71], v[96:99], v[100:103], v[68:71]
  v_mfma_f32_16x16x32_bf16 v[12:15], v[96:99], v[116:119], v[12:15]
  s_waitcnt lgkmcnt(0)
  v_mfma_f32_16x16x32_bf16 v[68:71], v[104:107], v[108:111], v[68:71]
  v_mfma_f32_16x16x32_bf16 v[12:15], v[104:107], v[116:119], v[12:15]
  s_barrier
  v_mov_b32 v9, 163200
  ds_read_b32 v9, v9
  ds_read_b64 v[72:73], v66
  v_cmp_gt_u32 vcc, 16, v1
  s_waitcnt lgkmcnt(0)
  s_nop 1
  v_mul_f32 v74, v73, v12
  v_mul_f32 v75, v73, v13
  v_mul_f32 v76, v73, v14
  v_mul_f32 v77, v73, v15
  v_fma_f32 v68, v72, v68, -v74
  v_fma_f32 v69, v72, v69, -v75
  v_fma_f32 v70, v72, v70, -v76
  v_fma_f32 v71, v72, v71, -v77
  v_cvt_pk_bf16_f32 v72, v68, v69
  v_cvt_pk_bf16_f32 v73, v70, v71
  s_cmp_eq_u32 s6, 6
  s_nop 0
  s_cbranch_scc1 L_kvst_a
  v_cndmask_b32 v72, v116, v72, vcc
  v_cndmask_b32 v73, 0, v73, vcc
  s_mov_b64 exec, 0xffffffff
  s_nop 0
  s_branch L_kvst_a
L_kvV_a:
  ds_read_b128 v[76:79], v60 offset:0
  ds_read_b64_tr_b16 v[72:73], v64 offset:0
  ds_read_b64_tr_b16 v[74:75], v64 offset:160
  ds_read_b128 v[84:87], v61 offset:0
  ds_read_b64_tr_b16 v[80:81], v64 offset:1280
  ds_read_b64_tr_b16 v[82:83], v64 offset:1440
  ds_read_b128 v[92:95], v62 offset:0
  ds_read_b64_tr_b16 v[88:89], v64 offset:2560
  ds_read_b64_tr_b16 v[90:91], v64 offset:2720
  ds_read_b128 v[100:103], v63 offset:0
  ds_read_b64_tr_b16 v[96:97], v64 offset:3840
  ds_read_b64_tr_b16 v[98:99], v64 offset:4000
  ds_read_b128 v[108:111], v60 offset:8192
  ds_read_b64_tr_b16 v[104:105], v64 offset:5120
  ds_read_b64_tr_b16 v[106:107], v64 offset:5280
  s_waitcnt lgkmcnt(12)
  v_mfma_f32_16x16x32_bf16 v[68:71], v[76:79], v[72:75], 0
  v_mfma_f32_16x16x32_bf16 v[12:15], v[116:119], v[72:75], 0
  ds_read_b128 v[76:79], v61 offset:8192
  ds_read_b64_tr_b16 v[72:73], v64 offset:6400
  ds_read_b64_tr_b16 v[74:75], v64 offset:6560
  s_waitcnt lgkmcnt(12)
  v_mfma_f32_16x16x32_bf16 v[68:71], v[84:87], v[80:83], v[68:71]
  v_mfma_f32_16x16x32_bf16 v[12:15], v[116:119], v[80:83], v[12:15]
  ds_read_b128 v[84:87], v62 offset:8192
  ds_read_b64_tr_b16 v[80:81], v64 offset:7680
  ds_read_b64_tr_b16 v[82:83], v64 offset:7840
  s_waitcnt lgkmcnt(12)
  v_mfma_f32_16x16x32_bf16 v[68:71], v[92:95], v[88:91], v[68:71]
  v_mfma_f32_16x16x32_bf16 v[12:15], v[116:119], v[88:91], v[12:15]
  ds_read_b128 v[92:95], v63 offset:8192
  ds_read_b64_tr_b16 v[88:89], v64 offset:8960
  ds_read_b64_tr_b16 v[90:91], v64 offset:9120
  s_waitcnt lgkmcnt(12)
  v_mfma_f32_16x16x32_bf16 v[68:71], v[100:103], v[96:99], v[68:71]
  v_mfma_f32_16x16x32_bf16 v[12:15], v[116:119], v[96:99], v[12:15]
  ds_read_b128 v[100:103], v60 offset:16384
  ds_read_b64_tr_b16 v[96:97], v64 offset:10240
  ds_read_b64_tr_b16 v[98:99], v64 offset:10400
  s_waitcnt lgkmcnt(12)
  v_mfma_f32_16x16x32_bf16 v[68:71], v[108:111], v[104:107], v[68:71]
  v_mfma_f32_16x16x32_bf16 v[12:15], v[116:119], v[104:107], v[12:15]
  ds_read_b128 v[108:111], v61 offset:16384
  ds_read_b64_tr_b16 v[104:105], v64 offset:11520
  ds_read_b64_tr_b16 v[106:107], v64 offset:11680
  s_waitcnt lgkmcnt(12)
  v_mfma_f32_16x16x32_bf16 v[68:71], v[76:79], v[72:75], v[68:71]
  v_mfma_f32_16x16x32_bf16 v[12:15], v[116:119], v[72:75], v[12:15]
  ds_read_b128 v[76:79], v62 offset:16384
  ds_read_b64_tr_b16 v[72:73], v64 offset:12800
  ds_read_b64_tr_b16 v[74:75], v64 offset:12960
  s_waitcnt lgkmcnt(12)
  v_mfma_f32_16x16x32_bf16 v[68:71], v[84:87], v[80:83], v[68:71]
  v_mfma_f32_16x16x32_bf16 v[12:15], v[116:119], v[80:83], v[12:15]
  ds_read_b128 v[84:87], v63 offset:16384
  ds_read_b64_tr_b16 v[80:81], v64 offset:14080
  ds_read_b64_tr_b16 v[82:83], v64 offset:14240
  s_waitcnt lgkmcnt(12)
  v_mfma_f32_16x16x32_bf16 v[68:71], v[92:95], v[88:91], v[68:71]
  v_mfma_f32_16x16x32_bf16 v[12:15], v[116:119], v[88:91], v[12:15]
  ds_read_b128 v[92:95], v60 offset:24576
  ds_read_b64_tr_b16 v[88:89], v64 offset:15360
  ds_read_b64_tr_b16 v[90:91], v64 offset:15520
  s_waitcnt lgkmcnt(12)
  v_mfma_f32_16x16x32_bf16 v[68:71], v[100:103], v[96:99], v[68:71]
  v_mfma_f32_16x16x32_bf16 v[12:15], v[116:119], v[96:99], v[12:15]
  ds_read_b128 v[100:103], v61 offset:24576
  ds_read_b64_tr_b16 v[96:97], v64 offset:16640
  ds_read_b64_tr_b16 v[98:99], v64 offset:16800
  s_waitcnt lgkmcnt(12)
  v_mfma_f32_16x16x32_bf16 v[68:71], v[108:111], v[104:107], v[68:71]
  v_mfma_f32_16x16x32_bf16 v[12:15], v[116:119], v[104:107], v[12:15]
  ds_read_b128 v[108:111], v62 offset:24576
  ds_read_b64_tr_b16 v[104:105], v64 offset:17920
  ds_read_b64_tr_b16 v[106:107], v64 offset:18080
  s_waitcnt lgkmcnt(12)
  v_mfma_f32_16x16x32_bf16 v[68:71], v[76:79], v[72:75], v[68:71]
  v_mfma_f32_16x16x32_bf16 v[12:15], v[116:119], v[72:75], v[12:15]
  ds_read_b128 v[76:79], v63 offset:24576
  ds_read_b64_tr_b16 v[72:73], v64 offset:19200
  ds_read_b64_tr_b16 v[74:75], v64 offset:19360
  s_waitcnt lgkmcnt(12)
  v_mfma_f32_16x16x32_bf16 v[68:71], v[84:87], v[80:83], v[68:71]
  v_mfma_f32_16x16x32_bf16 v[12:15], v[116:119], v[80:83], v[12:15]
  ds_read_b128 v[84:87], v60 offset:32768
  ds_read_b64_tr_b16 v[80:81], v64 offset:20480
  ds_read_b64_tr_b16 v[82:83], v64 offset:20640
  s_waitcnt lgkmcnt(12)
  v_mfma_f32_16x16x32_bf16 v[68:71], v[92:95], v[88:91], v[68:71]
  v_mfma_f32_16x16x32_bf16 v[12:15], v[116:119], v[88:91], v[12:15]
  ds_read_b128 v[92:95], v61 offset:32768
  ds_read_b64_tr_b16 v[88:89], v64 offset:21760
  ds_read_b64_tr_b16 v[90:91], v64 offset:21920
  s_waitcnt lgkmcnt(12)
  v_mfma_f32_16x16x32_bf16 v[68:71], v[100:103], v[96:99], v[68:71]
  v_mfma_f32_16x16x32_bf16 v[12:15], v[116:119], v[96:99], v[12:15]
  ds_read_b128 v[100:103], v62 offset:32768
  ds_read_b64_tr_b16 v[96:97], v64 offset:23040
  ds_read_b64_tr_b16 v[98:99], v64 offset:23200
  s_waitcnt lgkmcnt(12)
  v_mfma_f32_16x16x32_bf16 v[68:71], v[108:111], v[104:107], v[68:71]
  v_mfma_f32_16x16x32_bf16 v[12:15], v[116:119], v[104:107], v[12:15]
  ds_read_b128 v[108:111], v63 offset:32768
  ds_read_b64_tr_b16 v[104:105], v64 offset:24320
  ds_read_b64_tr_b16 v[106:107], v64 offset:24480
  s_waitcnt lgkmcnt(12)
  v_mfma_f32_16x16x32_bf16 v[68:71], v[76:79], v[72:75], v[68:71]
  v_mfma_f32_16x16x32_bf16 v[12:15], v[116:119], v[72:75], v[12:15]
  s_waitcnt lgkmcnt(9)
  v_mfma_f32_16x16x32_bf16 v[68:71], v[84:87], v[80:83], v[68:71]
  v_mfma_f32_16x16x32_bf16 v[12:15], v[116:119], v[80:83], v[12:15]
  s_waitcnt lgkmcnt(6)
  v_mfma_f32_16x16x32_bf16 v[68:71], v[92:95], v[88:91], v[68:71]
  v_mfma_f32_16x16x32_bf16 v[12:15], v[116:119], v[88:91], v[12:15]
  s_waitcnt lgkmcnt(3)
  v_mfma_f32_16x16x32_bf16 v[68:71], v[100:103], v[96:99], v[68:71]
  v_mfma_f32_16x16x32_bf16 v[12:15], v[116:119], v[96:99], v[12:15]
  s_waitcnt lgkmcnt(0)
  v_mfma_f32_16x16x32_bf16 v[68:71], v[108:111], v[104:107], v[68:71]
  v_mfma_f32_16x16x32_bf16 v[12:15], v[116:119], v[104:107], v[12:15]
  s_barrier
  v_mov_b32 v9, 163200
  ds_read_b32 v9, v9
  ds_read_b128 v[72:75], v66
  ds_read_b128 v[76:79], v66 offset:16
  v_cmp_eq_u32 vcc, 4, v6
  s_nop 1
  v_cndmask_b32 v80, 0, v116, vcc
  v_cmp_gt_u32 vcc, 4, v6
  s_waitcnt lgkmcnt(0)
  v_mul_f32 v73, v73, v12
  v_mul_f32 v75, v75, v12
  v_mul_f32 v77, v77, v12
  v_mul_f32 v79, v79, v12
  v_fma_f32 v68, v72, v68, -v73
  v_fma_f32 v69, v74, v69, -v75
  v_fma_f32 v70, v76, v70, -v77
  v_fma_f32 v71, v78, v71, -v79
  v_cvt_pk_bf16_f32 v72, v68, v69
  v_cvt_pk_bf16_f32 v73, v70, v71
  s_cmp_eq_u32 s6, 6
  s_nop 0
  s_cbranch_scc1 L_kvst_a
  v_cndmask_b32 v72, v80, v72, vcc
  v_cndmask_b32 v73, v80, v73, vcc
  s_nop 1
L_kvst_a:
  global_store_dwordx2 v65, v[72:73], s[68:69] sc1
  s_mov_b64 exec, -1
  v_readfirstlane_b32 s7, v9
  s_barrier
  v_bfe_u32 v9, v1, 2, 2
  v_lshlrev_b32 v9, 1, v9
  v_lshl_add_u32 v9, v7, 3, v9
  v_mul_u32_u24 v9, 160, v9
  v_and_b32 v10, 3, v1
  v_lshl_add_u32 v9, v10, 3, v9
  s_cmp_eq_u32 s6, 6
  s_cselect_b32 s20, 0, 96
  s_cselect_b32 s21, 64, 0x80
  v_add_u32 v100, s20, v9
  v_add_u32 v101, 40960, v100
  v_add_u32 v102, s21, v9
  v_add_u32 v103, 40960, v102
  ds_read_b64_tr_b16 v[140:141], v100 offset:30720
  ds_read_b64_tr_b16 v[142:143], v100 offset:30880
  ds_read_b64_tr_b16 v[144:145], v100 offset:30752
  ds_read_b64_tr_b16 v[146:147], v100 offset:30912
  ds_read_b64_tr_b16 v[148:149], v102 offset:30720
  ds_read_b64_tr_b16 v[150:151], v102 offset:30880
  ds_read_b64_tr_b16 v[152:153], v100 offset:35840
  ds_read_b64_tr_b16 v[154:155], v100 offset:36000
  ds_read_b64_tr_b16 v[156:157], v100 offset:35872
  ds_read_b64_tr_b16 v[158:159], v100 offset:36032
  ds_read_b64_tr_b16 v[160:161], v102 offset:35840
  ds_read_b64_tr_b16 v[162:163], v102 offset:36000
  ds_read_b64_tr_b16 v[164:165], v101 offset:0
  ds_read_b64_tr_b16 v[166:167], v101 offset:160
  ds_read_b64_tr_b16 v[168:169], v101 offset:32
  ds_read_b64_tr_b16 v[170:171], v101 offset:192
  ds_read_b64_tr_b16 v[172:173], v103 offset:0
  ds_read_b64_tr_b16 v[174:175], v103 offset:160
  s_waitcnt lgkmcnt(12)
  v_mfma_f32_16x16x32_bf16 v[124:127], v[140:143], v[116:119], 0
  v_mfma_f32_16x16x32_bf16 v[128:131], v[144:147], v[116:119], 0
  v_mfma_f32_16x16x32_bf16 v[132:135], v[148:151], v[116:119], 0
  ds_read_b64_tr_b16 v[140:141], v101 offset:5120
  ds_read_b64_tr_b16 v[142:143], v101 offset:5280
  ds_read_b64_tr_b16 v[144:145], v101 offset:5152
  ds_read_b64_tr_b16 v[146:147], v101 offset:5312
  ds_read_b64_tr_b16 v[148:149], v103 offset:5120
  ds_read_b64_tr_b16 v[150:151], v103 offset:5280
  s_waitcnt lgkmcnt(12)
  v_mfma_f32_16x16x32_bf16 v[124:127], v[152:155], v[116:119], v[124:127]
  v_mfma_f32_16x16x32_bf16 v[128:131], v[156:159], v[116:119], v[128:131]
  v_mfma_f32_16x16x32_bf16 v[132:135], v[160:163], v[116:119], v[132:135]
  s_waitcnt lgkmcnt(6)
  v_mfma_f32_16x16x32_bf16 v[124:127], v[164:167], v[116:119], v[124:127]
  v_mfma_f32_16x16x32_bf16 v[128:131], v[168:171], v[116:119], v[128:131]
  v_mfma_f32_16x16x32_bf16 v[132:135], v[172:175], v[116:119], v[132:135]
  s_waitcnt lgkmcnt(0)
  v_mfma_f32_16x16x32_bf16 v[124:127], v[140:143], v[116:119], v[124:127]
  v_mfma_f32_16x16x32_bf16 v[128:131], v[144:147], v[116:119], v[128:131]
  v_mfma_f32_16x16x32_bf16 v[132:135], v[148:151], v[116:119], v[132:135]
  s_waitcnt vmcnt(0)
  v_mov_b32 v11, s7
  s_mov_b64 exec, 1
  global_store_dword v114, v11, s[60:61] sc1
  s_mov_b64 exec, -1
  ds_read_b64_tr_b16 v[140:141], v101 offset:10240
  ds_read_b64_tr_b16 v[142:143], v101 offset:10400
  ds_read_b64_tr_b16 v[144:145], v101 offset:10272
  ds_read_b64_tr_b16 v[146:147], v101 offset:10432
  ds_read_b64_tr_b16 v[148:149], v103 offset:10240
  ds_read_b64_tr_b16 v[150:151], v103 offset:10400
  ds_read_b64_tr_b16 v[152:153], v101 offset:15360
  ds_read_b64_tr_b16 v[154:155], v101 offset:15520
  ds_read_b64_tr_b16 v[156:157], v101 offset:15392
  ds_read_b64_tr_b16 v[158:159], v101 offset:15552
  ds_read_b64_tr_b16 v[160:161], v103 offset:15360
  ds_read_b64_tr_b16 v[162:163], v103 offset:15520
  s_waitcnt lgkmcnt(6)
  v_mfma_f32_16x16x32_bf16 v[124:127], v[140:143], v[116:119], v[124:127]
  v_mfma_f32_16x16x32_bf16 v[128:131], v[144:147], v[116:119], v[128:131]
  v_mfma_f32_16x16x32_bf16 v[132:135], v[148:151], v[116:119], v[132:135]
  s_waitcnt lgkmcnt(0)
  v_mfma_f32_16x16x32_bf16 v[124:127], v[152:155], v[116:119], v[124:127]
  v_mfma_f32_16x16x32_bf16 v[128:131], v[156:159], v[116:119], v[128:131]
  v_mfma_f32_16x16x32_bf16 v[132:135], v[160:163], v[116:119], v[132:135]
  s_barrier
  ds_read_b64_tr_b16 v[140:141], v101 offset:20480
  ds_read_b64_tr_b16 v[142:143], v101 offset:20640
  ds_read_b64_tr_b16 v[144:145], v101 offset:20512
  ds_read_b64_tr_b16 v[146:147], v101 offset:20672
  ds_read_b64_tr_b16 v[148:149], v103 offset:20480
  ds_read_b64_tr_b16 v[150:151], v103 offset:20640
  ds_read_b64_tr_b16 v[152:153], v101 offset:25600
  ds_read_b64_tr_b16 v[154:155], v101 offset:25760
  ds_read_b64_tr_b16 v[156:157], v101 offset:25632
  ds_read_b64_tr_b16 v[158:159], v101 offset:25792
  ds_read_b64_tr_b16 v[160:161], v103 offset:25600
  ds_read_b64_tr_b16 v[162:163], v103 offset:25760
  s_waitcnt lgkmcnt(6)
  v_mfma_f32_16x16x32_bf16 v[124:127], v[140:143], v[116:119], v[124:127]
  v_mfma_f32_16x16x32_bf16 v[128:131], v[144:147], v[116:119], v[128:131]
  v_mfma_f32_16x16x32_bf16 v[132:135], v[148:151], v[116:119], v[132:135]
  s_waitcnt lgkmcnt(0)
  v_mfma_f32_16x16x32_bf16 v[124:127], v[152:155], v[116:119], v[124:127]
  v_mfma_f32_16x16x32_bf16 v[128:131], v[156:159], v[116:119], v[128:131]
  v_mfma_f32_16x16x32_bf16 v[132:135], v[160:163], v[116:119], v[132:135]
  s_barrier
  ds_read_b64_tr_b16 v[140:141], v100 offset:0
  ds_read_b64_tr_b16 v[142:143], v100 offset:160
  ds_read_b64_tr_b16 v[144:145], v100 offset:32
  ds_read_b64_tr_b16 v[146:147], v100 offset:192
  ds_read_b64_tr_b16 v[148:149], v102 offset:0
  ds_read_b64_tr_b16 v[150:151], v102 offset:160
  ds_read_b64_tr_b16 v[152:153], v100 offset:5120
  ds_read_b64_tr_b16 v[154:155], v100 offset:5280
  ds_read_b64_tr_b16 v[156:157], v100 offset:5152
  ds_read_b64_tr_b16 v[158:159], v100 offset:5312
  ds_read_b64_tr_b16 v[160:161], v102 offset:5120
  ds_read_b64_tr_b16 v[162:163], v102 offset:5280
  ds_read_b64_tr_b16 v[164:165], v100 offset:10240
  ds_read_b64_tr_b16 v[166:167], v100 offset:10400
  ds_read_b64_tr_b16 v[168:169], v100 offset:10272
  ds_read_b64_tr_b16 v[170:171], v100 offset:10432
  ds_read_b64_tr_b16 v[172:173], v102 offset:10240
  ds_read_b64_tr_b16 v[174:175], v102 offset:10400
  s_waitcnt lgkmcnt(12)
  v_mfma_f32_16x16x32_bf16 v[124:127], v[140:143], v[116:119], v[124:127]
  v_mfma_f32_16x16x32_bf16 v[128:131], v[144:147], v[116:119], v[128:131]
  v_mfma_f32_16x16x32_bf16 v[132:135], v[148:151], v[116:119], v[132:135]
  ds_read_b64_tr_b16 v[140:141], v100 offset:15360
  ds_read_b64_tr_b16 v[142:143], v100 offset:15520
  ds_read_b64_tr_b16 v[144:145], v100 offset:15392
  ds_read_b64_tr_b16 v[146:147], v100 offset:15552
  ds_read_b64_tr_b16 v[148:149], v102 offset:15360
  ds_read_b64_tr_b16 v[150:151], v102 offset:15520
  s_waitcnt lgkmcnt(12)
  v_mfma_f32_16x16x32_bf16 v[124:127], v[152:155], v[116:119], v[124:127]
  v_mfma_f32_16x16x32_bf16 v[128:131], v[156:159], v[116:119], v[128:131]
  v_mfma_f32_16x16x32_bf16 v[132:135], v[160:163], v[116:119], v[132:135]
  ds_read_b64_tr_b16 v[152:153], v100 offset:20480
  ds_read_b64_tr_b16 v[154:155], v100 offset:20640
  ds_read_b64_tr_b16 v[156:157], v100 offset:20512
  ds_read_b64_tr_b16 v[158:159], v100 offset:20672
  ds_read_b64_tr_b16 v[160:161], v102 offset:20480
  ds_read_b64_tr_b16 v[162:163], v102 offset:20640
  s_waitcnt lgkmcnt(12)
  v_mfma_f32_16x16x32_bf16 v[124:127], v[164:167], v[116:119], v[124:127]
  v_mfma_f32_16x16x32_bf16 v[128:131], v[168:171], v[116:119], v[128:131]
  v_mfma_f32_16x16x32_bf16 v[132:135], v[172:175], v[116:119], v[132:135]
  ds_read_b64_tr_b16 v[164:165], v100 offset:25600
  ds_read_b64_tr_b16 v[166:167], v100 offset:25760
  ds_read_b64_tr_b16 v[168:169], v100 offset:25632
  ds_read_b64_tr_b16 v[170:171], v100 offset:25792
  ds_read_b64_tr_b16 v[172:173], v102 offset:25600
  ds_read_b64_tr_b16 v[174:175], v102 offset:25760
  s_waitcnt lgkmcnt(12)
  v_mfma_f32_16x16x32_bf16 v[124:127], v[140:143], v[116:119], v[124:127]
  v_mfma_f32_16x16x32_bf16 v[128:131], v[144:147], v[116:119], v[128:131]
  v_mfma_f32_16x16x32_bf16 v[132:135], v[148:151], v[116:119], v[132:135]
  s_waitcnt lgkmcnt(6)
  v_mfma_f32_16x16x32_bf16 v[124:127], v[152:155], v[116:119], v[124:127]
  v_mfma_f32_16x16x32_bf16 v[128:131], v[156:159], v[116:119], v[128:131]
  v_mfma_f32_16x16x32_bf16 v[132:135], v[160:163], v[116:119], v[132:135]
  s_waitcnt lgkmcnt(0)
  v_mfma_f32_16x16x32_bf16 v[124:127], v[164:167], v[116:119], v[124:127]
  v_mfma_f32_16x16x32_bf16 v[128:131], v[168:171], v[116:119], v[128:131]
  v_mfma_f32_16x16x32_bf16 v[132:135], v[172:175], v[116:119], v[132:135]
  s_barrier
  s_and_b32 s22, s6, 3
  s_mul_i32 s20, s22, 7168
  s_add_u32 s62, s60, s20
  s_addc_u32 s63, s61, 0
  s_lshl_b32 s20, s22, 10
  s_add_u32 s20, s20, 524288
  v_lshrrev_b32 v248, 3, v1
  v_lshlrev_b32 v248, 12, v248
  v_and_b32 v249, 7, v1
  v_lshl_add_u32 v248, v249, 7, v248
  v_add_u32 v248, s20, v248
  s_mov_b32 s34, 0x01010101
  s_mov_b32 s35, 0x01010101
  v_mov_b32 v249, s7
  s_mov_b32 s10, 0
  s_mov_b64 s[100:101], 0
  global_load_dwordx2 v[240:241], v248, s[60:61] sc1
  ds_read_b64_tr_b16 v[140:141], v100 offset:30720
  ds_read_b64_tr_b16 v[142:143], v100 offset:30880
  ds_read_b64_tr_b16 v[144:145], v100 offset:30752
  ds_read_b64_tr_b16 v[146:147], v100 offset:30912
  ds_read_b64_tr_b16 v[148:149], v102 offset:30720
  ds_read_b64_tr_b16 v[150:151], v102 offset:30880
  ds_read_b64_tr_b16 v[152:153], v100 offset:35840
  ds_read_b64_tr_b16 v[154:155], v100 offset:36000
  ds_read_b64_tr_b16 v[156:157], v100 offset:35872
  ds_read_b64_tr_b16 v[158:159], v100 offset:36032
  ds_read_b64_tr_b16 v[160:161], v102 offset:35840
  ds_read_b64_tr_b16 v[162:163], v102 offset:36000
  ds_read_b64_tr_b16 v[164:165], v101 offset:0
  ds_read_b64_tr_b16 v[166:167], v101 offset:160
  ds_read_b64_tr_b16 v[168:169], v101 offset:32
  ds_read_b64_tr_b16 v[170:171], v101 offset:192
  ds_read_b64_tr_b16 v[172:173], v103 offset:0
  ds_read_b64_tr_b16 v[174:175], v103 offset:160
  s_waitcnt lgkmcnt(12)
  v_mfma_f32_16x16x32_bf16 v[124:127], v[140:143], v[116:119], v[124:127]
  v_mfma_f32_16x16x32_bf16 v[128:131], v[144:147], v[116:119], v[128:131]
  v_mfma_f32_16x16x32_bf16 v[132:135], v[148:151], v[116:119], v[132:135]
  ds_read_b64_tr_b16 v[140:141], v101 offset:5120
  ds_read_b64_tr_b16 v[142:143], v101 offset:5280
  ds_read_b64_tr_b16 v[144:145], v101 offset:5152
  ds_read_b64_tr_b16 v[146:147], v101 offset:5312
  ds_read_b64_tr_b16 v[148:149], v103 offset:5120
  ds_read_b64_tr_b16 v[150:151], v103 offset:5280
  s_waitcnt lgkmcnt(12)
  v_mfma_f32_16x16x32_bf16 v[124:127], v[152:155], v[116:119], v[124:127]
  v_mfma_f32_16x16x32_bf16 v[128:131], v[156:159], v[116:119], v[128:131]
  v_mfma_f32_16x16x32_bf16 v[132:135], v[160:163], v[116:119], v[132:135]
  ds_read_b64_tr_b16 v[152:153], v101 offset:10240
  ds_read_b64_tr_b16 v[154:155], v101 offset:10400
  ds_read_b64_tr_b16 v[156:157], v101 offset:10272
  ds_read_b64_tr_b16 v[158:159], v101 offset:10432
  ds_read_b64_tr_b16 v[160:161], v103 offset:10240
  ds_read_b64_tr_b16 v[162:163], v103 offset:10400
  s_waitcnt lgkmcnt(12)
  v_mfma_f32_16x16x32_bf16 v[124:127], v[164:167], v[116:119], v[124:127]
  v_mfma_f32_16x16x32_bf16 v[128:131], v[168:171], v[116:119], v[128:131]
  v_mfma_f32_16x16x32_bf16 v[132:135], v[172:175], v[116:119], v[132:135]
  ds_read_b64_tr_b16 v[164:165], v101 offset:15360
  ds_read_b64_tr_b16 v[166:167], v101 offset:15520
  ds_read_b64_tr_b16 v[168:169], v101 offset:15392
  ds_read_b64_tr_b16 v[170:171], v101 offset:15552
  ds_read_b64_tr_b16 v[172:173], v103 offset:15360
  ds_read_b64_tr_b16 v[174:175], v103 offset:15520
  s_waitcnt lgkmcnt(12)
  v_mfma_f32_16x16x32_bf16 v[124:127], v[140:143], v[116:119], v[124:127]
  v_mfma_f32_16x16x32_bf16 v[128:131], v[144:147], v[116:119], v[128:131]
  v_mfma_f32_16x16x32_bf16 v[132:135], v[148:151], v[116:119], v[132:135]
  s_waitcnt lgkmcnt(6)
  v_mfma_f32_16x16x32_bf16 v[124:127], v[152:155], v[116:119], v[124:127]
  v_mfma_f32_16x16x32_bf16 v[128:131], v[156:159], v[116:119], v[128:131]
  v_mfma_f32_16x16x32_bf16 v[132:135], v[160:163], v[116:119], v[132:135]
  s_waitcnt lgkmcnt(0)
  v_mfma_f32_16x16x32_bf16 v[124:127], v[164:167], v[116:119], v[124:127]
  v_mfma_f32_16x16x32_bf16 v[128:131], v[168:171], v[116:119], v[128:131]
  v_mfma_f32_16x16x32_bf16 v[132:135], v[172:175], v[116:119], v[132:135]
  s_cmp_eq_u32 s6, 6
  s_cselect_b32 s20, 0, 192
  s_cselect_b32 s21, 0, 128
  s_add_u32 s20, s20, 162816
  s_add_u32 s21, s21, 162944
  v_lshl_add_u32 v9, v7, 4, s20
  v_lshl_add_u32 v10, v7, 4, s21
  ds_write_b128 v9, v[124:127]
  ds_write_b128 v9, v[128:131] offset:64
  ds_write_b128 v10, v[132:135]
  s_waitcnt lgkmcnt(0)
  s_barrier
  s_mov_b32 s10, 0
  s_waitcnt vmcnt(0)
  v_cmp_eq_u32 vcc, v249, v240
  v_cmp_eq_u32 s[24:25], v249, v241
  s_nop 0
  s_and_b64 s[24:25], s[24:25], vcc
  s_lshr_b64 s[26:27], s[24:25], 4
  s_and_b64 s[24:25], s[24:25], s[26:27]
  s_lshr_b64 s[26:27], s[24:25], 2
  s_and_b64 s[24:25], s[24:25], s[26:27]
  s_lshr_b64 s[26:27], s[24:25], 1
  s_and_b64 s[24:25], s[24:25], s[26:27]
  s_mov_b64 s[100:101], s[24:25]
  s_and_b64 s[24:25], s[24:25], s[34:35]
  s_cbranch_scc0 L_try_7
  s_ff1_i32_b64 s20, s[24:25]
  s_bitset0_b64 s[34:35], s20
  s_mul_i32 s20, s20, 3584
  s_add_u32 s66, s62, s20
  s_addc_u32 s67, s63, 0
  global_load_dwordx4 v[212:215], v0, s[66:67] sc1
  global_load_dwordx2 v[216:217], v5, s[66:67] sc1
  global_load_dwordx4 v[218:221], v4, s[66:67] offset:1536 sc1
  global_load_dwordx4 v[222:225], v4, s[66:67] offset:2560 sc1
  s_mov_b32 s10, 1
L_try_7:
  s_cmp_eq_u32 s10, 0
  s_cbranch_scc0 L_must_8
  global_load_dwordx2 v[240:241], v248, s[60:61] sc1
  s_waitcnt vmcnt(0)
  s_and_b64 s[24:25], s[100:101], s[34:35]
  s_cmp_eq_u64 s[24:25], s[34:35]
  s_cbranch_scc1 SK_nbp_9
  v_cmp_eq_u32 vcc, v249, v240
  v_cmp_eq_u32 s[24:25], v249, v241
  s_nop 0
  s_and_b64 s[24:25], s[24:25], vcc
  s_lshr_b64 s[26:27], s[24:25], 4
  s_and_b64 s[24:25], s[24:25], s[26:27]
  s_lshr_b64 s[26:27], s[24:25], 2
  s_and_b64 s[24:25], s[24:25], s[26:27]
  s_lshr_b64 s[26:27], s[24:25], 1
  s_and_b64 s[24:25], s[24:25], s[26:27]
  s_mov_b64 s[100:101], s[24:25]
  s_and_b64 s[24:25], s[24:25], s[34:35]
  s_cbranch_scc1 SK_nbp_9
  s_mov_b32 s20, 0
L_nbpp_9:
  global_load_dwordx2 v[240:241], v248, s[60:61] sc1
  s_waitcnt vmcnt(0)
  v_cmp_eq_u32 vcc, v249, v240
  v_cmp_eq_u32 s[24:25], v249, v241
  s_nop 0
  s_and_b64 s[24:25], s[24:25], vcc
  s_lshr_b64 s[26:27], s[24:25], 4
  s_and_b64 s[24:25], s[24:25], s[26:27]
  s_lshr_b64 s[26:27], s[24:25], 2
  s_and_b64 s[24:25], s[24:25], s[26:27]
  s_lshr_b64 s[26:27], s[24:25], 1
  s_and_b64 s[24:25], s[24:25], s[26:27]
  s_mov_b64 s[100:101], s[24:25]
  s_and_b64 s[24:25], s[24:25], s[34:35]
  s_cbranch_scc1 SK_nbp_9
  s_add_u32 s20, s20, 1
  s_cmp_lt_u32 s20, s9
  s_cbranch_scc1 L_nbpp_9
  s_mov_b32 s9, 0
  s_mov_b64 s[24:25], s[34:35]
SK_nbp_9:
  s_ff1_i32_b64 s20, s[24:25]
  s_bitset0_b64 s[34:35], s20
  s_mul_i32 s20, s20, 3584
  s_add_u32 s66, s62, s20
  s_addc_u32 s67, s63, 0
  global_load_dwordx4 v[212:215], v0, s[66:67] sc1
  global_load_dwordx2 v[216:217], v5, s[66:67] sc1
  global_load_dwordx4 v[218:221], v4, s[66:67] offset:1536 sc1
  global_load_dwordx4 v[222:225], v4, s[66:67] offset:2560 sc1
L_must_8:
L_q_done_a:
  s_waitcnt lgkmcnt(0)
  s_barrier
L_ATT:
  s_mov_b32 s11, 0
  s_lshr_b32 s20, s6, 2
  s_mul_i32 s20, s20, 6144
  s_add_u32 s20, s20, 141312
  v_add_u32 v6, s20, v0
  v_add_u32 v7, s20, v2
  ds_read_b128 v[60:63], v6 offset:0
  ds_read_b64 v[64:65], v7 offset:0
  ds_read_b128 v[66:69], v6 offset:1536
  ds_read_b64 v[70:71], v7 offset:1536
  ds_read_b128 v[72:75], v6 offset:3072
  ds_read_b64 v[76:77], v7 offset:3072
  ds_read_b128 v[78:81], v6 offset:4608
  ds_read_b64 v[82:83], v7 offset:4608
L_ATT_RUN:
  v_mov_b32 v244, 0
  v_mov_b32 v245, 0
  v_mov_b32 v246, 0
  v_mov_b32 v247, 0
  s_nop 1
  v_mfma_f32_32x32x16_bf16 v[84:99], v[244:247], v[244:247], 0
  v_mfma_f32_32x32x16_bf16 v[100:115], v[244:247], v[244:247], 0
  v_mfma_f32_32x32x16_bf16 v[116:131], v[244:247], v[244:247], 0
  v_mfma_f32_32x32x16_bf16 v[132:147], v[244:247], v[244:247], 0
  s_waitcnt vmcnt(0) lgkmcnt(0)
  s_cmp_eq_u32 s14, 2
  s_nop 9
  s_cbranch_scc0 L_nopend
  s_mov_b32 s14, 0
  s_add_u32 s20, s7, 2
  v_mov_b32 v11, s20
  s_mov_b64 exec, 1
  global_store_dword v10, v11, s[60:61] sc1
  s_mov_b64 exec, -1
L_nopend:
  v_mfma_f32_32x32x16_bf16 v[148:163], v[212:215], v[60:63], 0
  v_mfma_f32_32x32x8_bf16 v[148:163], v[216:217], v[64:65], v[148:163]
  .p2align 3
  s_cmp_ge_u32 s6, 4
  s_cbranch_scc0 SK_pr0
  s_setprio 1
SK_pr0:
  v_mfma_f32_32x32x16_bf16 v[164:179], v[212:215], v[66:69], 0
  s_nop 8
  v_exp_f32 v148, v148
  v_exp_f32 v149, v149
  v_exp_f32 v150, v150
  v_exp_f32 v151, v151
  v_mfma_f32_32x32x8_bf16 v[164:179], v[216:217], v[70:71], v[164:179]
  v_exp_f32 v152, v152
  v_exp_f32 v153, v153
  v_exp_f32 v154, v154
  v_exp_f32 v155, v155
  s_mul_i32 s20, s6, 80
  v_add_u32 v8, s20, v1
  v_mul_u32_u24 v8, 3456, v8
  s_mul_i32 s20, s6, 216
  v_lshrrev_b32 v9, 1, v1
  v_add_u32 v9, s20, v9
  v_mul_u32_u24 v9, 1280, v9
  v_and_b32 v10, 1, v1
  v_lshl_add_u32 v9, v10, 4, v9
  s_mul_i32 s21, s8, 8192
  s_add_u32 s21, s21, 327680
  s_mul_i32 s22, s8, 32768
  s_add_u32 s22, s22, 589824
  s_mul_i32 s23, s8, 4096
  s_add_u32 s23, s23, 655360
  s_mul_i32 s24, s8, 16384
  s_add_u32 s24, s24, 671744
  s_mul_i32 s20, s4, 0x54400
  s_add_u32 s21, s21, s20
  s_lshl_b32 s20, s5, 10
  s_add_u32 s21, s21, s20
  s_add_u32 s21, s21, 1048576
  v_and_b32 v10, 7, v1
  v_lshlrev_b32 v10, 7, v10
  v_add_u32 v10, s21, v10
  s_lshl_b32 s20, s3, 7
  s_add_u32 s22, s22, s20
  v_writelane_b32 v10, s22, 8
  s_add_u32 s22, s20, 557056
  v_writelane_b32 v10, s22, 12
  s_lshl_b32 s20, s4, 7
  s_add_u32 s23, s23, s20
  v_writelane_b32 v10, s23, 9
  s_min_u32 s20, s74, 215
  s_lshl_b32 s20, s20, 6
  s_add_u32 s24, s24, s20
  v_writelane_b32 v10, s24, 10
  s_min_u32 s20, s75, 39
  s_lshl_b32 s20, s20, 7
  s_add_u32 s20, s20, 704512
  v_writelane_b32 v10, s20, 11
  s_and_b32 s20, s4, 3
  s_mul_i32 s20, s20, 48
  s_mul_i32 s21, s6, 6
  s_add_u32 s20, s20, s21
  s_add_u32 s20, s20, 448
  v_lshrrev_b32 v11, 1, v1
  v_min_u32 v11, 5, v11
  v_add_u32 v11, s20, v11
  v_mul_u32_u24 v11, 1280, v11
  v_and_b32 v6, 1, v1
  v_mul_u32_u24 v6, 144, v6
  v_add_u32 v11, v11, v6
  s_lshr_b32 s30, s6, 1
  s_and_b32 s31, s6, 1
  s_add_u32 s32, s6, 8
  s_min_u32 s32, s32, 13
  s_and_b32 s33, s32, 1
  s_lshr_b32 s32, s32, 1
  s_and_b64 s[24:25], s[100:101], s[34:35]
  s_cmp_eq_u64 s[24:25], s[34:35]
  s_cbranch_scc1 SK_kl0
  global_load_dwordx2 v[240:241], v248, s[60:61] sc1
SK_kl0:
  s_add_u32 s66, s66, 3584
  s_addc_u32 s67, s67, 0
  global_load_dwordx4 v[226:229], v0, s[66:67] sc1
  global_load_dwordx2 v[230:231], v5, s[66:67] sc1
  global_load_dwordx4 v[232:235], v4, s[66:67] offset:1536 sc1
  global_load_dwordx4 v[236:239], v4, s[66:67] offset:2560 sc1
  s_mul_i32 s21, s31, 40960
  s_mul_i32 s22, s30, 81920
  s_add_u32 s21, s21, s22
  s_add_u32 s68, s44, s21
  s_addc_u32 s69, s45, 0
  s_mul_i32 s77, s31, 5120
  s_mul_i32 s22, s30, 10240
  s_add_u32 s77, s77, s22
  s_mov_b32 m0, s77
  s_nop 0
  global_load_lds_dwordx4 v250, s[68:69] offset:0
  v_exp_f32 v156, v156
  v_exp_f32 v157, v157
  v_exp_f32 v158, v158
  v_exp_f32 v159, v159
  v_smfmac_f32_32x32x32_bf16 v[84:99], v[218:221], v[148:155], v3
  v_exp_f32 v160, v160
  v_exp_f32 v161, v161
  v_exp_f32 v162, v162
  v_exp_f32 v163, v163
  v_mfma_f32_32x32x16_bf16 v[180:195], v[212:215], v[72:75], 0
  v_exp_f32 v164, v164
  v_exp_f32 v165, v165
  v_exp_f32 v166, v166
  v_exp_f32 v167, v167
  v_mfma_f32_32x32x8_bf16 v[180:195], v[216:217], v[76:77], v[180:195]
  v_exp_f32 v168, v168
  v_exp_f32 v169, v169
  v_exp_f32 v170, v170
  v_exp_f32 v171, v171
  v_smfmac_f32_32x32x32_bf16 v[84:99], v[222:225], v[156:163], v3
  s_mov_b32 m0, s77
  s_nop 0
  global_load_lds_dwordx4 v251, s[68:69] offset:1024
  v_exp_f32 v172, v172
  v_exp_f32 v173, v173
  v_exp_f32 v174, v174
  v_exp_f32 v175, v175
  v_smfmac_f32_32x32x32_bf16 v[100:115], v[218:221], v[164:171], v3
  v_exp_f32 v176, v176
  v_exp_f32 v177, v177
  v_exp_f32 v178, v178
  v_exp_f32 v179, v179
  v_mfma_f32_32x32x16_bf16 v[196:211], v[212:215], v[78:81], 0
  v_exp_f32 v180, v180
  v_exp_f32 v181, v181
  v_exp_f32 v182, v182
  v_exp_f32 v183, v183
  v_mfma_f32_32x32x8_bf16 v[196:211], v[216:217], v[82:83], v[196:211]
  v_exp_f32 v184, v184
  v_exp_f32 v185, v185
  v_exp_f32 v186, v186
  v_exp_f32 v187, v187
  v_smfmac_f32_32x32x32_bf16 v[100:115], v[222:225], v[172:179], v3
  v_exp_f32 v188, v188
  v_exp_f32 v189, v189
  v_exp_f32 v190, v190
  v_exp_f32 v191, v191
  v_smfmac_f32_32x32x32_bf16 v[116:131], v[218:221], v[180:187], v3
  v_exp_f32 v192, v192
  v_exp_f32 v193, v193
  v_exp_f32 v194, v194
  v_exp_f32 v195, v195
  s_waitcnt vmcnt(2)
  v_mfma_f32_32x32x16_bf16 v[148:163], v[226:229], v[60:63], 0
  v_exp_f32 v196, v196
  v_exp_f32 v197, v197
  v_exp_f32 v198, v198
  v_exp_f32 v199, v199
  v_mfma_f32_32x32x8_bf16 v[148:163], v[230:231], v[64:65], v[148:163]
  v_exp_f32 v200, v200
  v_exp_f32 v201, v201
  v_exp_f32 v202, v202
  v_exp_f32 v203, v203
  v_smfmac_f32_32x32x32_bf16 v[116:131], v[222:225], v[188:195], v3
  v_exp_f32 v204, v204
  v_exp_f32 v205, v205
  v_exp_f32 v206, v206
  v_exp_f32 v207, v207
  v_smfmac_f32_32x32x32_bf16 v[132:147], v[218:221], v[196:203], v3
  v_exp_f32 v208, v208
  v_exp_f32 v209, v209
  v_exp_f32 v210, v210
  v_exp_f32 v211, v211
  v_mfma_f32_32x32x16_bf16 v[164:179], v[226:229], v[66:69], 0
  v_exp_f32 v148, v148
  v_exp_f32 v149, v149
  v_exp_f32 v150, v150
  v_exp_f32 v151, v151
  v_mfma_f32_32x32x8_bf16 v[164:179], v[230:231], v[70:71], v[164:179]
  v_exp_f32 v152, v152
  v_exp_f32 v153, v153
  v_exp_f32 v154, v154
  v_exp_f32 v155, v155
  v_smfmac_f32_32x32x32_bf16 v[132:147], v[222:225], v[204:211], v3
  s_and_b64 s[24:25], s[100:101], s[34:35]
  s_cmp_eq_u64 s[24:25], s[34:35]
  s_cbranch_scc1 SK_nb00
  v_cmp_eq_u32 vcc, v249, v240
  v_cmp_eq_u32 s[24:25], v249, v241
  s_nop 0
  s_and_b64 s[24:25], s[24:25], vcc
  s_lshr_b64 s[26:27], s[24:25], 4
  s_and_b64 s[24:25], s[24:25], s[26:27]
  s_lshr_b64 s[26:27], s[24:25], 2
  s_and_b64 s[24:25], s[24:25], s[26:27]
  s_lshr_b64 s[26:27], s[24:25], 1
  s_and_b64 s[24:25], s[24:25], s[26:27]
  s_mov_b64 s[100:101], s[24:25]
  s_and_b64 s[24:25], s[24:25], s[34:35]
  s_cbranch_scc1 SK_nb00
  s_mov_b32 s20, 0
L_nbp00:
  global_load_dwordx2 v[240:241], v248, s[60:61] sc1
  s_waitcnt vmcnt(0)
  v_cmp_eq_u32 vcc, v249, v240
  v_cmp_eq_u32 s[24:25], v249, v241
  s_nop 0
  s_and_b64 s[24:25], s[24:25], vcc
  s_lshr_b64 s[26:27], s[24:25], 4
  s_and_b64 s[24:25], s[24:25], s[26:27]
  s_lshr_b64 s[26:27], s[24:25], 2
  s_and_b64 s[24:25], s[24:25], s[26:27]
  s_lshr_b64 s[26:27], s[24:25], 1
  s_and_b64 s[24:25], s[24:25], s[26:27]
  s_mov_b64 s[100:101], s[24:25]
  s_and_b64 s[24:25], s[24:25], s[34:35]
  s_cbranch_scc1 SK_nb00
  s_add_u32 s20, s20, 1
  s_cmp_lt_u32 s20, s9
  s_cbranch_scc1 L_nbp00
  s_mov_b32 s9, 0
  s_mov_b64 s[24:25], s[34:35]
SK_nb00:
  s_ff1_i32_b64 s20, s[24:25]
  s_bitset0_b64 s[34:35], s20
  s_mul_i32 s20, s20, 3584
  s_add_u32 s66, s62, s20
  s_addc_u32 s67, s63, 0
  global_load_dwordx4 v[212:215], v0, s[66:67] sc1
  global_load_dwordx2 v[216:217], v5, s[66:67] sc1
  global_load_dwordx4 v[218:221], v4, s[66:67] offset:1536 sc1
  global_load_dwordx4 v[222:225], v4, s[66:67] offset:2560 sc1
  s_cmp_eq_u32 s8, 0
  s_cbranch_scc0 SK_l_10
  s_cmp_lt_u32 s75, 40
  s_cbranch_scc1 SK_fd00
  s_lshl_b32 s20, s74, 4
  s_add_u32 s64, s50, s20
  s_addc_u32 s65, s51, 0
  s_mul_i32 s20, s6, 1280
  s_add_u32 m0, s20, 71680
  s_nop 0
  global_load_lds_dwordx4 v8, s[64:65] offset:0
  s_branch SK_fe00
SK_fd00:
  s_lshl_b32 s20, s75, 5
  s_add_u32 s64, s54, s20
  s_addc_u32 s65, s55, 0
  s_mul_i32 s20, s6, 6912
  s_add_u32 m0, s20, 71680
  s_nop 0
  global_load_lds_dwordx4 v9, s[64:65]
SK_fe00:
SK_l_10:
  v_exp_f32 v156, v156
  v_exp_f32 v157, v157
  v_exp_f32 v158, v158
  v_exp_f32 v159, v159
  v_smfmac_f32_32x32x32_bf16 v[84:99], v[232:235], v[148:155], v3
  v_exp_f32 v160, v160
  v_exp_f32 v161, v161
  v_exp_f32 v162, v162
  v_exp_f32 v163, v163
  v_mfma_f32_32x32x16_bf16 v[180:195], v[226:229], v[72:75], 0
  v_exp_f32 v164, v164
  v_exp_f32 v165, v165
  v_exp_f32 v166, v166
  v_exp_f32 v167, v167
  v_mfma_f32_32x32x8_bf16 v[180:195], v[230:231], v[76:77], v[180:195]
  v_exp_f32 v168, v168
  v_exp_f32 v169, v169
  v_exp_f32 v170, v170
  v_exp_f32 v171, v171
  v_smfmac_f32_32x32x32_bf16 v[84:99], v[236:239], v[156:163], v3
  v_exp_f32 v172, v172
  v_exp_f32 v173, v173
  v_exp_f32 v174, v174
  v_exp_f32 v175, v175
  v_smfmac_f32_32x32x32_bf16 v[100:115], v[232:235], v[164:171], v3
  v_exp_f32 v176, v176
  v_exp_f32 v177, v177
  v_exp_f32 v178, v178
  v_exp_f32 v179, v179
  v_mfma_f32_32x32x16_bf16 v[196:211], v[226:229], v[78:81], 0
  v_exp_f32 v180, v180
  v_exp_f32 v181, v181
  v_exp_f32 v182, v182
  v_exp_f32 v183, v183
  v_mfma_f32_32x32x8_bf16 v[196:211], v[230:231], v[82:83], v[196:211]
  v_exp_f32 v184, v184
  v_exp_f32 v185, v185
  v_exp_f32 v186, v186
  v_exp_f32 v187, v187
  v_smfmac_f32_32x32x32_bf16 v[100:115], v[236:239], v[172:179], v3
  v_exp_f32 v188, v188
  v_exp_f32 v189, v189
  v_exp_f32 v190, v190
  v_exp_f32 v191, v191
  v_smfmac_f32_32x32x32_bf16 v[116:131], v[232:235], v[180:187], v3
  v_exp_f32 v192, v192
  v_exp_f32 v193, v193
  v_exp_f32 v194, v194
  v_exp_f32 v195, v195
  s_waitcnt vmcnt(1)
  s_cmp_eq_u32 s8, 1
  s_cbranch_scc0 SK_l_11
  s_waitcnt vmcnt(0)
SK_l_11:
  v_mfma_f32_32x32x16_bf16 v[148:163], v[212:215], v[60:63], 0
  v_exp_f32 v196, v196
  v_exp_f32 v197, v197
  v_exp_f32 v198, v198
  v_exp_f32 v199, v199
  v_mfma_f32_32x32x8_bf16 v[148:163], v[216:217], v[64:65], v[148:163]
  v_exp_f32 v200, v200
  v_exp_f32 v201, v201
  v_exp_f32 v202, v202
  v_exp_f32 v203, v203
  v_smfmac_f32_32x32x32_bf16 v[116:131], v[236:239], v[188:195], v3
  v_exp_f32 v204, v204
  v_exp_f32 v205, v205
  v_exp_f32 v206, v206
  v_exp_f32 v207, v207
  v_smfmac_f32_32x32x32_bf16 v[132:147], v[232:235], v[196:203], v3
  v_exp_f32 v208, v208
  v_exp_f32 v209, v209
  v_exp_f32 v210, v210
  v_exp_f32 v211, v211
  v_mfma_f32_32x32x16_bf16 v[164:179], v[212:215], v[66:69], 0
  v_exp_f32 v148, v148
  v_exp_f32 v149, v149
  v_exp_f32 v150, v150
  v_exp_f32 v151, v151
  v_mfma_f32_32x32x8_bf16 v[164:179], v[216:217], v[70:71], v[164:179]
  v_exp_f32 v152, v152
  v_exp_f32 v153, v153
  v_exp_f32 v154, v154
  v_exp_f32 v155, v155
  v_smfmac_f32_32x32x32_bf16 v[132:147], v[236:239], v[204:211], v3
  s_and_b64 s[24:25], s[100:101], s[34:35]
  s_cmp_eq_u64 s[24:25], s[34:35]
  s_cbranch_scc1 SK_kl1
  global_load_dwordx2 v[240:241], v248, s[60:61] sc1
SK_kl1:
  s_add_u32 s66, s66, 3584
  s_addc_u32 s67, s67, 0
  global_load_dwordx4 v[226:229], v0, s[66:67] sc1
  global_load_dwordx2 v[230:231], v5, s[66:67] sc1
  global_load_dwordx4 v[232:235], v4, s[66:67] offset:1536 sc1
  global_load_dwordx4 v[236:239], v4, s[66:67] offset:2560 sc1
  s_mov_b32 m0, s77
  s_nop 0
  global_load_lds_dwordx4 v252, s[68:69] offset:2048
  v_exp_f32 v156, v156
  v_exp_f32 v157, v157
  v_exp_f32 v158, v158
  v_exp_f32 v159, v159
  v_smfmac_f32_32x32x32_bf16 v[84:99], v[218:221], v[148:155], v3
  v_exp_f32 v160, v160
  v_exp_f32 v161, v161
  v_exp_f32 v162, v162
  v_exp_f32 v163, v163
  v_mfma_f32_32x32x16_bf16 v[180:195], v[212:215], v[72:75], 0
  v_exp_f32 v164, v164
  v_exp_f32 v165, v165
  v_exp_f32 v166, v166
  v_exp_f32 v167, v167
  v_mfma_f32_32x32x8_bf16 v[180:195], v[216:217], v[76:77], v[180:195]
  v_exp_f32 v168, v168
  v_exp_f32 v169, v169
  v_exp_f32 v170, v170
  v_exp_f32 v171, v171
  v_smfmac_f32_32x32x32_bf16 v[84:99], v[222:225], v[156:163], v3
  v_exp_f32 v172, v172
  v_exp_f32 v173, v173
  v_exp_f32 v174, v174
  v_exp_f32 v175, v175
  v_smfmac_f32_32x32x32_bf16 v[100:115], v[218:221], v[164:171], v3
  v_exp_f32 v176, v176
  v_exp_f32 v177, v177
  v_exp_f32 v178, v178
  v_exp_f32 v179, v179
  v_mfma_f32_32x32x16_bf16 v[196:211], v[212:215], v[78:81], 0
  v_exp_f32 v180, v180
  v_exp_f32 v181, v181
  v_exp_f32 v182, v182
  v_exp_f32 v183, v183
  v_mfma_f32_32x32x8_bf16 v[196:211], v[216:217], v[82:83], v[196:211]
  v_exp_f32 v184, v184
  v_exp_f32 v185, v185
  v_exp_f32 v186, v186
  v_exp_f32 v187, v187
  v_smfmac_f32_32x32x32_bf16 v[100:115], v[222:225], v[172:179], v3
  v_exp_f32 v188, v188
  v_exp_f32 v189, v189
  v_exp_f32 v190, v190
  v_exp_f32 v191, v191
  v_smfmac_f32_32x32x32_bf16 v[116:131], v[218:221], v[180:187], v3
  v_exp_f32 v192, v192
  v_exp_f32 v193, v193
  v_exp_f32 v194, v194
  v_exp_f32 v195, v195
  s_waitcnt vmcnt(1)
  v_mfma_f32_32x32x16_bf16 v[148:163], v[226:229], v[60:63], 0
  v_exp_f32 v196, v196
  v_exp_f32 v197, v197
  v_exp_f32 v198, v198
  v_exp_f32 v199, v199
  v_mfma_f32_32x32x8_bf16 v[148:163], v[230:231], v[64:65], v[148:163]
  v_exp_f32 v200, v200
  v_exp_f32 v201, v201
  v_exp_f32 v202, v202
  v_exp_f32 v203, v203
  v_smfmac_f32_32x32x32_bf16 v[116:131], v[222:225], v[188:195], v3
  v_exp_f32 v204, v204
  v_exp_f32 v205, v205
  v_exp_f32 v206, v206
  v_exp_f32 v207, v207
  v_smfmac_f32_32x32x32_bf16 v[132:147], v[218:221], v[196:203], v3
  v_exp_f32 v208, v208
  v_exp_f32 v209, v209
  v_exp_f32 v210, v210
  v_exp_f32 v211, v211
  v_mfma_f32_32x32x16_bf16 v[164:179], v[226:229], v[66:69], 0
  v_exp_f32 v148, v148
  v_exp_f32 v149, v149
  v_exp_f32 v150, v150
  v_exp_f32 v151, v151
  v_mfma_f32_32x32x8_bf16 v[164:179], v[230:231], v[70:71], v[164:179]
  v_exp_f32 v152, v152
  v_exp_f32 v153, v153
  v_exp_f32 v154, v154
  v_exp_f32 v155, v155
  v_smfmac_f32_32x32x32_bf16 v[132:147], v[222:225], v[204:211], v3
  s_and_b64 s[24:25], s[100:101], s[34:35]
  s_cmp_eq_u64 s[24:25], s[34:35]
  s_cbranch_scc1 SK_nb01
  v_cmp_eq_u32 vcc, v249, v240
  v_cmp_eq_u32 s[24:25], v249, v241
  s_nop 0
  s_and_b64 s[24:25], s[24:25], vcc
  s_lshr_b64 s[26:27], s[24:25], 4
  s_and_b64 s[24:25], s[24:25], s[26:27]
  s_lshr_b64 s[26:27], s[24:25], 2
  s_and_b64 s[24:25], s[24:25], s[26:27]
  s_lshr_b64 s[26:27], s[24:25], 1
  s_and_b64 s[24:25], s[24:25], s[26:27]
  s_mov_b64 s[100:101], s[24:25]
  s_and_b64 s[24:25], s[24:25], s[34:35]
  s_cbranch_scc1 SK_nb01
  s_mov_b32 s20, 0
L_nbp01:
  global_load_dwordx2 v[240:241], v248, s[60:61] sc1
  s_waitcnt vmcnt(0)
  v_cmp_eq_u32 vcc, v249, v240
  v_cmp_eq_u32 s[24:25], v249, v241
  s_nop 0
  s_and_b64 s[24:25], s[24:25], vcc
  s_lshr_b64 s[26:27], s[24:25], 4
  s_and_b64 s[24:25], s[24:25], s[26:27]
  s_lshr_b64 s[26:27], s[24:25], 2
  s_and_b64 s[24:25], s[24:25], s[26:27]
  s_lshr_b64 s[26:27], s[24:25], 1
  s_and_b64 s[24:25], s[24:25], s[26:27]
  s_mov_b64 s[100:101], s[24:25]
  s_and_b64 s[24:25], s[24:25], s[34:35]
  s_cbranch_scc1 SK_nb01
  s_add_u32 s20, s20, 1
  s_cmp_lt_u32 s20, s9
  s_cbranch_scc1 L_nbp01
  s_mov_b32 s9, 0
  s_mov_b64 s[24:25], s[34:35]
SK_nb01:
  s_ff1_i32_b64 s20, s[24:25]
  s_bitset0_b64 s[34:35], s20
  s_mul_i32 s20, s20, 3584
  s_add_u32 s66, s62, s20
  s_addc_u32 s67, s63, 0
  global_load_dwordx4 v[212:215], v0, s[66:67] sc1
  global_load_dwordx2 v[216:217], v5, s[66:67] sc1
  global_load_dwordx4 v[218:221], v4, s[66:67] offset:1536 sc1
  global_load_dwordx4 v[222:225], v4, s[66:67] offset:2560 sc1
  s_cmp_eq_u32 s8, 0
  s_cbranch_scc0 SK_l_12
  s_cmp_lt_u32 s75, 40
  s_cbranch_scc1 SK_fd01
  global_load_dword v255, v2, s[54:55]
  s_branch SK_fe01
SK_fd01:
  s_lshl_b32 s20, s75, 5
  s_add_u32 s64, s54, s20
  s_addc_u32 s65, s55, 0
  s_add_u32 s64, s64, 40960
  s_addc_u32 s65, s65, 0
  s_mul_i32 s20, s6, 6912
  s_add_u32 m0, s20, 72704
  s_nop 0
  global_load_lds_dwordx4 v9, s[64:65]
SK_fe01:
SK_l_12:
  v_exp_f32 v156, v156
  v_exp_f32 v157, v157
  v_exp_f32 v158, v158
  v_exp_f32 v159, v159
  v_smfmac_f32_32x32x32_bf16 v[84:99], v[232:235], v[148:155], v3
  v_exp_f32 v160, v160
  v_exp_f32 v161, v161
  v_exp_f32 v162, v162
  v_exp_f32 v163, v163
  v_mfma_f32_32x32x16_bf16 v[180:195], v[226:229], v[72:75], 0
  v_exp_f32 v164, v164
  v_exp_f32 v165, v165
  v_exp_f32 v166, v166
  v_exp_f32 v167, v167
  v_mfma_f32_32x32x8_bf16 v[180:195], v[230:231], v[76:77], v[180:195]
  v_exp_f32 v168, v168
  v_exp_f32 v169, v169
  v_exp_f32 v170, v170
  v_exp_f32 v171, v171
  v_smfmac_f32_32x32x32_bf16 v[84:99], v[236:239], v[156:163], v3
  v_exp_f32 v172, v172
  v_exp_f32 v173, v173
  v_exp_f32 v174, v174
  v_exp_f32 v175, v175
  v_smfmac_f32_32x32x32_bf16 v[100:115], v[232:235], v[164:171], v3
  v_exp_f32 v176, v176
  v_exp_f32 v177, v177
  v_exp_f32 v178, v178
  v_exp_f32 v179, v179
  v_mfma_f32_32x32x16_bf16 v[196:211], v[226:229], v[78:81], 0
  v_exp_f32 v180, v180
  v_exp_f32 v181, v181
  v_exp_f32 v182, v182
  v_exp_f32 v183, v183
  v_mfma_f32_32x32x8_bf16 v[196:211], v[230:231], v[82:83], v[196:211]
  v_exp_f32 v184, v184
  v_exp_f32 v185, v185
  v_exp_f32 v186, v186
  v_exp_f32 v187, v187
  v_smfmac_f32_32x32x32_bf16 v[100:115], v[236:239], v[172:179], v3
  global_load_dword v255, v10, s[60:61] sc1
  v_exp_f32 v188, v188
  v_exp_f32 v189, v189
  v_exp_f32 v190, v190
  v_exp_f32 v191, v191
  v_smfmac_f32_32x32x32_bf16 v[116:131], v[232:235], v[180:187], v3
  v_exp_f32 v192, v192
  v_exp_f32 v193, v193
  v_exp_f32 v194, v194
  v_exp_f32 v195, v195
  s_waitcnt vmcnt(2)
  s_cmp_eq_u32 s8, 1
  s_cbranch_scc0 SK_l_13
  s_waitcnt vmcnt(1)
SK_l_13:
  v_mfma_f32_32x32x16_bf16 v[148:163], v[212:215], v[60:63], 0
  v_exp_f32 v196, v196
  v_exp_f32 v197, v197
  v_exp_f32 v198, v198
  v_exp_f32 v199, v199
  v_mfma_f32_32x32x8_bf16 v[148:163], v[216:217], v[64:65], v[148:163]
  v_exp_f32 v200, v200
  v_exp_f32 v201, v201
  v_exp_f32 v202, v202
  v_exp_f32 v203, v203
  v_smfmac_f32_32x32x32_bf16 v[116:131], v[236:239], v[188:195], v3
  v_exp_f32 v204, v204
  v_exp_f32 v205, v205
  v_exp_f32 v206, v206
  v_exp_f32 v207, v207
  v_smfmac_f32_32x32x32_bf16 v[132:147], v[232:235], v[196:203], v3
  v_exp_f32 v208, v208
  v_exp_f32 v209, v209
  v_exp_f32 v210, v210
  v_exp_f32 v211, v211
  v_mfma_f32_32x32x16_bf16 v[164:179], v[212:215], v[66:69], 0
  v_exp_f32 v148, v148
  v_exp_f32 v149, v149
  v_exp_f32 v150, v150
  v_exp_f32 v151, v151
  v_mfma_f32_32x32x8_bf16 v[164:179], v[216:217], v[70:71], v[164:179]
  v_exp_f32 v152, v152
  v_exp_f32 v153, v153
  v_exp_f32 v154, v154
  v_exp_f32 v155, v155
  v_smfmac_f32_32x32x32_bf16 v[132:147], v[236:239], v[204:211], v3
  s_and_b64 s[24:25], s[100:101], s[34:35]
  s_cmp_eq_u64 s[24:25], s[34:35]
  s_cbranch_scc1 SK_kl2
  global_load_dwordx2 v[240:241], v248, s[60:61] sc1
SK_kl2:
  s_add_u32 s66, s66, 3584
  s_addc_u32 s67, s67, 0
  global_load_dwordx4 v[226:229], v0, s[66:67] sc1
  global_load_dwordx2 v[230:231], v5, s[66:67] sc1
  global_load_dwordx4 v[232:235], v4, s[66:67] offset:1536 sc1
  global_load_dwordx4 v[236:239], v4, s[66:67] offset:2560 sc1
  s_mov_b32 m0, s77
  s_nop 0
  global_load_lds_dwordx4 v253, s[68:69] offset:3072
  v_exp_f32 v156, v156
  v_exp_f32 v157, v157
  v_exp_f32 v158, v158
  v_exp_f32 v159, v159
  v_smfmac_f32_32x32x32_bf16 v[84:99], v[218:221], v[148:155], v3
  v_exp_f32 v160, v160
  v_exp_f32 v161, v161
  v_exp_f32 v162, v162
  v_exp_f32 v163, v163
  v_mfma_f32_32x32x16_bf16 v[180:195], v[212:215], v[72:75], 0
  v_exp_f32 v164, v164
  v_exp_f32 v165, v165
  v_exp_f32 v166, v166
  v_exp_f32 v167, v167
  v_mfma_f32_32x32x8_bf16 v[180:195], v[216:217], v[76:77], v[180:195]
  v_exp_f32 v168, v168
  v_exp_f32 v169, v169
  v_exp_f32 v170, v170
  v_exp_f32 v171, v171
  v_smfmac_f32_32x32x32_bf16 v[84:99], v[222:225], v[156:163], v3
  s_add_u32 m0, s77, 4096
  s_nop 0
  global_load_lds_dwordx4 v254, s[68:69]
  v_exp_f32 v172, v172
  v_exp_f32 v173, v173
  v_exp_f32 v174, v174
  v_exp_f32 v175, v175
  v_smfmac_f32_32x32x32_bf16 v[100:115], v[218:221], v[164:171], v3
  v_exp_f32 v176, v176
  v_exp_f32 v177, v177
  v_exp_f32 v178, v178
  v_exp_f32 v179, v179
  v_mfma_f32_32x32x16_bf16 v[196:211], v[212:215], v[78:81], 0
  v_exp_f32 v180, v180
  v_exp_f32 v181, v181
  v_exp_f32 v182, v182
  v_exp_f32 v183, v183
  v_mfma_f32_32x32x8_bf16 v[196:211], v[216:217], v[82:83], v[196:211]
  v_exp_f32 v184, v184
  v_exp_f32 v185, v185
  v_exp_f32 v186, v186
  v_exp_f32 v187, v187
  v_smfmac_f32_32x32x32_bf16 v[100:115], v[222:225], v[172:179], v3
  v_exp_f32 v188, v188
  v_exp_f32 v189, v189
  v_exp_f32 v190, v190
  v_exp_f32 v191, v191
  v_smfmac_f32_32x32x32_bf16 v[116:131], v[218:221], v[180:187], v3
  v_exp_f32 v192, v192
  v_exp_f32 v193, v193
  v_exp_f32 v194, v194
  v_exp_f32 v195, v195
  s_waitcnt vmcnt(2)
  v_mfma_f32_32x32x16_bf16 v[148:163], v[226:229], v[60:63], 0
  v_exp_f32 v196, v196
  v_exp_f32 v197, v197
  v_exp_f32 v198, v198
  v_exp_f32 v199, v199
  v_mfma_f32_32x32x8_bf16 v[148:163], v[230:231], v[64:65], v[148:163]
  v_exp_f32 v200, v200
  v_exp_f32 v201, v201
  v_exp_f32 v202, v202
  v_exp_f32 v203, v203
  v_smfmac_f32_32x32x32_bf16 v[116:131], v[222:225], v[188:195], v3
  v_exp_f32 v204, v204
  v_exp_f32 v205, v205
  v_exp_f32 v206, v206
  v_exp_f32 v207, v207
  v_smfmac_f32_32x32x32_bf16 v[132:147], v[218:221], v[196:203], v3
  v_exp_f32 v208, v208
  v_exp_f32 v209, v209
  v_exp_f32 v210, v210
  v_exp_f32 v211, v211
  v_mfma_f32_32x32x16_bf16 v[164:179], v[226:229], v[66:69], 0
  v_exp_f32 v148, v148
  v_exp_f32 v149, v149
  v_exp_f32 v150, v150
  v_exp_f32 v151, v151
  v_mfma_f32_32x32x8_bf16 v[164:179], v[230:231], v[70:71], v[164:179]
  v_exp_f32 v152, v152
  v_exp_f32 v153, v153
  v_exp_f32 v154, v154
  v_exp_f32 v155, v155
  v_smfmac_f32_32x32x32_bf16 v[132:147], v[222:225], v[204:211], v3
  s_and_b64 s[24:25], s[100:101], s[34:35]
  s_cmp_eq_u64 s[24:25], s[34:35]
  s_cbranch_scc1 SK_nb02
  v_cmp_eq_u32 vcc, v249, v240
  v_cmp_eq_u32 s[24:25], v249, v241
  s_nop 0
  s_and_b64 s[24:25], s[24:25], vcc
  s_lshr_b64 s[26:27], s[24:25], 4
  s_and_b64 s[24:25], s[24:25], s[26:27]
  s_lshr_b64 s[26:27], s[24:25], 2
  s_and_b64 s[24:25], s[24:25], s[26:27]
  s_lshr_b64 s[26:27], s[24:25], 1
  s_and_b64 s[24:25], s[24:25], s[26:27]
  s_mov_b64 s[100:101], s[24:25]
  s_and_b64 s[24:25], s[24:25], s[34:35]
  s_cbranch_scc1 SK_nb02
  s_mov_b32 s20, 0
L_nbp02:
  global_load_dwordx2 v[240:241], v248, s[60:61] sc1
  s_waitcnt vmcnt(0)
  v_cmp_eq_u32 vcc, v249, v240
  v_cmp_eq_u32 s[24:25], v249, v241
  s_nop 0
  s_and_b64 s[24:25], s[24:25], vcc
  s_lshr_b64 s[26:27], s[24:25], 4
  s_and_b64 s[24:25], s[24:25], s[26:27]
  s_lshr_b64 s[26:27], s[24:25], 2
  s_and_b64 s[24:25], s[24:25], s[26:27]
  s_lshr_b64 s[26:27], s[24:25], 1
  s_and_b64 s[24:25], s[24:25], s[26:27]
  s_mov_b64 s[100:101], s[24:25]
  s_and_b64 s[24:25], s[24:25], s[34:35]
  s_cbranch_scc1 SK_nb02
  s_add_u32 s20, s20, 1
  s_cmp_lt_u32 s20, s9
  s_cbranch_scc1 L_nbp02
  s_mov_b32 s9, 0
  s_mov_b64 s[24:25], s[34:35]
SK_nb02:
  s_ff1_i32_b64 s20, s[24:25]
  s_bitset0_b64 s[34:35], s20
  s_mul_i32 s20, s20, 3584
  s_add_u32 s66, s62, s20
  s_addc_u32 s67, s63, 0
  global_load_dwordx4 v[212:215], v0, s[66:67] sc1
  global_load_dwordx2 v[216:217], v5, s[66:67] sc1
  global_load_dwordx4 v[218:221], v4, s[66:67] offset:1536 sc1
  global_load_dwordx4 v[222:225], v4, s[66:67] offset:2560 sc1
  s_cmp_eq_u32 s8, 0
  s_cbranch_scc0 SK_l_14
  s_cmp_lt_u32 s75, 40
  s_cbranch_scc1 SK_fd02
  s_lshl_b32 s20, s74, 4
  s_add_u32 s64, s50, s20
  s_addc_u32 s65, s51, 0
  s_add_u32 s64, s64, 220160
  s_addc_u32 s65, s65, 0
  s_mul_i32 s20, s6, 1280
  s_add_u32 m0, s20, 71680
  s_mov_b64 exec, 0xffff
  global_load_lds_dwordx4 v8, s[64:65] offset:1024
  s_mov_b64 exec, -1
  s_branch SK_fe02
SK_fd02:
  s_lshl_b32 s20, s75, 5
  s_add_u32 s64, s54, s20
  s_addc_u32 s65, s55, 0
  s_add_u32 s64, s64, 81920
  s_addc_u32 s65, s65, 0
  s_mul_i32 s20, s6, 6912
  s_add_u32 m0, s20, 73728
  s_nop 0
  global_load_lds_dwordx4 v9, s[64:65]
SK_fe02:
SK_l_14:
  v_exp_f32 v156, v156
  v_exp_f32 v157, v157
  v_exp_f32 v158, v158
  v_exp_f32 v159, v159
  v_smfmac_f32_32x32x32_bf16 v[84:99], v[232:235], v[148:155], v3
  v_exp_f32 v160, v160
  v_exp_f32 v161, v161
  v_exp_f32 v162, v162
  v_exp_f32 v163, v163
  v_mfma_f32_32x32x16_bf16 v[180:195], v[226:229], v[72:75], 0
  v_exp_f32 v164, v164
  v_exp_f32 v165, v165
  v_exp_f32 v166, v166
  v_exp_f32 v167, v167
  v_mfma_f32_32x32x8_bf16 v[180:195], v[230:231], v[76:77], v[180:195]
  v_exp_f32 v168, v168
  v_exp_f32 v169, v169
  v_exp_f32 v170, v170
  v_exp_f32 v171, v171
  v_smfmac_f32_32x32x32_bf16 v[84:99], v[236:239], v[156:163], v3
  v_exp_f32 v172, v172
  v_exp_f32 v173, v173
  v_exp_f32 v174, v174
  v_exp_f32 v175, v175
  v_smfmac_f32_32x32x32_bf16 v[100:115], v[232:235], v[164:171], v3
  v_exp_f32 v176, v176
  v_exp_f32 v177, v177
  v_exp_f32 v178, v178
  v_exp_f32 v179, v179
  v_mfma_f32_32x32x16_bf16 v[196:211], v[226:229], v[78:81], 0
  v_exp_f32 v180, v180
  v_exp_f32 v181, v181
  v_exp_f32 v182, v182
  v_exp_f32 v183, v183
  v_mfma_f32_32x32x8_bf16 v[196:211], v[230:231], v[82:83], v[196:211]
  v_exp_f32 v184, v184
  v_exp_f32 v185, v185
  v_exp_f32 v186, v186
  v_exp_f32 v187, v187
  v_smfmac_f32_32x32x32_bf16 v[100:115], v[236:239], v[172:179], v3
  v_exp_f32 v188, v188
  v_exp_f32 v189, v189
  v_exp_f32 v190, v190
  v_exp_f32 v191, v191
  v_smfmac_f32_32x32x32_bf16 v[116:131], v[232:235], v[180:187], v3
  v_exp_f32 v192, v192
  v_exp_f32 v193, v193
  v_exp_f32 v194, v194
  v_exp_f32 v195, v195
  s_waitcnt vmcnt(1)
  s_cmp_eq_u32 s8, 1
  s_cbranch_scc0 SK_l_15
  s_waitcnt vmcnt(0)
SK_l_15:
  v_mfma_f32_32x32x16_bf16 v[148:163], v[212:215], v[60:63], 0
  v_exp_f32 v196, v196
  v_exp_f32 v197, v197
  v_exp_f32 v198, v198
  v_exp_f32 v199, v199
  v_mfma_f32_32x32x8_bf16 v[148:163], v[216:217], v[64:65], v[148:163]
  v_exp_f32 v200, v200
  v_exp_f32 v201, v201
  v_exp_f32 v202, v202
  v_exp_f32 v203, v203
  v_smfmac_f32_32x32x32_bf16 v[116:131], v[236:239], v[188:195], v3
  v_exp_f32 v204, v204
  v_exp_f32 v205, v205
  v_exp_f32 v206, v206
  v_exp_f32 v207, v207
  v_smfmac_f32_32x32x32_bf16 v[132:147], v[232:235], v[196:203], v3
  v_exp_f32 v208, v208
  v_exp_f32 v209, v209
  v_exp_f32 v210, v210
  v_exp_f32 v211, v211
  v_mfma_f32_32x32x16_bf16 v[164:179], v[212:215], v[66:69], 0
  v_exp_f32 v148, v148
  v_exp_f32 v149, v149
  v_exp_f32 v150, v150
  v_exp_f32 v151, v151
  v_mfma_f32_32x32x8_bf16 v[164:179], v[216:217], v[70:71], v[164:179]
  v_exp_f32 v152, v152
  v_exp_f32 v153, v153
  v_exp_f32 v154, v154
  v_exp_f32 v155, v155
  v_smfmac_f32_32x32x32_bf16 v[132:147], v[236:239], v[204:211], v3
  s_and_b64 s[24:25], s[100:101], s[34:35]
  s_cmp_eq_u64 s[24:25], s[34:35]
  s_cbranch_scc1 SK_kl3
  global_load_dwordx2 v[240:241], v248, s[60:61] sc1
SK_kl3:
  s_add_u32 s66, s66, 3584
  s_addc_u32 s67, s67, 0
  global_load_dwordx4 v[226:229], v0, s[66:67] sc1
  global_load_dwordx2 v[230:231], v5, s[66:67] sc1
  global_load_dwordx4 v[232:235], v4, s[66:67] offset:1536 sc1
  global_load_dwordx4 v[236:239], v4, s[66:67] offset:2560 sc1
  s_mul_i32 s21, s33, 40960
  s_mul_i32 s22, s32, 81920
  s_add_u32 s21, s21, s22
  s_add_u32 s68, s44, s21
  s_addc_u32 s69, s45, 0
  s_mul_i32 s77, s33, 5120
  s_mul_i32 s22, s32, 10240
  s_add_u32 s77, s77, s22
  s_mov_b32 m0, s77
  s_nop 0
  global_load_lds_dwordx4 v250, s[68:69] offset:0
  v_exp_f32 v156, v156
  v_exp_f32 v157, v157
  v_exp_f32 v158, v158
  v_exp_f32 v159, v159
  v_smfmac_f32_32x32x32_bf16 v[84:99], v[218:221], v[148:155], v3
  v_exp_f32 v160, v160
  v_exp_f32 v161, v161
  v_exp_f32 v162, v162
  v_exp_f32 v163, v163
  v_mfma_f32_32x32x16_bf16 v[180:195], v[212:215], v[72:75], 0
  v_exp_f32 v164, v164
  v_exp_f32 v165, v165
  v_exp_f32 v166, v166
  v_exp_f32 v167, v167
  v_mfma_f32_32x32x8_bf16 v[180:195], v[216:217], v[76:77], v[180:195]
  v_exp_f32 v168, v168
  v_exp_f32 v169, v169
  v_exp_f32 v170, v170
  v_exp_f32 v171, v171
  v_smfmac_f32_32x32x32_bf16 v[84:99], v[222:225], v[156:163], v3
  v_exp_f32 v172, v172
  v_exp_f32 v173, v173
  v_exp_f32 v174, v174
  v_exp_f32 v175, v175
  v_smfmac_f32_32x32x32_bf16 v[100:115], v[218:221], v[164:171], v3
  v_exp_f32 v176, v176
  v_exp_f32 v177, v177
  v_exp_f32 v178, v178
  v_exp_f32 v179, v179
  v_mfma_f32_32x32x16_bf16 v[196:211], v[212:215], v[78:81], 0
  v_exp_f32 v180, v180
  v_exp_f32 v181, v181
  v_exp_f32 v182, v182
  v_exp_f32 v183, v183
  v_mfma_f32_32x32x8_bf16 v[196:211], v[216:217], v[82:83], v[196:211]
  v_exp_f32 v184, v184
  v_exp_f32 v185, v185
  v_exp_f32 v186, v186
  v_exp_f32 v187, v187
  v_smfmac_f32_32x32x32_bf16 v[100:115], v[222:225], v[172:179], v3
  v_exp_f32 v188, v188
  v_exp_f32 v189, v189
  v_exp_f32 v190, v190
  v_exp_f32 v191, v191
  v_smfmac_f32_32x32x32_bf16 v[116:131], v[218:221], v[180:187], v3
  v_exp_f32 v192, v192
  v_exp_f32 v193, v193
  v_exp_f32 v194, v194
  v_exp_f32 v195, v195
  s_waitcnt vmcnt(1)
  v_mfma_f32_32x32x16_bf16 v[148:163], v[226:229], v[60:63], 0
  v_exp_f32 v196, v196
  v_exp_f32 v197, v197
  v_exp_f32 v198, v198
  v_exp_f32 v199, v199
  v_mfma_f32_32x32x8_bf16 v[148:163], v[230:231], v[64:65], v[148:163]
  v_exp_f32 v200, v200
  v_exp_f32 v201, v201
  v_exp_f32 v202, v202
  v_exp_f32 v203, v203
  v_smfmac_f32_32x32x32_bf16 v[116:131], v[222:225], v[188:195], v3
  v_exp_f32 v204, v204
  v_exp_f32 v205, v205
  v_exp_f32 v206, v206
  v_exp_f32 v207, v207
  v_smfmac_f32_32x32x32_bf16 v[132:147], v[218:221], v[196:203], v3
  v_exp_f32 v208, v208
  v_exp_f32 v209, v209
  v_exp_f32 v210, v210
  v_exp_f32 v211, v211
  v_mfma_f32_32x32x16_bf16 v[164:179], v[226:229], v[66:69], 0
  v_exp_f32 v148, v148
  v_exp_f32 v149, v149
  v_exp_f32 v150, v150
  v_exp_f32 v151, v151
  v_mfma_f32_32x32x8_bf16 v[164:179], v[230:231], v[70:71], v[164:179]
  v_exp_f32 v152, v152
  v_exp_f32 v153, v153
  v_exp_f32 v154, v154
  v_exp_f32 v155, v155
  v_smfmac_f32_32x32x32_bf16 v[132:147], v[222:225], v[204:211], v3
  s_and_b64 s[24:25], s[100:101], s[34:35]
  s_cmp_eq_u64 s[24:25], s[34:35]
  s_cbranch_scc1 SK_nb03
  v_cmp_eq_u32 vcc, v249, v240
  v_cmp_eq_u32 s[24:25], v249, v241
  s_nop 0
  s_and_b64 s[24:25], s[24:25], vcc
  s_lshr_b64 s[26:27], s[24:25], 4
  s_and_b64 s[24:25], s[24:25], s[26:27]
  s_lshr_b64 s[26:27], s[24:25], 2
  s_and_b64 s[24:25], s[24:25], s[26:27]
  s_lshr_b64 s[26:27], s[24:25], 1
  s_and_b64 s[24:25], s[24:25], s[26:27]
  s_mov_b64 s[100:101], s[24:25]
  s_and_b64 s[24:25], s[24:25], s[34:35]
  s_cbranch_scc1 SK_nb03
  s_mov_b32 s20, 0
L_nbp03:
  global_load_dwordx2 v[240:241], v248, s[60:61] sc1
  s_waitcnt vmcnt(0)
  v_cmp_eq_u32 vcc, v249, v240
  v_cmp_eq_u32 s[24:25], v249, v241
  s_nop 0
  s_and_b64 s[24:25], s[24:25], vcc
  s_lshr_b64 s[26:27], s[24:25], 4
  s_and_b64 s[24:25], s[24:25], s[26:27]
  s_lshr_b64 s[26:27], s[24:25], 2
  s_and_b64 s[24:25], s[24:25], s[26:27]
  s_lshr_b64 s[26:27], s[24:25], 1
  s_and_b64 s[24:25], s[24:25], s[26:27]
  s_mov_b64 s[100:101], s[24:25]
  s_and_b64 s[24:25], s[24:25], s[34:35]
  s_cbranch_scc1 SK_nb03
  s_add_u32 s20, s20, 1
  s_cmp_lt_u32 s20, s9
  s_cbranch_scc1 L_nbp03
  s_mov_b32 s9, 0
  s_mov_b64 s[24:25], s[34:35]
SK_nb03:
  s_ff1_i32_b64 s20, s[24:25]
  s_bitset0_b64 s[34:35], s20
  s_mul_i32 s20, s20, 3584
  s_add_u32 s66, s62, s20
  s_addc_u32 s67, s63, 0
  global_load_dwordx4 v[212:215], v0, s[66:67] sc1
  global_load_dwordx2 v[216:217], v5, s[66:67] sc1
  global_load_dwordx4 v[218:221], v4, s[66:67] offset:1536 sc1
  global_load_dwordx4 v[222:225], v4, s[66:67] offset:2560 sc1
  s_cmp_eq_u32 s8, 0
  s_cbranch_scc0 SK_l_16
  s_cmp_lt_u32 s75, 40
  s_cbranch_scc1 SK_fd03
  global_load_dword v255, v2, s[54:55]
  s_branch SK_fe03
SK_fd03:
  s_lshl_b32 s20, s75, 5
  s_add_u32 s64, s54, s20
  s_addc_u32 s65, s55, 0
  s_add_u32 s64, s64, 122880
  s_addc_u32 s65, s65, 0
  s_mul_i32 s20, s6, 6912
  s_add_u32 m0, s20, 74752
  s_nop 0
  global_load_lds_dwordx4 v9, s[64:65]
SK_fe03:
SK_l_16:
  v_exp_f32 v156, v156
  v_exp_f32 v157, v157
  v_exp_f32 v158, v158
  v_exp_f32 v159, v159
  v_smfmac_f32_32x32x32_bf16 v[84:99], v[232:235], v[148:155], v3
  v_exp_f32 v160, v160
  v_exp_f32 v161, v161
  v_exp_f32 v162, v162
  v_exp_f32 v163, v163
  v_mfma_f32_32x32x16_bf16 v[180:195], v[226:229], v[72:75], 0
  v_exp_f32 v164, v164
  v_exp_f32 v165, v165
  v_exp_f32 v166, v166
  v_exp_f32 v167, v167
  v_mfma_f32_32x32x8_bf16 v[180:195], v[230:231], v[76:77], v[180:195]
  v_exp_f32 v168, v168
  v_exp_f32 v169, v169
  v_exp_f32 v170, v170
  v_exp_f32 v171, v171
  v_smfmac_f32_32x32x32_bf16 v[84:99], v[236:239], v[156:163], v3
  v_exp_f32 v172, v172
  v_exp_f32 v173, v173
  v_exp_f32 v174, v174
  v_exp_f32 v175, v175
  v_smfmac_f32_32x32x32_bf16 v[100:115], v[232:235], v[164:171], v3
  v_exp_f32 v176, v176
  v_exp_f32 v177, v177
  v_exp_f32 v178, v178
  v_exp_f32 v179, v179
  v_mfma_f32_32x32x16_bf16 v[196:211], v[226:229], v[78:81], 0
  v_exp_f32 v180, v180
  v_exp_f32 v181, v181
  v_exp_f32 v182, v182
  v_exp_f32 v183, v183
  v_mfma_f32_32x32x8_bf16 v[196:211], v[230:231], v[82:83], v[196:211]
  v_exp_f32 v184, v184
  v_exp_f32 v185, v185
  v_exp_f32 v186, v186
  v_exp_f32 v187, v187
  v_smfmac_f32_32x32x32_bf16 v[100:115], v[236:239], v[172:179], v3
  global_load_dword v255, v11, s[44:45]
  v_exp_f32 v188, v188
  v_exp_f32 v189, v189
  v_exp_f32 v190, v190
  v_exp_f32 v191, v191
  v_smfmac_f32_32x32x32_bf16 v[116:131], v[232:235], v[180:187], v3
  v_exp_f32 v192, v192
  v_exp_f32 v193, v193
  v_exp_f32 v194, v194
  v_exp_f32 v195, v195
  s_waitcnt vmcnt(2)
  s_cmp_eq_u32 s8, 1
  s_cbranch_scc0 SK_l_17
  s_waitcnt vmcnt(1)
SK_l_17:
  v_mfma_f32_32x32x16_bf16 v[148:163], v[212:215], v[60:63], 0
  v_exp_f32 v196, v196
  v_exp_f32 v197, v197
  v_exp_f32 v198, v198
  v_exp_f32 v199, v199
  v_mfma_f32_32x32x8_bf16 v[148:163], v[216:217], v[64:65], v[148:163]
  v_exp_f32 v200, v200
  v_exp_f32 v201, v201
  v_exp_f32 v202, v202
  v_exp_f32 v203, v203
  v_smfmac_f32_32x32x32_bf16 v[116:131], v[236:239], v[188:195], v3
  v_exp_f32 v204, v204
  v_exp_f32 v205, v205
  v_exp_f32 v206, v206
  v_exp_f32 v207, v207
  v_smfmac_f32_32x32x32_bf16 v[132:147], v[232:235], v[196:203], v3
  v_exp_f32 v208, v208
  v_exp_f32 v209, v209
  v_exp_f32 v210, v210
  v_exp_f32 v211, v211
  v_mfma_f32_32x32x16_bf16 v[164:179], v[212:215], v[66:69], 0
  v_exp_f32 v148, v148
  v_exp_f32 v149, v149
  v_exp_f32 v150, v150
  v_exp_f32 v151, v151
  v_mfma_f32_32x32x8_bf16 v[164:179], v[216:217], v[70:71], v[164:179]
  v_exp_f32 v152, v152
  v_exp_f32 v153, v153
  v_exp_f32 v154, v154
  v_exp_f32 v155, v155
  v_smfmac_f32_32x32x32_bf16 v[132:147], v[236:239], v[204:211], v3
  s_and_b64 s[24:25], s[100:101], s[34:35]
  s_cmp_eq_u64 s[24:25], s[34:35]
  s_cbranch_scc1 SK_kl4
  global_load_dwordx2 v[240:241], v248, s[60:61] sc1
SK_kl4:
  s_add_u32 s66, s66, 3584
  s_addc_u32 s67, s67, 0
  global_load_dwordx4 v[226:229], v0, s[66:67] sc1
  global_load_dwordx2 v[230:231], v5, s[66:67] sc1
  global_load_dwordx4 v[232:235], v4, s[66:67] offset:1536 sc1
  global_load_dwordx4 v[236:239], v4, s[66:67] offset:2560 sc1
  s_mov_b32 m0, s77
  s_nop 0
  global_load_lds_dwordx4 v251, s[68:69] offset:1024
  v_exp_f32 v156, v156
  v_exp_f32 v157, v157
  v_exp_f32 v158, v158
  v_exp_f32 v159, v159
  v_smfmac_f32_32x32x32_bf16 v[84:99], v[218:221], v[148:155], v3
  v_exp_f32 v160, v160
  v_exp_f32 v161, v161
  v_exp_f32 v162, v162
  v_exp_f32 v163, v163
  v_mfma_f32_32x32x16_bf16 v[180:195], v[212:215], v[72:75], 0
  v_exp_f32 v164, v164
  v_exp_f32 v165, v165
  v_exp_f32 v166, v166
  v_exp_f32 v167, v167
  v_mfma_f32_32x32x8_bf16 v[180:195], v[216:217], v[76:77], v[180:195]
  v_exp_f32 v168, v168
  v_exp_f32 v169, v169
  v_exp_f32 v170, v170
  v_exp_f32 v171, v171
  v_smfmac_f32_32x32x32_bf16 v[84:99], v[222:225], v[156:163], v3
  v_exp_f32 v172, v172
  v_exp_f32 v173, v173
  v_exp_f32 v174, v174
  v_exp_f32 v175, v175
  v_smfmac_f32_32x32x32_bf16 v[100:115], v[218:221], v[164:171], v3
  v_exp_f32 v176, v176
  v_exp_f32 v177, v177
  v_exp_f32 v178, v178
  v_exp_f32 v179, v179
  v_mfma_f32_32x32x16_bf16 v[196:211], v[212:215], v[78:81], 0
  v_exp_f32 v180, v180
  v_exp_f32 v181, v181
  v_exp_f32 v182, v182
  v_exp_f32 v183, v183
  v_mfma_f32_32x32x8_bf16 v[196:211], v[216:217], v[82:83], v[196:211]
  v_exp_f32 v184, v184
  v_exp_f32 v185, v185
  v_exp_f32 v186, v186
  v_exp_f32 v187, v187
  v_smfmac_f32_32x32x32_bf16 v[100:115], v[222:225], v[172:179], v3
  v_exp_f32 v188, v188
  v_exp_f32 v189, v189
  v_exp_f32 v190, v190
  v_exp_f32 v191, v191
  v_smfmac_f32_32x32x32_bf16 v[116:131], v[218:221], v[180:187], v3
  v_exp_f32 v192, v192
  v_exp_f32 v193, v193
  v_exp_f32 v194, v194
  v_exp_f32 v195, v195
  s_waitcnt vmcnt(1)
  v_mfma_f32_32x32x16_bf16 v[148:163], v[226:229], v[60:63], 0
  v_exp_f32 v196, v196
  v_exp_f32 v197, v197
  v_exp_f32 v198, v198
  v_exp_f32 v199, v199
  v_mfma_f32_32x32x8_bf16 v[148:163], v[230:231], v[64:65], v[148:163]
  v_exp_f32 v200, v200
  v_exp_f32 v201, v201
  v_exp_f32 v202, v202
  v_exp_f32 v203, v203
  v_smfmac_f32_32x32x32_bf16 v[116:131], v[222:225], v[188:195], v3
  v_exp_f32 v204, v204
  v_exp_f32 v205, v205
  v_exp_f32 v206, v206
  v_exp_f32 v207, v207
  v_smfmac_f32_32x32x32_bf16 v[132:147], v[218:221], v[196:203], v3
  v_exp_f32 v208, v208
  v_exp_f32 v209, v209
  v_exp_f32 v210, v210
  v_exp_f32 v211, v211
  v_mfma_f32_32x32x16_bf16 v[164:179], v[226:229], v[66:69], 0
  v_exp_f32 v148, v148
  v_exp_f32 v149, v149
  v_exp_f32 v150, v150
  v_exp_f32 v151, v151
  v_mfma_f32_32x32x8_bf16 v[164:179], v[230:231], v[70:71], v[164:179]
  v_exp_f32 v152, v152
  v_exp_f32 v153, v153
  v_exp_f32 v154, v154
  v_exp_f32 v155, v155
  v_smfmac_f32_32x32x32_bf16 v[132:147], v[222:225], v[204:211], v3
  s_and_b64 s[24:25], s[100:101], s[34:35]
  s_cmp_eq_u64 s[24:25], s[34:35]
  s_cbranch_scc1 SK_nb04
  v_cmp_eq_u32 vcc, v249, v240
  v_cmp_eq_u32 s[24:25], v249, v241
  s_nop 0
  s_and_b64 s[24:25], s[24:25], vcc
  s_lshr_b64 s[26:27], s[24:25], 4
  s_and_b64 s[24:25], s[24:25], s[26:27]
  s_lshr_b64 s[26:27], s[24:25], 2
  s_and_b64 s[24:25], s[24:25], s[26:27]
  s_lshr_b64 s[26:27], s[24:25], 1
  s_and_b64 s[24:25], s[24:25], s[26:27]
  s_mov_b64 s[100:101], s[24:25]
  s_and_b64 s[24:25], s[24:25], s[34:35]
  s_cbranch_scc1 SK_nb04
  s_mov_b32 s20, 0
L_nbp04:
  global_load_dwordx2 v[240:241], v248, s[60:61] sc1
  s_waitcnt vmcnt(0)
  v_cmp_eq_u32 vcc, v249, v240
  v_cmp_eq_u32 s[24:25], v249, v241
  s_nop 0
  s_and_b64 s[24:25], s[24:25], vcc
  s_lshr_b64 s[26:27], s[24:25], 4
  s_and_b64 s[24:25], s[24:25], s[26:27]
  s_lshr_b64 s[26:27], s[24:25], 2
  s_and_b64 s[24:25], s[24:25], s[26:27]
  s_lshr_b64 s[26:27], s[24:25], 1
  s_and_b64 s[24:25], s[24:25], s[26:27]
  s_mov_b64 s[100:101], s[24:25]
  s_and_b64 s[24:25], s[24:25], s[34:35]
  s_cbranch_scc1 SK_nb04
  s_add_u32 s20, s20, 1
  s_cmp_lt_u32 s20, s9
  s_cbranch_scc1 L_nbp04
  s_mov_b32 s9, 0
  s_mov_b64 s[24:25], s[34:35]
SK_nb04:
  s_ff1_i32_b64 s20, s[24:25]
  s_bitset0_b64 s[34:35], s20
  s_mul_i32 s20, s20, 3584
  s_add_u32 s66, s62, s20
  s_addc_u32 s67, s63, 0
  global_load_dwordx4 v[212:215], v0, s[66:67] sc1
  global_load_dwordx2 v[216:217], v5, s[66:67] sc1
  global_load_dwordx4 v[218:221], v4, s[66:67] offset:1536 sc1
  global_load_dwordx4 v[222:225], v4, s[66:67] offset:2560 sc1
  s_cmp_eq_u32 s8, 0
  s_cbranch_scc0 SK_l_18
  s_cmp_lt_u32 s75, 40
  s_cbranch_scc1 SK_fd04
  s_lshl_b32 s20, s74, 4
  s_add_u32 s64, s52, s20
  s_addc_u32 s65, s53, 0
  s_mul_i32 s20, s6, 1280
  s_add_u32 m0, s20, 81920
  s_nop 0
  global_load_lds_dwordx4 v8, s[64:65] offset:0
  s_branch SK_fe04
SK_fd04:
  s_lshl_b32 s20, s75, 5
  s_add_u32 s64, s54, s20
  s_addc_u32 s65, s55, 0
  s_add_u32 s64, s64, 163840
  s_addc_u32 s65, s65, 0
  s_mul_i32 s20, s6, 6912
  s_add_u32 m0, s20, 75776
  s_nop 0
  global_load_lds_dwordx4 v9, s[64:65]
SK_fe04:
SK_l_18:
  v_exp_f32 v156, v156
  v_exp_f32 v157, v157
  v_exp_f32 v158, v158
  v_exp_f32 v159, v159
  v_smfmac_f32_32x32x32_bf16 v[84:99], v[232:235], v[148:155], v3
  v_exp_f32 v160, v160
  v_exp_f32 v161, v161
  v_exp_f32 v162, v162
  v_exp_f32 v163, v163
  v_mfma_f32_32x32x16_bf16 v[180:195], v[226:229], v[72:75], 0
  v_exp_f32 v164, v164
  v_exp_f32 v165, v165
  v_exp_f32 v166, v166
  v_exp_f32 v167, v167
  v_mfma_f32_32x32x8_bf16 v[180:195], v[230:231], v[76:77], v[180:195]
  v_exp_f32 v168, v168
  v_exp_f32 v169, v169
  v_exp_f32 v170, v170
  v_exp_f32 v171, v171
  v_smfmac_f32_32x32x32_bf16 v[84:99], v[236:239], v[156:163], v3
  v_exp_f32 v172, v172
  v_exp_f32 v173, v173
  v_exp_f32 v174, v174
  v_exp_f32 v175, v175
  v_smfmac_f32_32x32x32_bf16 v[100:115], v[232:235], v[164:171], v3
  v_exp_f32 v176, v176
  v_exp_f32 v177, v177
  v_exp_f32 v178, v178
  v_exp_f32 v179, v179
  v_mfma_f32_32x32x16_bf16 v[196:211], v[226:229], v[78:81], 0
  v_exp_f32 v180, v180
  v_exp_f32 v181, v181
  v_exp_f32 v182, v182
  v_exp_f32 v183, v183
  v_mfma_f32_32x32x8_bf16 v[196:211], v[230:231], v[82:83], v[196:211]
  v_exp_f32 v184, v184
  v_exp_f32 v185, v185
  v_exp_f32 v186, v186
  v_exp_f32 v187, v187
  v_smfmac_f32_32x32x32_bf16 v[100:115], v[236:239], v[172:179], v3
  v_exp_f32 v188, v188
  v_exp_f32 v189, v189
  v_exp_f32 v190, v190
  v_exp_f32 v191, v191
  v_smfmac_f32_32x32x32_bf16 v[116:131], v[232:235], v[180:187], v3
  v_exp_f32 v192, v192
  v_exp_f32 v193, v193
  v_exp_f32 v194, v194
  v_exp_f32 v195, v195
  s_waitcnt vmcnt(1)
  s_cmp_eq_u32 s8, 1
  s_cbranch_scc0 SK_l_19
  s_waitcnt vmcnt(0)
SK_l_19:
  v_mfma_f32_32x32x16_bf16 v[148:163], v[212:215], v[60:63], 0
  v_exp_f32 v196, v196
  v_exp_f32 v197, v197
  v_exp_f32 v198, v198
  v_exp_f32 v199, v199
  v_mfma_f32_32x32x8_bf16 v[148:163], v[216:217], v[64:65], v[148:163]
  v_exp_f32 v200, v200
  v_exp_f32 v201, v201
  v_exp_f32 v202, v202
  v_exp_f32 v203, v203
  v_smfmac_f32_32x32x32_bf16 v[116:131], v[236:239], v[188:195], v3
  v_exp_f32 v204, v204
  v_exp_f32 v205, v205
  v_exp_f32 v206, v206
  v_exp_f32 v207, v207
  v_smfmac_f32_32x32x32_bf16 v[132:147], v[232:235], v[196:203], v3
  v_exp_f32 v208, v208
  v_exp_f32 v209, v209
  v_exp_f32 v210, v210
  v_exp_f32 v211, v211
  s_cmp_ge_u32 s6, 4
  s_cbranch_scc0 SK_pr5
  s_setprio 0
SK_pr5:
  v_mfma_f32_32x32x16_bf16 v[164:179], v[212:215], v[66:69], 0
  v_exp_f32 v148, v148
  v_exp_f32 v149, v149
  v_exp_f32 v150, v150
  v_exp_f32 v151, v151
  v_mfma_f32_32x32x8_bf16 v[164:179], v[216:217], v[70:71], v[164:179]
  v_exp_f32 v152, v152
  v_exp_f32 v153, v153
  v_exp_f32 v154, v154
  v_exp_f32 v155, v155
  v_smfmac_f32_32x32x32_bf16 v[132:147], v[236:239], v[204:211], v3
  s_and_b64 s[24:25], s[100:101], s[34:35]
  s_cmp_eq_u64 s[24:25], s[34:35]
  s_cbranch_scc1 SK_kl5
  global_load_dwordx2 v[240:241], v248, s[60:61] sc1
SK_kl5:
  s_add_u32 s66, s66, 3584
  s_addc_u32 s67, s67, 0
  global_load_dwordx4 v[226:229], v0, s[66:67] sc1
  global_load_dwordx2 v[230:231], v5, s[66:67] sc1
  global_load_dwordx4 v[232:235], v4, s[66:67] offset:1536 sc1
  global_load_dwordx4 v[236:239], v4, s[66:67] offset:2560 sc1
  s_mov_b32 m0, s77
  s_nop 0
  global_load_lds_dwordx4 v252, s[68:69] offset:2048
  v_exp_f32 v156, v156
  v_exp_f32 v157, v157
  v_exp_f32 v158, v158
  v_exp_f32 v159, v159
  v_smfmac_f32_32x32x32_bf16 v[84:99], v[218:221], v[148:155], v3
  v_exp_f32 v160, v160
  v_exp_f32 v161, v161
  v_exp_f32 v162, v162
  v_exp_f32 v163, v163
  v_mfma_f32_32x32x16_bf16 v[180:195], v[212:215], v[72:75], 0
  v_exp_f32 v164, v164
  v_exp_f32 v165, v165
  v_exp_f32 v166, v166
  v_exp_f32 v167, v167
  v_mfma_f32_32x32x8_bf16 v[180:195], v[216:217], v[76:77], v[180:195]
  v_exp_f32 v168, v168
  v_exp_f32 v169, v169
  v_exp_f32 v170, v170
  v_exp_f32 v171, v171
  v_smfmac_f32_32x32x32_bf16 v[84:99], v[222:225], v[156:163], v3
  v_exp_f32 v172, v172
  v_exp_f32 v173, v173
  v_exp_f32 v174, v174
  v_exp_f32 v175, v175
  v_smfmac_f32_32x32x32_bf16 v[100:115], v[218:221], v[164:171], v3
  v_exp_f32 v176, v176
  v_exp_f32 v177, v177
  v_exp_f32 v178, v178
  v_exp_f32 v179, v179
  v_mfma_f32_32x32x16_bf16 v[196:211], v[212:215], v[78:81], 0
  v_exp_f32 v180, v180
  v_exp_f32 v181, v181
  v_exp_f32 v182, v182
  v_exp_f32 v183, v183
  v_mfma_f32_32x32x8_bf16 v[196:211], v[216:217], v[82:83], v[196:211]
  v_exp_f32 v184, v184
  v_exp_f32 v185, v185
  v_exp_f32 v186, v186
  v_exp_f32 v187, v187
  v_smfmac_f32_32x32x32_bf16 v[100:115], v[222:225], v[172:179], v3
  v_exp_f32 v188, v188
  v_exp_f32 v189, v189
  v_exp_f32 v190, v190
  v_exp_f32 v191, v191
  v_smfmac_f32_32x32x32_bf16 v[116:131], v[218:221], v[180:187], v3
  v_exp_f32 v192, v192
  v_exp_f32 v193, v193
  v_exp_f32 v194, v194
  v_exp_f32 v195, v195
  s_waitcnt vmcnt(1)
  v_mfma_f32_32x32x16_bf16 v[148:163], v[226:229], v[60:63], 0
  v_exp_f32 v196, v196
  v_exp_f32 v197, v197
  v_exp_f32 v198, v198
  v_exp_f32 v199, v199
  v_mfma_f32_32x32x8_bf16 v[148:163], v[230:231], v[64:65], v[148:163]
  v_exp_f32 v200, v200
  v_exp_f32 v201, v201
  v_exp_f32 v202, v202
  v_exp_f32 v203, v203
  v_smfmac_f32_32x32x32_bf16 v[116:131], v[222:225], v[188:195], v3
  v_exp_f32 v204, v204
  v_exp_f32 v205, v205
  v_exp_f32 v206, v206
  v_exp_f32 v207, v207
  v_smfmac_f32_32x32x32_bf16 v[132:147], v[218:221], v[196:203], v3
  v_exp_f32 v208, v208
  v_exp_f32 v209, v209
  v_exp_f32 v210, v210
  v_exp_f32 v211, v211
  v_mfma_f32_32x32x16_bf16 v[164:179], v[226:229], v[66:69], 0
  v_exp_f32 v148, v148
  v_exp_f32 v149, v149
  v_exp_f32 v150, v150
  v_exp_f32 v151, v151
  v_mfma_f32_32x32x8_bf16 v[164:179], v[230:231], v[70:71], v[164:179]
  v_exp_f32 v152, v152
  v_exp_f32 v153, v153
  v_exp_f32 v154, v154
  v_exp_f32 v155, v155
  v_smfmac_f32_32x32x32_bf16 v[132:147], v[222:225], v[204:211], v3
  s_and_b64 s[24:25], s[100:101], s[34:35]
  s_cmp_eq_u64 s[24:25], s[34:35]
  s_cbranch_scc1 SK_nb05
  v_cmp_eq_u32 vcc, v249, v240
  v_cmp_eq_u32 s[24:25], v249, v241
  s_nop 0
  s_and_b64 s[24:25], s[24:25], vcc
  s_lshr_b64 s[26:27], s[24:25], 4
  s_and_b64 s[24:25], s[24:25], s[26:27]
  s_lshr_b64 s[26:27], s[24:25], 2
  s_and_b64 s[24:25], s[24:25], s[26:27]
  s_lshr_b64 s[26:27], s[24:25], 1
  s_and_b64 s[24:25], s[24:25], s[26:27]
  s_mov_b64 s[100:101], s[24:25]
  s_and_b64 s[24:25], s[24:25], s[34:35]
  s_cbranch_scc1 SK_nb05
  s_mov_b32 s20, 0
L_nbp05:
  global_load_dwordx2 v[240:241], v248, s[60:61] sc1
  s_waitcnt vmcnt(0)
  v_cmp_eq_u32 vcc, v249, v240
  v_cmp_eq_u32 s[24:25], v249, v241
  s_nop 0
  s_and_b64 s[24:25], s[24:25], vcc
  s_lshr_b64 s[26:27], s[24:25], 4
  s_and_b64 s[24:25], s[24:25], s[26:27]
  s_lshr_b64 s[26:27], s[24:25], 2
  s_and_b64 s[24:25], s[24:25], s[26:27]
  s_lshr_b64 s[26:27], s[24:25], 1
  s_and_b64 s[24:25], s[24:25], s[26:27]
  s_mov_b64 s[100:101], s[24:25]
  s_and_b64 s[24:25], s[24:25], s[34:35]
  s_cbranch_scc1 SK_nb05
  s_add_u32 s20, s20, 1
  s_cmp_lt_u32 s20, s9
  s_cbranch_scc1 L_nbp05
  s_mov_b32 s9, 0
  s_mov_b64 s[24:25], s[34:35]
SK_nb05:
  s_ff1_i32_b64 s20, s[24:25]
  s_bitset0_b64 s[34:35], s20
  s_mul_i32 s20, s20, 3584
  s_add_u32 s66, s62, s20
  s_addc_u32 s67, s63, 0
  global_load_dwordx4 v[212:215], v0, s[66:67] sc1
  global_load_dwordx2 v[216:217], v5, s[66:67] sc1
  global_load_dwordx4 v[218:221], v4, s[66:67] offset:1536 sc1
  global_load_dwordx4 v[222:225], v4, s[66:67] offset:2560 sc1
  s_cmp_eq_u32 s8, 0
  s_cbranch_scc0 SK_l_20
  s_cmp_lt_u32 s75, 40
  s_cbranch_scc1 SK_fd05
  global_load_dword v255, v2, s[54:55]
  s_branch SK_fe05
SK_fd05:
  s_lshl_b32 s20, s75, 5
  s_add_u32 s64, s54, s20
  s_addc_u32 s65, s55, 0
  s_add_u32 s64, s64, 204800
  s_addc_u32 s65, s65, 0
  s_mul_i32 s20, s6, 6912
  s_add_u32 m0, s20, 76800
  s_nop 0
  global_load_lds_dwordx4 v9, s[64:65]
SK_fe05:
SK_l_20:
  v_exp_f32 v156, v156
  v_exp_f32 v157, v157
  v_exp_f32 v158, v158
  v_exp_f32 v159, v159
  v_smfmac_f32_32x32x32_bf16 v[84:99], v[232:235], v[148:155], v3
  v_exp_f32 v160, v160
  v_exp_f32 v161, v161
  v_exp_f32 v162, v162
  v_exp_f32 v163, v163
  v_mfma_f32_32x32x16_bf16 v[180:195], v[226:229], v[72:75], 0
  v_exp_f32 v164, v164
  v_exp_f32 v165, v165
  v_exp_f32 v166, v166
  v_exp_f32 v167, v167
  v_mfma_f32_32x32x8_bf16 v[180:195], v[230:231], v[76:77], v[180:195]
  v_exp_f32 v168, v168
  v_exp_f32 v169, v169
  v_exp_f32 v170, v170
  v_exp_f32 v171, v171
  v_smfmac_f32_32x32x32_bf16 v[84:99], v[236:239], v[156:163], v3
  v_exp_f32 v172, v172
  v_exp_f32 v173, v173
  v_exp_f32 v174, v174
  v_exp_f32 v175, v175
  v_smfmac_f32_32x32x32_bf16 v[100:115], v[232:235], v[164:171], v3
  v_exp_f32 v176, v176
  v_exp_f32 v177, v177
  v_exp_f32 v178, v178
  v_exp_f32 v179, v179
  v_mfma_f32_32x32x16_bf16 v[196:211], v[226:229], v[78:81], 0
  v_exp_f32 v180, v180
  v_exp_f32 v181, v181
  v_exp_f32 v182, v182
  v_exp_f32 v183, v183
  v_mfma_f32_32x32x8_bf16 v[196:211], v[230:231], v[82:83], v[196:211]
  v_exp_f32 v184, v184
  v_exp_f32 v185, v185
  v_exp_f32 v186, v186
  v_exp_f32 v187, v187
  v_smfmac_f32_32x32x32_bf16 v[100:115], v[236:239], v[172:179], v3
  v_exp_f32 v188, v188
  v_exp_f32 v189, v189
  v_exp_f32 v190, v190
  v_exp_f32 v191, v191
  v_smfmac_f32_32x32x32_bf16 v[116:131], v[232:235], v[180:187], v3
  v_exp_f32 v192, v192
  v_exp_f32 v193, v193
  v_exp_f32 v194, v194
  v_exp_f32 v195, v195
  s_waitcnt vmcnt(1)
  s_cmp_eq_u32 s8, 1
  s_cbranch_scc0 SK_l_21
  s_waitcnt vmcnt(0)
SK_l_21:
  v_mfma_f32_32x32x16_bf16 v[148:163], v[212:215], v[60:63], 0
  v_exp_f32 v196, v196
  v_exp_f32 v197, v197
  v_exp_f32 v198, v198
  v_exp_f32 v199, v199
  v_mfma_f32_32x32x8_bf16 v[148:163], v[216:217], v[64:65], v[148:163]
  v_exp_f32 v200, v200
  v_exp_f32 v201, v201
  v_exp_f32 v202, v202
  v_exp_f32 v203, v203
  v_smfmac_f32_32x32x32_bf16 v[116:131], v[236:239], v[188:195], v3
  v_exp_f32 v204, v204
  v_exp_f32 v205, v205
  v_exp_f32 v206, v206
  v_exp_f32 v207, v207
  v_smfmac_f32_32x32x32_bf16 v[132:147], v[232:235], v[196:203], v3
  v_exp_f32 v208, v208
  v_exp_f32 v209, v209
  v_exp_f32 v210, v210
  v_exp_f32 v211, v211
  v_mfma_f32_32x32x16_bf16 v[164:179], v[212:215], v[66:69], 0
  v_exp_f32 v148, v148
  v_exp_f32 v149, v149
  v_exp_f32 v150, v150
  v_exp_f32 v151, v151
  v_mfma_f32_32x32x8_bf16 v[164:179], v[216:217], v[70:71], v[164:179]
  v_exp_f32 v152, v152
  v_exp_f32 v153, v153
  v_exp_f32 v154, v154
  v_exp_f32 v155, v155
  v_smfmac_f32_32x32x32_bf16 v[132:147], v[236:239], v[204:211], v3
  s_and_b64 s[24:25], s[100:101], s[34:35]
  s_cmp_eq_u64 s[24:25], s[34:35]
  s_cbranch_scc1 SK_kl6
  global_load_dwordx2 v[240:241], v248, s[60:61] sc1
SK_kl6:
  s_add_u32 s66, s66, 3584
  s_addc_u32 s67, s67, 0
  global_load_dwordx4 v[226:229], v0, s[66:67] sc1
  global_load_dwordx2 v[230:231], v5, s[66:67] sc1
  global_load_dwordx4 v[232:235], v4, s[66:67] offset:1536 sc1
  global_load_dwordx4 v[236:239], v4, s[66:67] offset:2560 sc1
  s_mov_b32 m0, s77
  s_nop 0
  global_load_lds_dwordx4 v253, s[68:69] offset:3072
  v_exp_f32 v156, v156
  v_exp_f32 v157, v157
  v_exp_f32 v158, v158
  v_exp_f32 v159, v159
  v_smfmac_f32_32x32x32_bf16 v[84:99], v[218:221], v[148:155], v3
  v_exp_f32 v160, v160
  v_exp_f32 v161, v161
  v_exp_f32 v162, v162
  v_exp_f32 v163, v163
  v_mfma_f32_32x32x16_bf16 v[180:195], v[212:215], v[72:75], 0
  v_exp_f32 v164, v164
  v_exp_f32 v165, v165
  v_exp_f32 v166, v166
  v_exp_f32 v167, v167
  v_mfma_f32_32x32x8_bf16 v[180:195], v[216:217], v[76:77], v[180:195]
  v_exp_f32 v168, v168
  v_exp_f32 v169, v169
  v_exp_f32 v170, v170
  v_exp_f32 v171, v171
  v_smfmac_f32_32x32x32_bf16 v[84:99], v[222:225], v[156:163], v3
  v_exp_f32 v172, v172
  v_exp_f32 v173, v173
  v_exp_f32 v174, v174
  v_exp_f32 v175, v175
  v_smfmac_f32_32x32x32_bf16 v[100:115], v[218:221], v[164:171], v3
  v_exp_f32 v176, v176
  v_exp_f32 v177, v177
  v_exp_f32 v178, v178
  v_exp_f32 v179, v179
  v_mfma_f32_32x32x16_bf16 v[196:211], v[212:215], v[78:81], 0
  v_exp_f32 v180, v180
  v_exp_f32 v181, v181
  v_exp_f32 v182, v182
  v_exp_f32 v183, v183
  v_mfma_f32_32x32x8_bf16 v[196:211], v[216:217], v[82:83], v[196:211]
  v_exp_f32 v184, v184
  v_exp_f32 v185, v185
  v_exp_f32 v186, v186
  v_exp_f32 v187, v187
  v_smfmac_f32_32x32x32_bf16 v[100:115], v[222:225], v[172:179], v3
  v_exp_f32 v188, v188
  v_exp_f32 v189, v189
  v_exp_f32 v190, v190
  v_exp_f32 v191, v191
  v_smfmac_f32_32x32x32_bf16 v[116:131], v[218:221], v[180:187], v3
  v_exp_f32 v192, v192
  v_exp_f32 v193, v193
  v_exp_f32 v194, v194
  v_exp_f32 v195, v195
  s_waitcnt vmcnt(1)
  v_mfma_f32_32x32x16_bf16 v[148:163], v[226:229], v[60:63], 0
  v_exp_f32 v196, v196
  v_exp_f32 v197, v197
  v_exp_f32 v198, v198
  v_exp_f32 v199, v199
  v_mfma_f32_32x32x8_bf16 v[148:163], v[230:231], v[64:65], v[148:163]
  v_exp_f32 v200, v200
  v_exp_f32 v201, v201
  v_exp_f32 v202, v202
  v_exp_f32 v203, v203
  v_smfmac_f32_32x32x32_bf16 v[116:131], v[222:225], v[188:195], v3
  v_exp_f32 v204, v204
  v_exp_f32 v205, v205
  v_exp_f32 v206, v206
  v_exp_f32 v207, v207
  v_smfmac_f32_32x32x32_bf16 v[132:147], v[218:221], v[196:203], v3
  v_exp_f32 v208, v208
  v_exp_f32 v209, v209
  v_exp_f32 v210, v210
  v_exp_f32 v211, v211
  v_mfma_f32_32x32x16_bf16 v[164:179], v[226:229], v[66:69], 0
  v_exp_f32 v148, v148
  v_exp_f32 v149, v149
  v_exp_f32 v150, v150
  v_exp_f32 v151, v151
  v_mfma_f32_32x32x8_bf16 v[164:179], v[230:231], v[70:71], v[164:179]
  v_exp_f32 v152, v152
  v_exp_f32 v153, v153
  v_exp_f32 v154, v154
  v_exp_f32 v155, v155
  v_smfmac_f32_32x32x32_bf16 v[132:147], v[222:225], v[204:211], v3
  s_and_b64 s[24:25], s[100:101], s[34:35]
  s_cmp_eq_u64 s[24:25], s[34:35]
  s_cbranch_scc1 SK_nb06
  v_cmp_eq_u32 vcc, v249, v240
  v_cmp_eq_u32 s[24:25], v249, v241
  s_nop 0
  s_and_b64 s[24:25], s[24:25], vcc
  s_lshr_b64 s[26:27], s[24:25], 4
  s_and_b64 s[24:25], s[24:25], s[26:27]
  s_lshr_b64 s[26:27], s[24:25], 2
  s_and_b64 s[24:25], s[24:25], s[26:27]
  s_lshr_b64 s[26:27], s[24:25], 1
  s_and_b64 s[24:25], s[24:25], s[26:27]
  s_mov_b64 s[100:101], s[24:25]
  s_and_b64 s[24:25], s[24:25], s[34:35]
  s_cbranch_scc1 SK_nb06
  s_mov_b32 s20, 0
L_nbp06:
  global_load_dwordx2 v[240:241], v248, s[60:61] sc1
  s_waitcnt vmcnt(0)
  v_cmp_eq_u32 vcc, v249, v240
  v_cmp_eq_u32 s[24:25], v249, v241
  s_nop 0
  s_and_b64 s[24:25], s[24:25], vcc
  s_lshr_b64 s[26:27], s[24:25], 4
  s_and_b64 s[24:25], s[24:25], s[26:27]
  s_lshr_b64 s[26:27], s[24:25], 2
  s_and_b64 s[24:25], s[24:25], s[26:27]
  s_lshr_b64 s[26:27], s[24:25], 1
  s_and_b64 s[24:25], s[24:25], s[26:27]
  s_mov_b64 s[100:101], s[24:25]
  s_and_b64 s[24:25], s[24:25], s[34:35]
  s_cbranch_scc1 SK_nb06
  s_add_u32 s20, s20, 1
  s_cmp_lt_u32 s20, s9
  s_cbranch_scc1 L_nbp06
  s_mov_b32 s9, 0
  s_mov_b64 s[24:25], s[34:35]
SK_nb06:
  s_ff1_i32_b64 s20, s[24:25]
  s_bitset0_b64 s[34:35], s20
  s_mul_i32 s20, s20, 3584
  s_add_u32 s66, s62, s20
  s_addc_u32 s67, s63, 0
  global_load_dwordx4 v[212:215], v0, s[66:67] sc1
  global_load_dwordx2 v[216:217], v5, s[66:67] sc1
  global_load_dwordx4 v[218:221], v4, s[66:67] offset:1536 sc1
  global_load_dwordx4 v[222:225], v4, s[66:67] offset:2560 sc1
  s_cmp_eq_u32 s8, 0
  s_cbranch_scc0 SK_l_22
  s_cmp_lt_u32 s75, 40
  s_cbranch_scc1 SK_fd06
  s_lshl_b32 s20, s74, 4
  s_add_u32 s64, s52, s20
  s_addc_u32 s65, s53, 0
  s_add_u32 s64, s64, 220160
  s_addc_u32 s65, s65, 0
  s_mul_i32 s20, s6, 1280
  s_add_u32 m0, s20, 81920
  s_mov_b64 exec, 0xffff
  global_load_lds_dwordx4 v8, s[64:65] offset:1024
  s_mov_b64 exec, -1
  s_branch SK_fe06
SK_fd06:
  s_lshl_b32 s20, s75, 5
  s_add_u32 s64, s54, s20
  s_addc_u32 s65, s55, 0
  s_add_u32 s64, s64, 245760
  s_addc_u32 s65, s65, 0
  s_mul_i32 s20, s6, 6912
  s_add_u32 m0, s20, 77824
  s_mov_b32 exec_hi, 0xffff
  global_load_lds_dwordx4 v9, s[64:65]
  s_mov_b64 exec, -1
SK_fe06:
SK_l_22:
  v_exp_f32 v156, v156
  v_exp_f32 v157, v157
  v_exp_f32 v158, v158
  v_exp_f32 v159, v159
  v_smfmac_f32_32x32x32_bf16 v[84:99], v[232:235], v[148:155], v3
  v_exp_f32 v160, v160
  v_exp_f32 v161, v161
  v_exp_f32 v162, v162
  v_exp_f32 v163, v163
  v_mfma_f32_32x32x16_bf16 v[180:195], v[226:229], v[72:75], 0
  v_exp_f32 v164, v164
  v_exp_f32 v165, v165
  v_exp_f32 v166, v166
  v_exp_f32 v167, v167
  v_mfma_f32_32x32x8_bf16 v[180:195], v[230:231], v[76:77], v[180:195]
  v_exp_f32 v168, v168
  v_exp_f32 v169, v169
  v_exp_f32 v170, v170
  v_exp_f32 v171, v171
  v_smfmac_f32_32x32x32_bf16 v[84:99], v[236:239], v[156:163], v3
  v_exp_f32 v172, v172
  v_exp_f32 v173, v173
  v_exp_f32 v174, v174
  v_exp_f32 v175, v175
  v_smfmac_f32_32x32x32_bf16 v[100:115], v[232:235], v[164:171], v3
  v_exp_f32 v176, v176
  v_exp_f32 v177, v177
  v_exp_f32 v178, v178
  v_exp_f32 v179, v179
  v_mfma_f32_32x32x16_bf16 v[196:211], v[226:229], v[78:81], 0
  v_exp_f32 v180, v180
  v_exp_f32 v181, v181
  v_exp_f32 v182, v182
  v_exp_f32 v183, v183
  v_mfma_f32_32x32x8_bf16 v[196:211], v[230:231], v[82:83], v[196:211]
  v_exp_f32 v184, v184
  v_exp_f32 v185, v185
  v_exp_f32 v186, v186
  v_exp_f32 v187, v187
  v_smfmac_f32_32x32x32_bf16 v[100:115], v[236:239], v[172:179], v3
  v_exp_f32 v188, v188
  v_exp_f32 v189, v189
  v_exp_f32 v190, v190
  v_exp_f32 v191, v191
  v_smfmac_f32_32x32x32_bf16 v[116:131], v[232:235], v[180:187], v3
  v_exp_f32 v192, v192
  v_exp_f32 v193, v193
  v_exp_f32 v194, v194
  v_exp_f32 v195, v195
  s_waitcnt vmcnt(1)
  s_cmp_eq_u32 s8, 1
  s_cbranch_scc0 SK_l_23
  s_waitcnt vmcnt(0)
SK_l_23:
  v_mfma_f32_32x32x16_bf16 v[148:163], v[212:215], v[60:63], 0
  v_exp_f32 v196, v196
  v_exp_f32 v197, v197
  v_exp_f32 v198, v198
  v_exp_f32 v199, v199
  v_mfma_f32_32x32x8_bf16 v[148:163], v[216:217], v[64:65], v[148:163]
  v_exp_f32 v200, v200
  v_exp_f32 v201, v201
  v_exp_f32 v202, v202
  v_exp_f32 v203, v203
  v_smfmac_f32_32x32x32_bf16 v[116:131], v[236:239], v[188:195], v3
  v_exp_f32 v204, v204
  v_exp_f32 v205, v205
  v_exp_f32 v206, v206
  v_exp_f32 v207, v207
  v_smfmac_f32_32x32x32_bf16 v[132:147], v[232:235], v[196:203], v3
  v_exp_f32 v208, v208
  v_exp_f32 v209, v209
  v_exp_f32 v210, v210
  v_exp_f32 v211, v211
  v_mfma_f32_32x32x16_bf16 v[164:179], v[212:215], v[66:69], 0
  v_exp_f32 v148, v148
  v_exp_f32 v149, v149
  v_exp_f32 v150, v150
  v_exp_f32 v151, v151
  v_mfma_f32_32x32x8_bf16 v[164:179], v[216:217], v[70:71], v[164:179]
  v_exp_f32 v152, v152
  v_exp_f32 v153, v153
  v_exp_f32 v154, v154
  v_exp_f32 v155, v155
  v_smfmac_f32_32x32x32_bf16 v[132:147], v[236:239], v[204:211], v3
  s_add_u32 s66, s66, 3584
  s_addc_u32 s67, s67, 0
  global_load_dwordx4 v[226:229], v0, s[66:67] sc1
  global_load_dwordx2 v[230:231], v5, s[66:67] sc1
  global_load_dwordx4 v[232:235], v4, s[66:67] offset:1536 sc1
  global_load_dwordx4 v[236:239], v4, s[66:67] offset:2560 sc1
  s_add_u32 m0, s77, 4096
  s_nop 0
  global_load_lds_dwordx4 v254, s[68:69]
  v_exp_f32 v156, v156
  v_exp_f32 v157, v157
  v_exp_f32 v158, v158
  v_exp_f32 v159, v159
  v_smfmac_f32_32x32x32_bf16 v[84:99], v[218:221], v[148:155], v3
  v_exp_f32 v160, v160
  v_exp_f32 v161, v161
  v_exp_f32 v162, v162
  v_exp_f32 v163, v163
  v_mfma_f32_32x32x16_bf16 v[180:195], v[212:215], v[72:75], 0
  v_exp_f32 v164, v164
  v_exp_f32 v165, v165
  v_exp_f32 v166, v166
  v_exp_f32 v167, v167
  v_mfma_f32_32x32x8_bf16 v[180:195], v[216:217], v[76:77], v[180:195]
  v_exp_f32 v168, v168
  v_exp_f32 v169, v169
  v_exp_f32 v170, v170
  v_exp_f32 v171, v171
  v_smfmac_f32_32x32x32_bf16 v[84:99], v[222:225], v[156:163], v3
  v_exp_f32 v172, v172
  v_exp_f32 v173, v173
  v_exp_f32 v174, v174
  v_exp_f32 v175, v175
  v_smfmac_f32_32x32x32_bf16 v[100:115], v[218:221], v[164:171], v3
  v_exp_f32 v176, v176
  v_exp_f32 v177, v177
  v_exp_f32 v178, v178
  v_exp_f32 v179, v179
  v_mfma_f32_32x32x16_bf16 v[196:211], v[212:215], v[78:81], 0
  v_exp_f32 v180, v180
  v_exp_f32 v181, v181
  v_exp_f32 v182, v182
  v_exp_f32 v183, v183
  v_mfma_f32_32x32x8_bf16 v[196:211], v[216:217], v[82:83], v[196:211]
  v_exp_f32 v184, v184
  v_exp_f32 v185, v185
  v_exp_f32 v186, v186
  v_exp_f32 v187, v187
  v_smfmac_f32_32x32x32_bf16 v[100:115], v[222:225], v[172:179], v3
  v_exp_f32 v188, v188
  v_exp_f32 v189, v189
  v_exp_f32 v190, v190
  v_exp_f32 v191, v191
  v_smfmac_f32_32x32x32_bf16 v[116:131], v[218:221], v[180:187], v3
  v_exp_f32 v192, v192
  v_exp_f32 v193, v193
  v_exp_f32 v194, v194
  v_exp_f32 v195, v195
  s_waitcnt vmcnt(1)
  v_mfma_f32_32x32x16_bf16 v[148:163], v[226:229], v[60:63], 0
  v_exp_f32 v196, v196
  v_exp_f32 v197, v197
  v_exp_f32 v198, v198
  v_exp_f32 v199, v199
  v_mfma_f32_32x32x8_bf16 v[148:163], v[230:231], v[64:65], v[148:163]
  v_exp_f32 v200, v200
  v_exp_f32 v201, v201
  v_exp_f32 v202, v202
  v_exp_f32 v203, v203
  v_smfmac_f32_32x32x32_bf16 v[116:131], v[222:225], v[188:195], v3
  v_exp_f32 v204, v204
  v_exp_f32 v205, v205
  v_exp_f32 v206, v206
  v_exp_f32 v207, v207
  v_smfmac_f32_32x32x32_bf16 v[132:147], v[218:221], v[196:203], v3
  v_exp_f32 v208, v208
  v_exp_f32 v209, v209
  v_exp_f32 v210, v210
  v_exp_f32 v211, v211
  v_mfma_f32_32x32x16_bf16 v[164:179], v[226:229], v[66:69], 0
  v_exp_f32 v148, v148
  v_exp_f32 v149, v149
  v_exp_f32 v150, v150
  v_exp_f32 v151, v151
  v_mfma_f32_32x32x8_bf16 v[164:179], v[230:231], v[70:71], v[164:179]
  v_exp_f32 v152, v152
  v_exp_f32 v153, v153
  v_exp_f32 v154, v154
  v_exp_f32 v155, v155
  v_smfmac_f32_32x32x32_bf16 v[132:147], v[222:225], v[204:211], v3
  v_exp_f32 v156, v156
  v_exp_f32 v157, v157
  v_exp_f32 v158, v158
  v_exp_f32 v159, v159
  v_smfmac_f32_32x32x32_bf16 v[84:99], v[232:235], v[148:155], v3
  v_exp_f32 v160, v160
  v_exp_f32 v161, v161
  v_exp_f32 v162, v162
  v_exp_f32 v163, v163
  v_mfma_f32_32x32x16_bf16 v[180:195], v[226:229], v[72:75], 0
  v_exp_f32 v164, v164
  v_exp_f32 v165, v165
  v_exp_f32 v166, v166
  v_exp_f32 v167, v167
  v_mfma_f32_32x32x8_bf16 v[180:195], v[230:231], v[76:77], v[180:195]
  v_exp_f32 v168, v168
  v_exp_f32 v169, v169
  v_exp_f32 v170, v170
  v_exp_f32 v171, v171
  v_smfmac_f32_32x32x32_bf16 v[84:99], v[236:239], v[156:163], v3
  v_exp_f32 v172, v172
  v_exp_f32 v173, v173
  v_exp_f32 v174, v174
  v_exp_f32 v175, v175
  v_smfmac_f32_32x32x32_bf16 v[100:115], v[232:235], v[164:171], v3
  v_exp_f32 v176, v176
  v_exp_f32 v177, v177
  v_exp_f32 v178, v178
  v_exp_f32 v179, v179
  v_mfma_f32_32x32x16_bf16 v[196:211], v[226:229], v[78:81], 0
  v_exp_f32 v180, v180
  v_exp_f32 v181, v181
  v_exp_f32 v182, v182
  v_exp_f32 v183, v183
  v_mfma_f32_32x32x8_bf16 v[196:211], v[230:231], v[82:83], v[196:211]
  v_exp_f32 v184, v184
  v_exp_f32 v185, v185
  v_exp_f32 v186, v186
  v_exp_f32 v187, v187
  v_smfmac_f32_32x32x32_bf16 v[100:115], v[236:239], v[172:179], v3
  v_exp_f32 v188, v188
  v_exp_f32 v189, v189
  v_exp_f32 v190, v190
  v_exp_f32 v191, v191
  v_smfmac_f32_32x32x32_bf16 v[116:131], v[232:235], v[180:187], v3
  v_exp_f32 v192, v192
  v_exp_f32 v193, v193
  v_exp_f32 v194, v194
  v_exp_f32 v195, v195
  v_exp_f32 v196, v196
  v_exp_f32 v197, v197
  v_exp_f32 v198, v198
  v_exp_f32 v199, v199
  v_exp_f32 v200, v200
  v_exp_f32 v201, v201
  v_exp_f32 v202, v202
  v_exp_f32 v203, v203
  v_smfmac_f32_32x32x32_bf16 v[116:131], v[236:239], v[188:195], v3
  v_exp_f32 v204, v204
  v_exp_f32 v205, v205
  v_exp_f32 v206, v206
  v_exp_f32 v207, v207
  v_smfmac_f32_32x32x32_bf16 v[132:147], v[232:235], v[196:203], v3
  v_exp_f32 v208, v208
  v_exp_f32 v209, v209
  v_exp_f32 v210, v210
  v_exp_f32 v211, v211
  s_nop 1
  v_smfmac_f32_32x32x32_bf16 v[132:147], v[236:239], v[204:211], v3
  s_setprio 0
  s_nop 10
L_att_end:
  s_cmp_eq_u32 s8, 0
  s_cbranch_scc0 L_noffr
  s_waitcnt vmcnt(0)
  s_barrier
  v_bfe_u32 v6, v1, 2, 2
  v_lshrrev_b32 v7, 4, v1
  s_cmp_ge_u32 s6, 6
  s_cbranch_scc1 SK_ffr_gu
  v_lshl_add_u32 v6, v7, 3, v6
  v_lshlrev_b32 v6, 5, v6
  v_and_b32 v7, 3, v1
  v_lshl_add_u32 v6, v7, 3, v6
  s_mul_i32 s20, s6, 9216
  s_add_u32 s20, s20, 71680
  v_add_u32 v6, s20, v6
  ds_read_b64_tr_b16 v[20:21], v6 offset:0
  ds_read_b64_tr_b16 v[22:23], v6 offset:128
  ds_read_b64_tr_b16 v[24:25], v6 offset:1024
  ds_read_b64_tr_b16 v[26:27], v6 offset:1152
  ds_read_b64_tr_b16 v[28:29], v6 offset:2048
  ds_read_b64_tr_b16 v[30:31], v6 offset:2176
  ds_read_b64_tr_b16 v[32:33], v6 offset:3072
  ds_read_b64_tr_b16 v[34:35], v6 offset:3200
  ds_read_b64_tr_b16 v[36:37], v6 offset:4096
  ds_read_b64_tr_b16 v[38:39], v6 offset:4224
  ds_read_b64_tr_b16 v[40:41], v6 offset:5120
  ds_read_b64_tr_b16 v[42:43], v6 offset:5248
  ds_read_b64_tr_b16 v[44:45], v6 offset:6144
  ds_read_b64_tr_b16 v[46:47], v6 offset:6272
  ds_read_b64_tr_b16 v[48:49], v6 offset:7168
  ds_read_b64_tr_b16 v[50:51], v6 offset:7296
  ds_read_b64_tr_b16 v[52:53], v6 offset:8192
  ds_read_b64_tr_b16 v[54:55], v6 offset:8320
  s_branch SK_ffr_done
SK_ffr_gu:
  v_lshl_add_u32 v6, v7, 2, v6
  v_lshlrev_b32 v6, 4, v6
  v_and_b32 v7, 1, v1
  v_lshl_add_u32 v6, v7, 3, v6
  v_bfe_u32 v7, v1, 1, 1
  v_mul_u32_u24 v7, 10240, v7
  v_add_u32 v6, v6, v7
  s_sub_u32 s20, s6, 6
  s_mul_i32 s20, s20, 5120
  s_add_u32 s20, s20, 71680
  v_add_u32 v6, s20, v6
  ds_read_b64_tr_b16 v[20:21], v6 offset:0
  ds_read_b64_tr_b16 v[22:23], v6 offset:256
  ds_read_b64_tr_b16 v[24:25], v6 offset:512
  ds_read_b64_tr_b16 v[26:27], v6 offset:768
  ds_read_b64_tr_b16 v[28:29], v6 offset:1024
  ds_read_b64_tr_b16 v[30:31], v6 offset:1280
  ds_read_b64_tr_b16 v[32:33], v6 offset:1536
  ds_read_b64_tr_b16 v[34:35], v6 offset:1792
  ds_read_b64_tr_b16 v[36:37], v6 offset:2048
  ds_read_b64_tr_b16 v[38:39], v6 offset:2304
  ds_read_b64_tr_b16 v[40:41], v6 offset:2560
  ds_read_b64_tr_b16 v[42:43], v6 offset:2816
  ds_read_b64_tr_b16 v[44:45], v6 offset:3072
  ds_read_b64_tr_b16 v[46:47], v6 offset:3328
  ds_read_b64_tr_b16 v[48:49], v6 offset:3584
  ds_read_b64_tr_b16 v[50:51], v6 offset:3840
  ds_read_b64_tr_b16 v[52:53], v6 offset:4096
  ds_read_b64_tr_b16 v[54:55], v6 offset:4352
  ds_read_b64_tr_b16 v[56:57], v6 offset:4608
  ds_read_b64_tr_b16 v[58:59], v6 offset:4864
SK_ffr_done:
  s_waitcnt lgkmcnt(0)
  s_barrier
L_noffr:
  s_and_b32 s22, s6, 3
  s_lshr_b32 s23, s6, 2
  s_mul_i32 s23, s23, 36864
  s_add_u32 s23, s23, 71680
  s_cmp_eq_u32 s22, 0
  s_cbranch_scc1 L_mown0
  s_sub_u32 s20, s22, 1
  s_and_b32 s20, s20, 3
  s_add_u32 s20, s20, 0
  s_mul_i32 s20, s20, 3072
  s_add_u32 s20, s20, s23
  v_add_u32 v6, s20, v0
  ds_write_b128 v6, v[84:87] offset:0
  ds_write_b128 v6, v[88:91] offset:1024
  ds_write_b128 v6, v[92:95] offset:2048
  s_branch L_mnext0
L_mown0:
  v_mov_b32 v148, v84
  v_mov_b32 v149, v85
  v_mov_b32 v150, v86
  v_mov_b32 v151, v87
  v_mov_b32 v152, v88
  v_mov_b32 v153, v89
  v_mov_b32 v154, v90
  v_mov_b32 v155, v91
  v_mov_b32 v156, v92
  v_mov_b32 v157, v93
  v_mov_b32 v158, v94
  v_mov_b32 v159, v95
  s_nop 1
L_mnext0:
  s_cmp_eq_u32 s22, 1
  s_cbranch_scc1 L_mown1
  s_sub_u32 s20, s22, 2
  s_and_b32 s20, s20, 3
  s_add_u32 s20, s20, 3
  s_mul_i32 s20, s20, 3072
  s_add_u32 s20, s20, s23
  v_add_u32 v6, s20, v0
  ds_write_b128 v6, v[100:103] offset:0
  ds_write_b128 v6, v[104:107] offset:1024
  ds_write_b128 v6, v[108:111] offset:2048
  s_branch L_mnext1
L_mown1:
  v_mov_b32 v148, v100
  v_mov_b32 v149, v101
  v_mov_b32 v150, v102
  v_mov_b32 v151, v103
  v_mov_b32 v152, v104
  v_mov_b32 v153, v105
  v_mov_b32 v154, v106
  v_mov_b32 v155, v107
  v_mov_b32 v156, v108
  v_mov_b32 v157, v109
  v_mov_b32 v158, v110
  v_mov_b32 v159, v111
  s_nop 1
L_mnext1:
  s_cmp_eq_u32 s22, 2
  s_cbranch_scc1 L_mown2
  s_sub_u32 s20, s22, 3
  s_and_b32 s20, s20, 3
  s_add_u32 s20, s20, 6
  s_mul_i32 s20, s20, 3072
  s_add_u32 s20, s20, s23
  v_add_u32 v6, s20, v0
  ds_write_b128 v6, v[116:119] offset:0
  ds_write_b128 v6, v[120:123] offset:1024
  ds_write_b128 v6, v[124:127] offset:2048
  s_branch L_mnext2
L_mown2:
  v_mov_b32 v148, v116
  v_mov_b32 v149, v117
  v_mov_b32 v150, v118
  v_mov_b32 v151, v119
  v_mov_b32 v152, v120
  v_mov_b32 v153, v121
  v_mov_b32 v154, v122
  v_mov_b32 v155, v123
  v_mov_b32 v156, v124
  v_mov_b32 v157, v125
  v_mov_b32 v158, v126
  v_mov_b32 v159, v127
  s_nop 1
L_mnext2:
  s_cmp_eq_u32 s22, 3
  s_cbranch_scc1 L_mown3
  s_sub_u32 s20, s22, 4
  s_and_b32 s20, s20, 3
  s_add_u32 s20, s20, 9
  s_mul_i32 s20, s20, 3072
  s_add_u32 s20, s20, s23
  v_add_u32 v6, s20, v0
  ds_write_b128 v6, v[132:135] offset:0
  ds_write_b128 v6, v[136:139] offset:1024
  ds_write_b128 v6, v[140:143] offset:2048
  s_branch L_mnext3
L_mown3:
  v_mov_b32 v148, v132
  v_mov_b32 v149, v133
  v_mov_b32 v150, v134
  v_mov_b32 v151, v135
  v_mov_b32 v152, v136
  v_mov_b32 v153, v137
  v_mov_b32 v154, v138
  v_mov_b32 v155, v139
  v_mov_b32 v156, v140
  v_mov_b32 v157, v141
  v_mov_b32 v158, v142
  v_mov_b32 v159, v143
  s_nop 1
L_mnext3:
  s_mul_i32 s20, s22, 9216
  s_add_u32 s20, s20, s23
  v_add_u32 v10, s20, v0
  v_lshrrev_b32 v7, 5, v1
  s_mul_i32 s20, s22, 5
  v_lshl_add_u32 v7, v7, 1, s20
  v_and_b32 v6, 31, v1
  s_lshr_b32 s21, s6, 2
  s_mul_i32 s21, s21, 5120
  s_add_u32 s21, s21, 145408
  v_lshl_add_u32 v6, v6, 4, s21
  v_lshrrev_b32 v244, 1, v7
  v_lshl_add_u32 v240, v244, 9, v6
  v_and_b32 v244, 1, v7
  v_lshl_add_u32 v240, v244, 3, v240
  v_add_u32 v7, 1, v7
  v_lshrrev_b32 v244, 1, v7
  v_lshl_add_u32 v241, v244, 9, v6
  v_and_b32 v244, 1, v7
  v_lshl_add_u32 v241, v244, 3, v241
  s_add_u32 s20, s20, 4
  v_mov_b32 v7, s20
  v_lshrrev_b32 v244, 1, v7
  v_lshl_add_u32 v242, v244, 9, v6
  v_and_b32 v244, 1, v7
  v_lshl_add_u32 v242, v244, 3, v242
  s_mul_i32 s21, s8, 81920
  s_add_u32 s21, s21, 0
  s_mul_i32 s20, s5, 5120
  s_add_u32 s23, s21, s20
  s_cmp_ge_u32 s6, 5
  s_cselect_b32 s20, 35840, 0
  s_lshl_b32 s22, s6, 10
  s_add_u32 s20, s20, s22
  s_add_u32 s20, s20, s23
  s_add_u32 s64, s40, s20
  s_addc_u32 s65, s41, 0
  s_add_u32 s20, s23, s22
  s_add_u32 s20, s20, 44032
  s_add_u32 s66, s40, s20
  s_addc_u32 s67, s41, 0
  s_and_b32 s33, s6, 3
  s_lshl_b32 s33, s33, 11
  s_add_u32 s21, s21, s33
  s_add_u32 s68, s40, s21
  s_addc_u32 s69, s41, 0
  s_add_u32 s20, s22, 145408
  v_add_u32 v11, s20, v0
  v_mov_b32 v243, 0x207
  v_mov_b32 v7, 163208
  s_waitcnt lgkmcnt(0)
  s_barrier
  ds_read_b128 v[164:167], v10 offset:0
  ds_read_b128 v[168:171], v10 offset:1024
  ds_read_b128 v[172:175], v10 offset:2048
  ds_read_b128 v[176:179], v10 offset:3072
  ds_read_b128 v[180:183], v10 offset:4096
  ds_read_b128 v[184:187], v10 offset:5120
  ds_read_b128 v[188:191], v10 offset:6144
  ds_read_b128 v[192:195], v10 offset:7168
  ds_read_b128 v[196:199], v10 offset:8192
  s_waitcnt lgkmcnt(6)
  v_add_f32 v148, v148, v164
  v_add_f32 v149, v149, v165
  v_add_f32 v150, v150, v166
  v_add_f32 v151, v151, v167
  v_add_f32 v152, v152, v168
  v_add_f32 v153, v153, v169
  v_add_f32 v154, v154, v170
  v_add_f32 v155, v155, v171
  v_add_f32 v156, v156, v172
  v_add_f32 v157, v157, v173
  v_add_f32 v158, v158, v174
  v_add_f32 v159, v159, v175
  s_waitcnt lgkmcnt(3)
  v_add_f32 v148, v148, v176
  v_add_f32 v149, v149, v177
  v_add_f32 v150, v150, v178
  v_add_f32 v151, v151, v179
  v_add_f32 v152, v152, v180
  v_add_f32 v153, v153, v181
  v_add_f32 v154, v154, v182
  v_add_f32 v155, v155, v183
  v_add_f32 v156, v156, v184
  v_add_f32 v157, v157, v185
  v_add_f32 v158, v158, v186
  v_add_f32 v159, v159, v187
  s_waitcnt lgkmcnt(0)
  v_add_f32 v148, v148, v188
  v_add_f32 v149, v149, v189
  v_add_f32 v150, v150, v190
  v_add_f32 v151, v151, v191
  v_add_f32 v152, v152, v192
  v_add_f32 v153, v153, v193
  v_add_f32 v154, v154, v194
  v_add_f32 v155, v155, v195
  v_add_f32 v156, v156, v196
  v_add_f32 v157, v157, v197
  v_add_f32 v158, v158, v198
  v_add_f32 v159, v159, v199
  v_mov_b32 v245, v156
  v_mov_b32 v246, v156
  s_nop 1
  v_permlane32_swap_b32 v245, v246
  v_rcp_f32 v245, v246
  s_nop 0
  v_mul_f32 v148, v148, v245
  v_mul_f32 v149, v149, v245
  v_mul_f32 v150, v150, v245
  v_mul_f32 v151, v151, v245
  v_mul_f32 v152, v152, v245
  v_mul_f32 v153, v153, v245
  v_mul_f32 v154, v154, v245
  v_mul_f32 v155, v155, v245
  v_mul_f32 v156, v156, v245
  v_mul_f32 v157, v157, v245
  v_mul_f32 v158, v158, v245
  v_mul_f32 v159, v159, v245
  v_cvt_pk_bf16_f32 v164, v148, v149
  v_cvt_pk_bf16_f32 v165, v150, v151
  v_cvt_pk_bf16_f32 v166, v152, v153
  v_cvt_pk_bf16_f32 v167, v154, v155
  v_cvt_pk_bf16_f32 v168, v156, v157
  v_cvt_pk_bf16_f32 v169, v158, v159
  ds_write_b64 v240, v[164:165]
  ds_write_b64 v241, v[166:167]
  s_mov_b64 exec, 0xffffffff
  ds_write_b64 v242, v[168:169]
  s_mov_b64 exec, -1
  v_add_f32 v148, |v148|, |v149|
  v_add_f32 v150, |v150|, |v151|
  v_add_f32 v152, |v152|, |v153|
  v_add_f32 v154, |v154|, |v155|
  v_add_f32 v156, |v156|, |v157|
  v_add_f32 v158, |v158|, |v159|
  v_add_f32 v148, v148, v150
  v_add_f32 v152, v152, v154
  v_add_f32 v156, v156, v158
  v_add_f32 v148, v148, v152
  v_add_f32 v148, v148, v156
  s_mov_b32 s26, 0x1f800000
  s_mov_b32 s27, 0x5f800000
  v_cmp_nle_f32 s[24:25], s26, v246
  v_cmp_nge_f32 s[28:29], s27, v246
  v_cmp_class_f32 vcc, v148, v243
  s_or_b64 s[24:25], s[24:25], s[28:29]
  s_or_b64 vcc, vcc, s[24:25]
  s_nop 2
  s_cbranch_vccz L_notbad
  v_mov_b32 v6, 1
  ds_write_b32 v7, v6
  s_nop 0
L_notbad:
  s_waitcnt lgkmcnt(0)
  s_barrier
  ds_read_b32 v7, v7
  ds_read_b128 v[148:151], v11
  ds_read_b128 v[152:155], v11 offset:8192
  s_mul_i32 s21, s8, 32768
  s_add_u32 s21, s21, 589824
  s_and_b32 s20, s3, 0xf8
  s_lshl_b32 s20, s20, 7
  s_add_u32 s20, s20, s21
  v_and_b32 v6, 7, v1
  v_lshlrev_b32 v6, 7, v6
  v_add_u32 v6, s20, v6
  s_waitcnt lgkmcnt(2)
  v_readfirstlane_b32 s20, v7
  s_nop 0
  s_cmp_gt_u32 s20, s11
  s_nop 2
  s_cbranch_scc1 L_FALLBACK
  s_waitcnt lgkmcnt(0)
  global_store_dwordx4 v0, v[148:151], s[64:65] sc1
  s_cmp_lt_u32 s6, 2
  s_nop 0
  s_cbranch_scc0 L_ost
  global_store_dwordx4 v0, v[152:155], s[66:67] sc1
  s_nop 1
L_ost:
  v_mov_b32 v10, v6
  v_lshrrev_b32 v6, 4, v1
  v_and_b32 v6, 1, v6
  v_lshlrev_b32 v6, 2, v6
  v_and_b32 v7, 3, v1
  v_add_u32 v7, v7, v6
  v_lshrrev_b32 v8, 2, v7
  v_lshlrev_b32 v8, 2, v8
  v_and_b32 v9, 1, v7
  v_lshl_add_u32 v8, v9, 1, v8
  v_bfe_u32 v9, v7, 1, 1
  v_add_u32 v8, v8, v9
  s_lshl_b32 s20, s46, 3
  v_add_u32 v8, s20, v8
  v_subrev_u32 v9, 8, v8
  v_cmp_lt_u32 vcc, 19, v8
  s_nop 1
  v_cndmask_b32 v8, v8, v9, vcc
  v_lshrrev_b32 v6, 5, v1
  v_lshlrev_b32 v6, 3, v6
  v_bfe_u32 v7, v1, 2, 2
  v_lshl_add_u32 v6, v7, 1, v6
  v_mul_u32_u24 v6, 160, v6
  v_lshl_add_u32 v100, v8, 3, v6
  v_add_u32 v101, 40960, v100
  s_mul_i32 s20, s47, 40960
  s_add_u32 s20, s20, 71680
  v_add_u32 v102, s20, v0
  s_cmp_ge_u32 s6, 6
  s_cselect_b32 s20, 1024, 0
  s_cselect_b32 s23, 2560, 0
  v_add_u32 v102, s20, v102
  v_add_u32 v100, s23, v100
  v_add_u32 v101, s23, v101
  v_add_u32 v103, 71680, v100
  s_waitcnt vmcnt(0)
  s_barrier
  s_cmp_eq_u32 s6, 0
  s_cbranch_scc0 L_nofo
  s_lshl_b32 s20, s3, 7
  s_add_u32 s20, s20, s21
  v_mov_b32 v6, s20
  v_mov_b32 v7, s7
  s_mov_b64 exec, 1
  global_store_dword v6, v7, s[60:61] sc1
  v_mov_b32 v6, 163208
  v_mov_b32 v7, 0
  ds_write_b32 v6, v7
  s_mov_b64 exec, -1
L_nofo:
  s_cmp_ge_u32 s6, 4
  s_cbranch_scc1 L_o_half
  s_mul_i32 s21, s8, 81920
  s_add_u32 s21, s21, 163840
  s_mul_i32 s20, s47, 40960
  s_add_u32 s21, s21, s20
  s_mul_i32 s20, s5, 5120
  s_add_u32 s21, s21, s20
  s_lshl_b32 s20, s46, 11
  s_add_u32 s21, s21, s20
  s_add_u32 s66, s40, s21
  s_addc_u32 s67, s41, 0
  v_lshrrev_b32 v6, 5, v1
  v_lshlrev_b32 v6, 4, v6
  s_lshl_b32 s20, s46, 6
  s_add_u32 s20, s20, 163264
  v_add_u32 v6, s20, v6
  ds_read_b128 v[160:163], v6
  ds_read_b128 v[164:167], v6 offset:32
  v_and_b32 v6, 31, v1
  s_lshl_b32 s20, s47, 9
  s_lshl_b32 s21, s46, 10
  s_add_u32 s20, s20, s21
  s_add_u32 s20, s20, 71680
  v_lshl_add_u32 v67, v6, 4, s20
  s_lshl_b32 s20, s47, 11
  s_add_u32 s20, s20, 153600
  v_add_u32 v68, s20, v0
  v_mov_b32 v9, 0x3f803f80
  v_mov_b32 v60, 0
  v_mov_b32 v61, 0
  v_mov_b32 v62, 0
  s_waitcnt lgkmcnt(0)
  s_barrier
  ds_read_b128 v[132:135], v102 offset:0
  ds_read_b64_tr_b16 v[128:129], v100 offset:0
  ds_read_b64_tr_b16 v[130:131], v100 offset:160
  ds_read_b128 v[140:143], v102 offset:1024
  ds_read_b64_tr_b16 v[136:137], v100 offset:2560
  ds_read_b64_tr_b16 v[138:139], v100 offset:2720
  ds_read_b128 v[148:151], v102 offset:2048
  ds_read_b64_tr_b16 v[144:145], v100 offset:5120
  ds_read_b64_tr_b16 v[146:147], v100 offset:5280
  ds_read_b128 v[156:159], v102 offset:3072
  ds_read_b64_tr_b16 v[152:153], v100 offset:7680
  ds_read_b64_tr_b16 v[154:155], v100 offset:7840
  s_waitcnt lgkmcnt(9)
  v_mfma_f32_32x32x16_bf16 v[112:127], v[128:131], v[132:135], 0
  ds_read_b128 v[132:135], v102 offset:4096
  ds_read_b64_tr_b16 v[128:129], v100 offset:10240
  ds_read_b64_tr_b16 v[130:131], v100 offset:10400
  s_waitcnt lgkmcnt(9)
  v_mfma_f32_32x32x16_bf16 v[112:127], v[136:139], v[140:143], v[112:127]
  ds_read_b128 v[140:143], v102 offset:5120
  ds_read_b64_tr_b16 v[136:137], v100 offset:12800
  ds_read_b64_tr_b16 v[138:139], v100 offset:12960
  s_waitcnt lgkmcnt(9)
  v_mfma_f32_32x32x16_bf16 v[112:127], v[144:147], v[148:151], v[112:127]
  ds_read_b128 v[148:151], v102 offset:6144
  ds_read_b64_tr_b16 v[144:145], v100 offset:15360
  ds_read_b64_tr_b16 v[146:147], v100 offset:15520
  s_waitcnt lgkmcnt(9)
  v_mfma_f32_32x32x16_bf16 v[112:127], v[152:155], v[156:159], v[112:127]
  ds_read_b128 v[156:159], v102 offset:7168
  ds_read_b64_tr_b16 v[152:153], v100 offset:17920
  ds_read_b64_tr_b16 v[154:155], v100 offset:18080
  s_waitcnt lgkmcnt(9)
  v_mfma_f32_32x32x16_bf16 v[112:127], v[128:131], v[132:135], v[112:127]
  s_waitcnt lgkmcnt(6)
  v_mfma_f32_32x32x16_bf16 v[112:127], v[136:139], v[140:143], v[112:127]
  s_waitcnt lgkmcnt(3)
  v_mfma_f32_32x32x16_bf16 v[112:127], v[144:147], v[148:151], v[112:127]
  s_waitcnt lgkmcnt(0)
  v_mfma_f32_32x32x16_bf16 v[112:127], v[152:155], v[156:159], v[112:127]
  s_barrier
  ds_read_b128 v[132:135], v102 offset:8192
  ds_read_b64_tr_b16 v[128:129], v100 offset:20480
  ds_read_b64_tr_b16 v[130:131], v100 offset:20640
  ds_read_b128 v[140:143], v102 offset:9216
  ds_read_b64_tr_b16 v[136:137], v100 offset:23040
  ds_read_b64_tr_b16 v[138:139], v100 offset:23200
  ds_read_b128 v[148:151], v102 offset:10240
  ds_read_b64_tr_b16 v[144:145], v100 offset:25600
  ds_read_b64_tr_b16 v[146:147], v100 offset:25760
  ds_read_b128 v[156:159], v102 offset:11264
  ds_read_b64_tr_b16 v[152:153], v100 offset:28160
  ds_read_b64_tr_b16 v[154:155], v100 offset:28320
  s_waitcnt lgkmcnt(9)
  v_mfma_f32_32x32x16_bf16 v[112:127], v[128:131], v[132:135], v[112:127]
  ds_read_b128 v[132:135], v102 offset:12288
  ds_read_b64_tr_b16 v[128:129], v100 offset:30720
  ds_read_b64_tr_b16 v[130:131], v100 offset:30880
  s_waitcnt lgkmcnt(9)
  v_mfma_f32_32x32x16_bf16 v[112:127], v[136:139], v[140:143], v[112:127]
  ds_read_b128 v[140:143], v102 offset:13312
  ds_read_b64_tr_b16 v[136:137], v100 offset:33280
  ds_read_b64_tr_b16 v[138:139], v100 offset:33440
  s_waitcnt lgkmcnt(9)
  v_mfma_f32_32x32x16_bf16 v[112:127], v[144:147], v[148:151], v[112:127]
  ds_read_b128 v[148:151], v102 offset:14336
  ds_read_b64_tr_b16 v[144:145], v100 offset:35840
  ds_read_b64_tr_b16 v[146:147], v100 offset:36000
  s_waitcnt lgkmcnt(9)
  v_mfma_f32_32x32x16_bf16 v[112:127], v[152:155], v[156:159], v[112:127]
  ds_read_b128 v[156:159], v102 offset:15360
  ds_read_b64_tr_b16 v[152:153], v100 offset:38400
  ds_read_b64_tr_b16 v[154:155], v100 offset:38560
  s_waitcnt lgkmcnt(9)
  v_mfma_f32_32x32x16_bf16 v[112:127], v[128:131], v[132:135], v[112:127]
  ds_read_b128 v[132:135], v102 offset:16384
  ds_read_b64_tr_b16 v[128:129], v101 offset:0
  ds_read_b64_tr_b16 v[130:131], v101 offset:160
  s_waitcnt lgkmcnt(9)
  v_mfma_f32_32x32x16_bf16 v[112:127], v[136:139], v[140:143], v[112:127]
  ds_read_b128 v[140:143], v102 offset:17408
  ds_read_b64_tr_b16 v[136:137], v101 offset:2560
  ds_read_b64_tr_b16 v[138:139], v101 offset:2720
  s_waitcnt lgkmcnt(9)
  v_mfma_f32_32x32x16_bf16 v[112:127], v[144:147], v[148:151], v[112:127]
  ds_read_b128 v[148:151], v102 offset:18432
  ds_read_b64_tr_b16 v[144:145], v101 offset:5120
  ds_read_b64_tr_b16 v[146:147], v101 offset:5280
  s_waitcnt lgkmcnt(9)
  v_mfma_f32_32x32x16_bf16 v[112:127], v[152:155], v[156:159], v[112:127]
  ds_read_b128 v[156:159], v102 offset:19456
  ds_read_b64_tr_b16 v[152:153], v101 offset:7680
  ds_read_b64_tr_b16 v[154:155], v101 offset:7840
  s_waitcnt lgkmcnt(9)
  v_mfma_f32_32x32x16_bf16 v[112:127], v[128:131], v[132:135], v[112:127]
  ds_read_b128 v[132:135], v102 offset:20480
  ds_read_b64_tr_b16 v[128:129], v101 offset:10240
  ds_read_b64_tr_b16 v[130:131], v101 offset:10400
  s_waitcnt lgkmcnt(9)
  v_mfma_f32_32x32x16_bf16 v[112:127], v[136:139], v[140:143], v[112:127]
  ds_read_b128 v[140:143], v102 offset:21504
  ds_read_b64_tr_b16 v[136:137], v101 offset:12800
  ds_read_b64_tr_b16 v[138:139], v101 offset:12960
  s_waitcnt lgkmcnt(9)
  v_mfma_f32_32x32x16_bf16 v[112:127], v[144:147], v[148:151], v[112:127]
  ds_read_b128 v[148:151], v102 offset:22528
  ds_read_b64_tr_b16 v[144:145], v101 offset:15360
  ds_read_b64_tr_b16 v[146:147], v101 offset:15520
  s_waitcnt lgkmcnt(9)
  v_mfma_f32_32x32x16_bf16 v[112:127], v[152:155], v[156:159], v[112:127]
  ds_read_b128 v[156:159], v102 offset:23552
  ds_read_b64_tr_b16 v[152:153], v101 offset:17920
  ds_read_b64_tr_b16 v[154:155], v101 offset:18080
  s_waitcnt lgkmcnt(9)
  v_mfma_f32_32x32x16_bf16 v[112:127], v[128:131], v[132:135], v[112:127]
  s_waitcnt lgkmcnt(6)
  v_mfma_f32_32x32x16_bf16 v[112:127], v[136:139], v[140:143], v[112:127]
  s_waitcnt lgkmcnt(3)
  v_mfma_f32_32x32x16_bf16 v[112:127], v[144:147], v[148:151], v[112:127]
  s_waitcnt lgkmcnt(0)
  v_mfma_f32_32x32x16_bf16 v[112:127], v[152:155], v[156:159], v[112:127]
  s_barrier
  ds_read_b128 v[132:135], v102 offset:24576
  ds_read_b64_tr_b16 v[128:129], v101 offset:20480
  ds_read_b64_tr_b16 v[130:131], v101 offset:20640
  ds_read_b128 v[140:143], v102 offset:25600
  ds_read_b64_tr_b16 v[136:137], v101 offset:23040
  ds_read_b64_tr_b16 v[138:139], v101 offset:23200
  ds_read_b128 v[148:151], v102 offset:26624
  ds_read_b64_tr_b16 v[144:145], v101 offset:25600
  ds_read_b64_tr_b16 v[146:147], v101 offset:25760
  ds_read_b128 v[156:159], v102 offset:27648
  ds_read_b64_tr_b16 v[152:153], v101 offset:28160
  ds_read_b64_tr_b16 v[154:155], v101 offset:28320
  s_waitcnt lgkmcnt(9)
  v_mfma_f32_32x32x16_bf16 v[112:127], v[128:131], v[132:135], v[112:127]
  ds_read_b128 v[132:135], v102 offset:28672
  ds_read_b64_tr_b16 v[128:129], v100 offset:0
  ds_read_b64_tr_b16 v[130:131], v100 offset:160
  s_waitcnt lgkmcnt(9)
  v_mfma_f32_32x32x16_bf16 v[112:127], v[136:139], v[140:143], v[112:127]
  ds_read_b128 v[140:143], v102 offset:29696
  ds_read_b64_tr_b16 v[136:137], v100 offset:2560
  ds_read_b64_tr_b16 v[138:139], v100 offset:2720
  s_waitcnt lgkmcnt(9)
  v_mfma_f32_32x32x16_bf16 v[112:127], v[144:147], v[148:151], v[112:127]
  ds_read_b128 v[148:151], v102 offset:30720
  ds_read_b64_tr_b16 v[144:145], v100 offset:5120
  ds_read_b64_tr_b16 v[146:147], v100 offset:5280
  s_waitcnt lgkmcnt(9)
  v_mfma_f32_32x32x16_bf16 v[112:127], v[152:155], v[156:159], v[112:127]
  ds_read_b128 v[156:159], v102 offset:31744
  ds_read_b64_tr_b16 v[152:153], v100 offset:7680
  ds_read_b64_tr_b16 v[154:155], v100 offset:7840
  s_waitcnt lgkmcnt(9)
  v_mfma_f32_32x32x16_bf16 v[112:127], v[128:131], v[132:135], v[112:127]
  ds_read_b128 v[132:135], v102 offset:32768
  ds_read_b64_tr_b16 v[128:129], v100 offset:10240
  ds_read_b64_tr_b16 v[130:131], v100 offset:10400
  s_waitcnt lgkmcnt(9)
  v_mfma_f32_32x32x16_bf16 v[112:127], v[136:139], v[140:143], v[112:127]
  ds_read_b128 v[140:143], v102 offset:33792
  ds_read_b64_tr_b16 v[136:137], v100 offset:12800
  ds_read_b64_tr_b16 v[138:139], v100 offset:12960
  s_waitcnt lgkmcnt(9)
  v_mfma_f32_32x32x16_bf16 v[112:127], v[144:147], v[148:151], v[112:127]
  ds_read_b128 v[148:151], v102 offset:34816
  ds_read_b64_tr_b16 v[144:145], v100 offset:15360
  ds_read_b64_tr_b16 v[146:147], v100 offset:15520
  s_waitcnt lgkmcnt(9)
  v_mfma_f32_32x32x16_bf16 v[112:127], v[152:155], v[156:159], v[112:127]
  ds_read_b128 v[156:159], v102 offset:35840
  ds_read_b64_tr_b16 v[152:153], v100 offset:17920
  ds_read_b64_tr_b16 v[154:155], v100 offset:18080
  s_waitcnt lgkmcnt(9)
  v_mfma_f32_32x32x16_bf16 v[112:127], v[128:131], v[132:135], v[112:127]
  ds_read_b128 v[132:135], v102 offset:36864
  ds_read_b64_tr_b16 v[128:129], v103 offset:0
  ds_read_b64_tr_b16 v[130:131], v103 offset:160
  s_waitcnt lgkmcnt(9)
  v_mfma_f32_32x32x16_bf16 v[112:127], v[136:139], v[140:143], v[112:127]
  ds_read_b128 v[140:143], v102 offset:37888
  ds_read_b64_tr_b16 v[136:137], v103 offset:2560
  ds_read_b64_tr_b16 v[138:139], v103 offset:2720
  s_waitcnt lgkmcnt(9)
  v_mfma_f32_32x32x16_bf16 v[112:127], v[144:147], v[148:151], v[112:127]
  ds_read_b128 v[148:151], v102 offset:38912
  ds_read_b64_tr_b16 v[144:145], v103 offset:40960
  ds_read_b64_tr_b16 v[146:147], v103 offset:41120
  s_waitcnt lgkmcnt(9)
  v_mfma_f32_32x32x16_bf16 v[112:127], v[152:155], v[156:159], v[112:127]
  ds_read_b128 v[156:159], v102 offset:39936
  ds_read_b64_tr_b16 v[152:153], v103 offset:43520
  ds_read_b64_tr_b16 v[154:155], v103 offset:43680
  s_waitcnt lgkmcnt(9)
  v_mfma_f32_32x32x16_bf16 v[112:127], v[128:131], v[132:135], v[112:127]
  s_waitcnt lgkmcnt(6)
  v_mfma_f32_32x32x16_bf16 v[112:127], v[136:139], v[140:143], v[112:127]
  s_waitcnt lgkmcnt(3)
  v_mfma_f32_32x32x16_bf16 v[112:127], v[144:147], v[148:151], v[112:127]
  s_waitcnt lgkmcnt(0)
  v_mfma_f32_32x32x16_bf16 v[112:127], v[152:155], v[156:159], v[112:127]
  s_barrier
  s_nop 10
  s_branch L_o_epi
L_o_half:
  s_mov_b32 s20, 0
PL_24:
  global_load_dword v7, v10, s[60:61] sc1
  s_waitcnt vmcnt(0)
  v_cmp_ne_u32 vcc, s7, v7
  s_nop 4
  s_cbranch_vccz PD_25
  s_add_u32 s20, s20, 1
  s_cmp_lt_u32 s20, s9
  s_cbranch_scc1 PL_24
  s_mov_b32 s9, 0
PD_25:
  s_add_u32 s28, s68, 40960
  s_addc_u32 s29, s69, 0
  s_add_u32 m0, s33, 71680
  s_nop 0
  global_load_lds_dwordx4 v0, s[68:69] sc1
  global_load_lds_dwordx4 v0, s[68:69] offset:1024 sc1
  s_add_u32 m0, s33, 112640
  s_nop 0
  global_load_lds_dwordx4 v0, s[28:29] sc1
  global_load_lds_dwordx4 v0, s[28:29] offset:1024 sc1
  s_add_u32 s68, s68, 8192
  s_addc_u32 s69, s69, 0
  s_add_u32 m0, s33, 79872
  s_nop 0
  global_load_lds_dwordx4 v0, s[68:69] sc1
  global_load_lds_dwordx4 v0, s[68:69] offset:1024 sc1
  s_add_u32 s28, s28, 8192
  s_addc_u32 s29, s29, 0
  s_add_u32 m0, s33, 120832
  s_nop 0
  global_load_lds_dwordx4 v0, s[28:29] sc1
  global_load_lds_dwordx4 v0, s[28:29] offset:1024 sc1
  s_add_u32 s68, s68, 8192
  s_addc_u32 s69, s69, 0
  s_add_u32 m0, s33, 88064
  s_nop 0
  global_load_lds_dwordx4 v0, s[68:69] sc1
  global_load_lds_dwordx4 v0, s[68:69] offset:1024 sc1
  s_add_u32 s28, s28, 8192
  s_addc_u32 s29, s29, 0
  s_add_u32 m0, s33, 129024
  s_nop 0
  global_load_lds_dwordx4 v0, s[28:29] sc1
  global_load_lds_dwordx4 v0, s[28:29] offset:1024 sc1
  s_mul_i32 s21, s8, 81920
  s_add_u32 s21, s21, 163840
  s_mul_i32 s20, s47, 40960
  s_add_u32 s21, s21, s20
  s_mul_i32 s20, s5, 5120
  s_add_u32 s21, s21, s20
  s_lshl_b32 s20, s46, 11
  s_add_u32 s21, s21, s20
  s_add_u32 s66, s40, s21
  s_addc_u32 s67, s41, 0
  v_lshrrev_b32 v6, 5, v1
  v_lshlrev_b32 v6, 4, v6
  s_lshl_b32 s20, s46, 6
  s_add_u32 s20, s20, 163264
  v_add_u32 v6, s20, v6
  ds_read_b128 v[160:163], v6
  ds_read_b128 v[164:167], v6 offset:32
  v_and_b32 v6, 31, v1
  s_lshl_b32 s20, s47, 9
  s_lshl_b32 s21, s46, 10
  s_add_u32 s20, s20, s21
  s_add_u32 s20, s20, 71680
  v_lshl_add_u32 v67, v6, 4, s20
  s_lshl_b32 s20, s47, 11
  s_add_u32 s20, s20, 153600
  v_add_u32 v68, s20, v0
  v_mov_b32 v9, 0x3f803f80
  v_mov_b32 v60, 0
  v_mov_b32 v61, 0
  v_mov_b32 v62, 0
  s_and_b32 s27, s6, 1
  s_cmp_ge_u32 s6, 6
  s_cbranch_scc1 L_o_h67
  s_waitcnt vmcnt(8) lgkmcnt(0)
  s_barrier
  s_add_u32 s68, s68, 8192
  s_addc_u32 s69, s69, 0
  s_add_u32 m0, s33, 96256
  s_nop 0
  global_load_lds_dwordx4 v0, s[68:69] sc1
  global_load_lds_dwordx4 v0, s[68:69] offset:1024 sc1
  s_add_u32 s28, s28, 8192
  s_addc_u32 s29, s29, 0
  s_add_u32 m0, s33, 137216
  s_nop 0
  global_load_lds_dwordx4 v0, s[28:29] sc1
  global_load_lds_dwordx4 v0, s[28:29] offset:1024 sc1
  s_add_u32 s68, s68, 8192
  s_addc_u32 s69, s69, 0
  s_add_u32 m0, s33, 104448
  s_nop 0
  global_load_lds_dwordx4 v0, s[68:69] sc1
  global_load_lds_dwordx4 v0, s[68:69] offset:1024 sc1
  s_add_u32 s28, s28, 8192
  s_addc_u32 s29, s29, 0
  s_add_u32 m0, s33, 145408
  s_nop 0
  global_load_lds_dwordx4 v0, s[28:29] sc1
  global_load_lds_dwordx4 v0, s[28:29] offset:1024 sc1
  ds_read_b128 v[132:135], v102 offset:0
  ds_read_b64_tr_b16 v[128:129], v100 offset:0
  ds_read_b64_tr_b16 v[130:131], v100 offset:160
  ds_read_b128 v[140:143], v102 offset:2048
  ds_read_b64_tr_b16 v[136:137], v100 offset:5120
  ds_read_b64_tr_b16 v[138:139], v100 offset:5280
  ds_read_b128 v[148:151], v102 offset:4096
  ds_read_b64_tr_b16 v[144:145], v100 offset:10240
  ds_read_b64_tr_b16 v[146:147], v100 offset:10400
  ds_read_b128 v[156:159], v102 offset:6144
  ds_read_b64_tr_b16 v[152:153], v100 offset:15360
  ds_read_b64_tr_b16 v[154:155], v100 offset:15520
  s_waitcnt lgkmcnt(9)
  v_mfma_f32_32x32x16_bf16 v[112:127], v[128:131], v[132:135], 0
  s_waitcnt lgkmcnt(6)
  v_mfma_f32_32x32x16_bf16 v[112:127], v[136:139], v[140:143], v[112:127]
  s_waitcnt lgkmcnt(3)
  v_mfma_f32_32x32x16_bf16 v[112:127], v[144:147], v[148:151], v[112:127]
  s_waitcnt lgkmcnt(0)
  v_mfma_f32_32x32x16_bf16 v[112:127], v[152:155], v[156:159], v[112:127]
  s_waitcnt vmcnt(8)
  s_barrier
  s_mul_i32 s21, s27, 40960
  s_add_u32 s21, s21, 573440
  s_add_u32 s64, s44, s21
  s_addc_u32 s65, s45, 0
  s_mul_i32 s76, s27, 5120
  s_add_u32 s76, s76, 0
  s_mov_b32 m0, s76
  s_nop 0
  global_load_lds_dwordx4 v250, s[64:65] offset:0
  s_mov_b32 m0, s76
  s_nop 0
  global_load_lds_dwordx4 v251, s[64:65] offset:1024
  s_mov_b32 m0, s76
  s_nop 0
  global_load_lds_dwordx4 v252, s[64:65] offset:2048
  s_mov_b32 m0, s76
  s_nop 0
  global_load_lds_dwordx4 v253, s[64:65] offset:3072
  s_add_u32 m0, s76, 4096
  s_nop 0
  global_load_lds_dwordx4 v254, s[64:65]
  s_mul_i32 s21, s27, 40960
  s_add_u32 s21, s21, 737280
  s_add_u32 s64, s44, s21
  s_addc_u32 s65, s45, 0
  s_mul_i32 s76, s27, 40960
  s_add_u32 s76, s76, 71680
  s_mov_b32 m0, s76
  s_nop 0
  global_load_lds_dwordx4 v250, s[64:65] offset:0
  s_mov_b32 m0, s76
  s_nop 0
  global_load_lds_dwordx4 v251, s[64:65] offset:1024
  s_mov_b32 m0, s76
  s_nop 0
  global_load_lds_dwordx4 v252, s[64:65] offset:2048
  s_mov_b32 m0, s76
  s_nop 0
  global_load_lds_dwordx4 v253, s[64:65] offset:3072
  s_add_u32 m0, s76, 4096
  s_nop 0
  global_load_lds_dwordx4 v254, s[64:65]
  ds_read_b128 v[132:135], v102 offset:8192
  ds_read_b64_tr_b16 v[128:129], v100 offset:20480
  ds_read_b64_tr_b16 v[130:131], v100 offset:20640
  ds_read_b128 v[140:143], v102 offset:10240
  ds_read_b64_tr_b16 v[136:137], v100 offset:25600
  ds_read_b64_tr_b16 v[138:139], v100 offset:25760
  ds_read_b128 v[148:151], v102 offset:12288
  ds_read_b64_tr_b16 v[144:145], v100 offset:30720
  ds_read_b64_tr_b16 v[146:147], v100 offset:30880
  ds_read_b128 v[156:159], v102 offset:14336
  ds_read_b64_tr_b16 v[152:153], v100 offset:35840
  ds_read_b64_tr_b16 v[154:155], v100 offset:36000
  s_waitcnt lgkmcnt(9)
  v_mfma_f32_32x32x16_bf16 v[112:127], v[128:131], v[132:135], v[112:127]
  ds_read_b128 v[132:135], v102 offset:16384
  ds_read_b64_tr_b16 v[128:129], v101 offset:0
  ds_read_b64_tr_b16 v[130:131], v101 offset:160
  s_waitcnt lgkmcnt(9)
  v_mfma_f32_32x32x16_bf16 v[112:127], v[136:139], v[140:143], v[112:127]
  ds_read_b128 v[140:143], v102 offset:18432
  ds_read_b64_tr_b16 v[136:137], v101 offset:5120
  ds_read_b64_tr_b16 v[138:139], v101 offset:5280
  s_waitcnt lgkmcnt(9)
  v_mfma_f32_32x32x16_bf16 v[112:127], v[144:147], v[148:151], v[112:127]
  ds_read_b128 v[148:151], v102 offset:20480
  ds_read_b64_tr_b16 v[144:145], v101 offset:10240
  ds_read_b64_tr_b16 v[146:147], v101 offset:10400
  s_waitcnt lgkmcnt(9)
  v_mfma_f32_32x32x16_bf16 v[112:127], v[152:155], v[156:159], v[112:127]
  ds_read_b128 v[156:159], v102 offset:22528
  ds_read_b64_tr_b16 v[152:153], v101 offset:15360
  ds_read_b64_tr_b16 v[154:155], v101 offset:15520
  s_waitcnt lgkmcnt(9)
  v_mfma_f32_32x32x16_bf16 v[112:127], v[128:131], v[132:135], v[112:127]
  s_waitcnt lgkmcnt(6)
  v_mfma_f32_32x32x16_bf16 v[112:127], v[136:139], v[140:143], v[112:127]
  s_waitcnt lgkmcnt(3)
  v_mfma_f32_32x32x16_bf16 v[112:127], v[144:147], v[148:151], v[112:127]
  s_waitcnt lgkmcnt(0)
  v_mfma_f32_32x32x16_bf16 v[112:127], v[152:155], v[156:159], v[112:127]
  s_waitcnt vmcnt(0)
  s_barrier
  ds_read_b128 v[132:135], v102 offset:24576
  ds_read_b64_tr_b16 v[128:129], v101 offset:20480
  ds_read_b64_tr_b16 v[130:131], v101 offset:20640
  ds_read_b128 v[140:143], v102 offset:26624
  ds_read_b64_tr_b16 v[136:137], v101 offset:25600
  ds_read_b64_tr_b16 v[138:139], v101 offset:25760
  ds_read_b128 v[148:151], v102 offset:28672
  ds_read_b64_tr_b16 v[144:145], v100 offset:0
  ds_read_b64_tr_b16 v[146:147], v100 offset:160
  ds_read_b128 v[156:159], v102 offset:30720
  ds_read_b64_tr_b16 v[152:153], v100 offset:5120
  ds_read_b64_tr_b16 v[154:155], v100 offset:5280
  s_waitcnt lgkmcnt(9)
  v_mfma_f32_32x32x16_bf16 v[112:127], v[128:131], v[132:135], v[112:127]
  ds_read_b128 v[132:135], v102 offset:32768
  ds_read_b64_tr_b16 v[128:129], v100 offset:10240
  ds_read_b64_tr_b16 v[130:131], v100 offset:10400
  s_waitcnt lgkmcnt(9)
  v_mfma_f32_32x32x16_bf16 v[112:127], v[136:139], v[140:143], v[112:127]
  ds_read_b128 v[140:143], v102 offset:34816
  ds_read_b64_tr_b16 v[136:137], v100 offset:15360
  ds_read_b64_tr_b16 v[138:139], v100 offset:15520
  s_waitcnt lgkmcnt(9)
  v_mfma_f32_32x32x16_bf16 v[112:127], v[144:147], v[148:151], v[112:127]
  ds_read_b128 v[148:151], v102 offset:36864
  ds_read_b64_tr_b16 v[144:145], v103 offset:0
  ds_read_b64_tr_b16 v[146:147], v103 offset:160
  s_waitcnt lgkmcnt(9)
  v_mfma_f32_32x32x16_bf16 v[112:127], v[152:155], v[156:159], v[112:127]
  ds_read_b128 v[156:159], v102 offset:38912
  ds_read_b64_tr_b16 v[152:153], v103 offset:40960
  ds_read_b64_tr_b16 v[154:155], v103 offset:41120
  s_waitcnt lgkmcnt(9)
  v_mfma_f32_32x32x16_bf16 v[112:127], v[128:131], v[132:135], v[112:127]
  s_waitcnt lgkmcnt(6)
  v_mfma_f32_32x32x16_bf16 v[112:127], v[136:139], v[140:143], v[112:127]
  s_waitcnt lgkmcnt(3)
  v_mfma_f32_32x32x16_bf16 v[112:127], v[144:147], v[148:151], v[112:127]
  s_waitcnt lgkmcnt(0)
  v_mfma_f32_32x32x16_bf16 v[112:127], v[152:155], v[156:159], v[112:127]
  s_barrier
  ds_read_b128 v[128:131], v68
  ds_read_b128 v[132:135], v68 offset:1024
  s_waitcnt lgkmcnt(0)
  s_nop 7
  v_add_f32 v112, v112, v128
  v_add_f32 v113, v113, v129
  v_add_f32 v114, v114, v130
  v_add_f32 v115, v115, v131
  v_add_f32 v116, v116, v132
  v_add_f32 v117, v117, v133
  v_add_f32 v118, v118, v134
  v_add_f32 v119, v119, v135
  s_nop 1
  s_branch L_o_epi
L_o_h67:
  s_waitcnt vmcnt(8) lgkmcnt(0)
  s_barrier
  s_add_u32 s68, s68, 8192
  s_addc_u32 s69, s69, 0
  s_add_u32 m0, s33, 96256
  s_nop 0
  global_load_lds_dwordx4 v0, s[68:69] sc1
  global_load_lds_dwordx4 v0, s[68:69] offset:1024 sc1
  s_add_u32 s28, s28, 8192
  s_addc_u32 s29, s29, 0
  s_add_u32 m0, s33, 137216
  s_nop 0
  global_load_lds_dwordx4 v0, s[28:29] sc1
  global_load_lds_dwordx4 v0, s[28:29] offset:1024 sc1
  s_add_u32 s68, s68, 8192
  s_addc_u32 s69, s69, 0
  s_add_u32 m0, s33, 104448
  s_nop 0
  global_load_lds_dwordx4 v0, s[68:69] sc1
  global_load_lds_dwordx4 v0, s[68:69] offset:1024 sc1
  s_add_u32 s28, s28, 8192
  s_addc_u32 s29, s29, 0
  s_add_u32 m0, s33, 145408
  s_nop 0
  global_load_lds_dwordx4 v0, s[28:29] sc1
  global_load_lds_dwordx4 v0, s[28:29] offset:1024 sc1
  ds_read_b128 v[132:135], v102 offset:0
  ds_read_b64_tr_b16 v[128:129], v100 offset:0
  ds_read_b64_tr_b16 v[130:131], v100 offset:160
  ds_read_b128 v[140:143], v102 offset:2048
  ds_read_b64_tr_b16 v[136:137], v100 offset:5120
  ds_read_b64_tr_b16 v[138:139], v100 offset:5280
  ds_read_b128 v[148:151], v102 offset:4096
  ds_read_b64_tr_b16 v[144:145], v100 offset:10240
  ds_read_b64_tr_b16 v[146:147], v100 offset:10400
  ds_read_b128 v[156:159], v102 offset:6144
  ds_read_b64_tr_b16 v[152:153], v100 offset:15360
  ds_read_b64_tr_b16 v[154:155], v100 offset:15520
  s_waitcnt lgkmcnt(9)
  v_mfma_f32_32x32x16_bf16 v[112:127], v[128:131], v[132:135], 0
  s_waitcnt lgkmcnt(6)
  v_mfma_f32_32x32x16_bf16 v[112:127], v[136:139], v[140:143], v[112:127]
  s_waitcnt lgkmcnt(3)
  v_mfma_f32_32x32x16_bf16 v[112:127], v[144:147], v[148:151], v[112:127]
  s_waitcnt lgkmcnt(0)
  v_mfma_f32_32x32x16_bf16 v[112:127], v[152:155], v[156:159], v[112:127]
  s_waitcnt vmcnt(8)
  s_barrier
  s_mul_i32 s21, s27, 40960
  s_add_u32 s21, s21, 655360
  s_add_u32 s64, s44, s21
  s_addc_u32 s65, s45, 0
  s_mul_i32 s76, s27, 5120
  s_add_u32 s76, s76, 10240
  s_mov_b32 m0, s76
  s_nop 0
  global_load_lds_dwordx4 v250, s[64:65] offset:0
  s_mov_b32 m0, s76
  s_nop 0
  global_load_lds_dwordx4 v251, s[64:65] offset:1024
  s_mov_b32 m0, s76
  s_nop 0
  global_load_lds_dwordx4 v252, s[64:65] offset:2048
  s_mov_b32 m0, s76
  s_nop 0
  global_load_lds_dwordx4 v253, s[64:65] offset:3072
  s_add_u32 m0, s76, 4096
  s_nop 0
  global_load_lds_dwordx4 v254, s[64:65]
  ds_read_b128 v[132:135], v102 offset:8192
  ds_read_b64_tr_b16 v[128:129], v100 offset:20480
  ds_read_b64_tr_b16 v[130:131], v100 offset:20640
  ds_read_b128 v[140:143], v102 offset:10240
  ds_read_b64_tr_b16 v[136:137], v100 offset:25600
  ds_read_b64_tr_b16 v[138:139], v100 offset:25760
  ds_read_b128 v[148:151], v102 offset:12288
  ds_read_b64_tr_b16 v[144:145], v100 offset:30720
  ds_read_b64_tr_b16 v[146:147], v100 offset:30880
  ds_read_b128 v[156:159], v102 offset:14336
  ds_read_b64_tr_b16 v[152:153], v100 offset:35840
  ds_read_b64_tr_b16 v[154:155], v100 offset:36000
  s_waitcnt lgkmcnt(9)
  v_mfma_f32_32x32x16_bf16 v[112:127], v[128:131], v[132:135], v[112:127]
  ds_read_b128 v[132:135], v102 offset:16384
  ds_read_b64_tr_b16 v[128:129], v101 offset:0
  ds_read_b64_tr_b16 v[130:131], v101 offset:160
  s_waitcnt lgkmcnt(9)
  v_mfma_f32_32x32x16_bf16 v[112:127], v[136:139], v[140:143], v[112:127]
  ds_read_b128 v[140:143], v102 offset:18432
  ds_read_b64_tr_b16 v[136:137], v101 offset:5120
  ds_read_b64_tr_b16 v[138:139], v101 offset:5280
  s_waitcnt lgkmcnt(9)
  v_mfma_f32_32x32x16_bf16 v[112:127], v[144:147], v[148:151], v[112:127]
  ds_read_b128 v[148:151], v102 offset:20480
  ds_read_b64_tr_b16 v[144:145], v101 offset:10240
  ds_read_b64_tr_b16 v[146:147], v101 offset:10400
  s_waitcnt lgkmcnt(9)
  v_mfma_f32_32x32x16_bf16 v[112:127], v[152:155], v[156:159], v[112:127]
  ds_read_b128 v[156:159], v102 offset:22528
  ds_read_b64_tr_b16 v[152:153], v101 offset:15360
  ds_read_b64_tr_b16 v[154:155], v101 offset:15520
  s_waitcnt lgkmcnt(9)
  v_mfma_f32_32x32x16_bf16 v[112:127], v[128:131], v[132:135], v[112:127]
  s_waitcnt lgkmcnt(6)
  v_mfma_f32_32x32x16_bf16 v[112:127], v[136:139], v[140:143], v[112:127]
  s_waitcnt lgkmcnt(3)
  v_mfma_f32_32x32x16_bf16 v[112:127], v[144:147], v[148:151], v[112:127]
  s_waitcnt lgkmcnt(0)
  v_mfma_f32_32x32x16_bf16 v[112:127], v[152:155], v[156:159], v[112:127]
  s_waitcnt vmcnt(0)
  s_barrier
  ds_read_b128 v[132:135], v102 offset:24576
  ds_read_b64_tr_b16 v[128:129], v101 offset:20480
  ds_read_b64_tr_b16 v[130:131], v101 offset:20640
  ds_read_b128 v[140:143], v102 offset:26624
  ds_read_b64_tr_b16 v[136:137], v101 offset:25600
  ds_read_b64_tr_b16 v[138:139], v101 offset:25760
  ds_read_b128 v[148:151], v102 offset:28672
  ds_read_b64_tr_b16 v[144:145], v100 offset:0
  ds_read_b64_tr_b16 v[146:147], v100 offset:160
  ds_read_b128 v[156:159], v102 offset:30720
  ds_read_b64_tr_b16 v[152:153], v100 offset:5120
  ds_read_b64_tr_b16 v[154:155], v100 offset:5280
  s_waitcnt lgkmcnt(9)
  v_mfma_f32_32x32x16_bf16 v[112:127], v[128:131], v[132:135], v[112:127]
  ds_read_b128 v[132:135], v102 offset:32768
  ds_read_b64_tr_b16 v[128:129], v100 offset:10240
  ds_read_b64_tr_b16 v[130:131], v100 offset:10400
  s_waitcnt lgkmcnt(9)
  v_mfma_f32_32x32x16_bf16 v[112:127], v[136:139], v[140:143], v[112:127]
  ds_read_b128 v[140:143], v102 offset:34816
  ds_read_b64_tr_b16 v[136:137], v100 offset:15360
  ds_read_b64_tr_b16 v[138:139], v100 offset:15520
  s_waitcnt lgkmcnt(9)
  v_mfma_f32_32x32x16_bf16 v[112:127], v[144:147], v[148:151], v[112:127]
  ds_read_b128 v[148:151], v102 offset:36864
  ds_read_b64_tr_b16 v[144:145], v103 offset:0
  ds_read_b64_tr_b16 v[146:147], v103 offset:160
  s_waitcnt lgkmcnt(9)
  v_mfma_f32_32x32x16_bf16 v[112:127], v[152:155], v[156:159], v[112:127]
  ds_read_b128 v[156:159], v102 offset:38912
  ds_read_b64_tr_b16 v[152:153], v103 offset:40960
  ds_read_b64_tr_b16 v[154:155], v103 offset:41120
  s_waitcnt lgkmcnt(9)
  v_mfma_f32_32x32x16_bf16 v[112:127], v[128:131], v[132:135], v[112:127]
  s_waitcnt lgkmcnt(6)
  v_mfma_f32_32x32x16_bf16 v[112:127], v[136:139], v[140:143], v[112:127]
  s_waitcnt lgkmcnt(3)
  v_mfma_f32_32x32x16_bf16 v[112:127], v[144:147], v[148:151], v[112:127]
  s_waitcnt lgkmcnt(0)
  v_mfma_f32_32x32x16_bf16 v[112:127], v[152:155], v[156:159], v[112:127]
  s_nop 11
  ds_write_b128 v68, v[112:115]
  ds_write_b128 v68, v[116:119] offset:1024
  s_waitcnt lgkmcnt(0)
  s_barrier
  s_barrier
  s_cmp_eq_u32 s8, 0
  s_cbranch_scc0 L_o_pub
  s_sub_u32 s21, s6, 6
  s_mul_i32 s21, s21, 12288
  s_add_u32 s64, s70, s21
  s_addc_u32 s65, s71, 0
  s_add_u32 m0, s21, 0
  s_nop 0
  global_load_lds_dwordx4 v0, s[64:65] offset:0
  global_load_lds_dwordx4 v0, s[64:65] offset:1024
  global_load_lds_dwordx4 v0, s[64:65] offset:2048
  global_load_lds_dwordx4 v0, s[64:65] offset:3072
  s_add_u32 s64, s64, 4096
  s_addc_u32 s65, s65, 0
  s_add_u32 m0, s21, 4096
  s_nop 0
  global_load_lds_dwordx4 v0, s[64:65] offset:0
  global_load_lds_dwordx4 v0, s[64:65] offset:1024
  global_load_lds_dwordx4 v0, s[64:65] offset:2048
  global_load_lds_dwordx4 v0, s[64:65] offset:3072
  s_add_u32 s64, s64, 4096
  s_addc_u32 s65, s65, 0
  s_add_u32 m0, s21, 8192
  s_nop 0
  global_load_lds_dwordx4 v0, s[64:65] offset:0
  global_load_lds_dwordx4 v0, s[64:65] offset:1024
  global_load_lds_dwordx4 v0, s[64:65] offset:2048
  global_load_lds_dwordx4 v0, s[64:65] offset:3072
  s_add_u32 s64, s64, 4096
  s_addc_u32 s65, s65, 0
  s_add_u32 m0, s21, 12288
  s_nop 0
  global_load_lds_dwordx4 v0, s[64:65] offset:0
  s_mul_i32 s21, s27, 40960
  s_add_u32 s21, s21, 0
  s_add_u32 s64, s38, s21
  s_addc_u32 s65, s39, 0
  s_mul_i32 s76, s27, 5120
  s_add_u32 s76, s76, 30720
  s_mov_b32 m0, s76
  s_nop 0
  global_load_lds_dwordx4 v250, s[64:65] offset:0
  s_mov_b32 m0, s76
  s_nop 0
  global_load_lds_dwordx4 v251, s[64:65] offset:1024
  s_mov_b32 m0, s76
  s_nop 0
  global_load_lds_dwordx4 v252, s[64:65] offset:2048
  s_mov_b32 m0, s76
  s_nop 0
  global_load_lds_dwordx4 v253, s[64:65] offset:3072
  s_add_u32 m0, s76, 4096
  s_nop 0
  global_load_lds_dwordx4 v254, s[64:65]
  s_mul_i32 s21, s27, 40960
  s_add_u32 s21, s21, 81920
  s_add_u32 s64, s38, s21
  s_addc_u32 s65, s39, 0
  s_mul_i32 s76, s27, 5120
  s_add_u32 s76, s76, 40960
  s_mov_b32 m0, s76
  s_nop 0
  global_load_lds_dwordx4 v250, s[64:65] offset:0
  s_mov_b32 m0, s76
  s_nop 0
  global_load_lds_dwordx4 v251, s[64:65] offset:1024
  s_mov_b32 m0, s76
  s_nop 0
  global_load_lds_dwordx4 v252, s[64:65] offset:2048
  s_mov_b32 m0, s76
  s_nop 0
  global_load_lds_dwordx4 v253, s[64:65] offset:3072
  s_add_u32 m0, s76, 4096
  s_nop 0
  global_load_lds_dwordx4 v254, s[64:65]
  s_mul_i32 s21, s27, 40960
  s_add_u32 s21, s21, 163840
  s_add_u32 s64, s38, s21
  s_addc_u32 s65, s39, 0
  s_mul_i32 s76, s27, 5120
  s_add_u32 s76, s76, 51200
  s_mov_b32 m0, s76
  s_nop 0
  global_load_lds_dwordx4 v250, s[64:65] offset:0
  s_mov_b32 m0, s76
  s_nop 0
  global_load_lds_dwordx4 v251, s[64:65] offset:1024
  s_mov_b32 m0, s76
  s_nop 0
  global_load_lds_dwordx4 v252, s[64:65] offset:2048
  s_mov_b32 m0, s76
  s_nop 0
  global_load_lds_dwordx4 v253, s[64:65] offset:3072
  s_add_u32 m0, s76, 4096
  s_nop 0
  global_load_lds_dwordx4 v254, s[64:65]
  s_mul_i32 s21, s27, 40960
  s_add_u32 s21, s21, 245760
  s_add_u32 s64, s38, s21
  s_addc_u32 s65, s39, 0
  s_mul_i32 s76, s27, 5120
  s_add_u32 s76, s76, 61440
  s_mov_b32 m0, s76
  s_nop 0
  global_load_lds_dwordx4 v250, s[64:65] offset:0
  s_mov_b32 m0, s76
  s_nop 0
  global_load_lds_dwordx4 v251, s[64:65] offset:1024
  s_mov_b32 m0, s76
  s_nop 0
  global_load_lds_dwordx4 v252, s[64:65] offset:2048
  s_mov_b32 m0, s76
  s_nop 0
  global_load_lds_dwordx4 v253, s[64:65] offset:3072
  s_add_u32 m0, s76, 4096
  s_nop 0
  global_load_lds_dwordx4 v254, s[64:65]
  s_branch L_o_pub
L_o_epi:
  v_cvt_pk_bf16_f32 v112, v112, v113
  v_cvt_pk_bf16_f32 v114, v114, v115
  v_cvt_pk_bf16_f32 v116, v116, v117
  v_cvt_pk_bf16_f32 v118, v118, v119
  v_lshlrev_b32 v140, 16, v12
  v_and_b32 v141, 0xffff0000, v12
  v_lshlrev_b32 v142, 16, v13
  v_and_b32 v143, 0xffff0000, v13
  v_lshlrev_b32 v144, 16, v14
  v_and_b32 v145, 0xffff0000, v14
  v_lshlrev_b32 v146, 16, v15
  v_and_b32 v147, 0xffff0000, v15
  v_and_b32 v113, 0xffff0000, v112
  v_lshlrev_b32 v112, 16, v112
  v_and_b32 v115, 0xffff0000, v114
  v_lshlrev_b32 v114, 16, v114
  v_and_b32 v117, 0xffff0000, v116
  v_lshlrev_b32 v116, 16, v116
  v_and_b32 v119, 0xffff0000, v118
  v_lshlrev_b32 v118, 16, v118
  v_add_f32 v112, v112, v140
  v_add_f32 v113, v113, v141
  v_add_f32 v114, v114, v142
  v_add_f32 v115, v115, v143
  v_add_f32 v116, v116, v144
  v_add_f32 v117, v117, v145
  v_add_f32 v118, v118, v146
  v_add_f32 v119, v119, v147
  v_cvt_pk_bf16_f32 v12, v112, v113
  v_cvt_pk_bf16_f32 v13, v114, v115
  v_cvt_pk_bf16_f32 v14, v116, v117
  v_cvt_pk_bf16_f32 v15, v118, v119
  global_store_dwordx4 v0, v[12:15], s[66:67] offset:0 sc1
  v_dot2_f32_bf16 v60, v12, v9, v60
  v_dot2_f32_bf16 v61, v12, v12, v61
  v_dot2_f32_bf16 v62, v12, v160, v62
  v_dot2_f32_bf16 v60, v13, v9, v60
  v_dot2_f32_bf16 v61, v13, v13, v61
  v_dot2_f32_bf16 v62, v13, v161, v62
  v_dot2_f32_bf16 v60, v14, v9, v60
  v_dot2_f32_bf16 v61, v14, v14, v61
  v_dot2_f32_bf16 v62, v14, v162, v62
  v_dot2_f32_bf16 v60, v15, v9, v60
  v_dot2_f32_bf16 v61, v15, v15, v61
  v_dot2_f32_bf16 v62, v15, v163, v62
  s_cmp_eq_u32 s46, 2
  s_nop 1
  s_cbranch_scc1 L_o_g1
  v_cvt_pk_bf16_f32 v120, v120, v121
  v_cvt_pk_bf16_f32 v122, v122, v123
  v_cvt_pk_bf16_f32 v124, v124, v125
  v_cvt_pk_bf16_f32 v126, v126, v127
  v_lshlrev_b32 v140, 16, v16
  v_and_b32 v141, 0xffff0000, v16
  v_lshlrev_b32 v142, 16, v17
  v_and_b32 v143, 0xffff0000, v17
  v_lshlrev_b32 v144, 16, v18
  v_and_b32 v145, 0xffff0000, v18
  v_lshlrev_b32 v146, 16, v19
  v_and_b32 v147, 0xffff0000, v19
  v_and_b32 v121, 0xffff0000, v120
  v_lshlrev_b32 v120, 16, v120
  v_and_b32 v123, 0xffff0000, v122
  v_lshlrev_b32 v122, 16, v122
  v_and_b32 v125, 0xffff0000, v124
  v_lshlrev_b32 v124, 16, v124
  v_and_b32 v127, 0xffff0000, v126
  v_lshlrev_b32 v126, 16, v126
  v_add_f32 v120, v120, v140
  v_add_f32 v121, v121, v141
  v_add_f32 v122, v122, v142
  v_add_f32 v123, v123, v143
  v_add_f32 v124, v124, v144
  v_add_f32 v125, v125, v145
  v_add_f32 v126, v126, v146
  v_add_f32 v127, v127, v147
  v_cvt_pk_bf16_f32 v16, v120, v121
  v_cvt_pk_bf16_f32 v17, v122, v123
  v_cvt_pk_bf16_f32 v18, v124, v125
  v_cvt_pk_bf16_f32 v19, v126, v127
  global_store_dwordx4 v0, v[16:19], s[66:67] offset:1024 sc1
  v_dot2_f32_bf16 v60, v16, v9, v60
  v_dot2_f32_bf16 v61, v16, v16, v61
  v_dot2_f32_bf16 v62, v16, v164, v62
  v_dot2_f32_bf16 v60, v17, v9, v60
  v_dot2_f32_bf16 v61, v17, v17, v61
  v_dot2_f32_bf16 v62, v17, v165, v62
  v_dot2_f32_bf16 v60, v18, v9, v60
  v_dot2_f32_bf16 v61, v18, v18, v61
  v_dot2_f32_bf16 v62, v18, v166, v62
  v_dot2_f32_bf16 v60, v19, v9, v60
  v_dot2_f32_bf16 v61, v19, v19, v61
  v_dot2_f32_bf16 v62, v19, v167, v62
  s_nop 2
L_o_g1:
  s_barrier
  v_mov_b32 v64, v60
  v_mov_b32 v65, v61
  v_mov_b32 v66, v62
  v_permlane32_swap_b32 v60, v64
  v_permlane32_swap_b32 v61, v65
  v_permlane32_swap_b32 v62, v66
  v_add_f32 v60, v60, v64
  v_add_f32 v61, v61, v65
  v_add_f32 v62, v62, v66
  ds_write_b128 v67, v[60:63]
  v_mov_b32 v6, 163208
  v_mov_b32 v7, 0
  ds_write_b32 v6, v7
  s_waitcnt vmcnt(0) lgkmcnt(0)
L_o_pub:
  s_mul_i32 s21, s8, 8192
  s_add_u32 s21, s21, 327680
  s_lshl_b32 s20, s6, 10
  s_add_u32 s22, s21, s20
  v_add_u32 v6, s22, v0
  s_add_u32 s22, s20, 153600
  v_add_u32 v10, s22, v0
  v_add_u32 v8, 71680, v0
  s_lshl_b32 s20, s5, 10
  s_add_u32 s20, s20, s21
  v_add_u32 v7, s20, v0
  s_barrier
  s_cmp_eq_u32 s6, 0
  s_cbranch_scc0 L_o_nost
  ds_read_b128 v[60:63], v8
  ds_read_b128 v[64:67], v8 offset:1024
  ds_read_b128 v[68:71], v8 offset:2048
  s_waitcnt lgkmcnt(0)
  v_add_f32 v60, v60, v64
  v_add_f32 v61, v61, v65
  v_add_f32 v62, v62, v66
  v_add_f32 v60, v60, v68
  v_add_f32 v61, v61, v69
  v_add_f32 v62, v62, v70
  v_mov_b32 v63, s7
  global_store_dwordx4 v7, v[60:63], s[40:41] sc1
  s_nop 1
L_o_nost:
  s_mov_b32 s20, 0
PL_27:
  global_load_dwordx4 v[60:63], v6, s[40:41] sc1
  s_waitcnt vmcnt(0)
  v_cmp_ne_u32 vcc, s7, v63
  s_nop 4
  s_cbranch_vccz PD_28
  s_add_u32 s20, s20, 1
  s_cmp_lt_u32 s20, s9
  s_cbranch_scc1 PL_27
  s_mov_b32 s9, 0
PD_28:
  ds_write_b128 v10, v[60:63]
  s_mul_i32 s21, s8, 81920
  s_add_u32 s21, s21, 163840
  s_add_u32 s72, s60, s21
  s_addc_u32 s73, s61, 0
  s_add_u32 s72, s72, 1048576
  s_addc_u32 s73, s73, 0
  s_cmp_eq_u32 s8, 0
  s_cbranch_scc0 L_st_b
  s_mul_i32 s20, s6, 5120
  s_lshr_b32 s21, s19, 1
  s_xor_b32 s21, s21, 0
  s_mul_i32 s22, s21, 40960
  s_add_u32 s22, s22, s20
  s_add_u32 s64, s40, s22
  s_addc_u32 s65, s41, 0
  s_add_u32 s64, s64, 163840
  s_addc_u32 s65, s65, 0
  s_add_u32 m0, s22, 71680
  s_nop 0
  global_load_lds_dwordx4 v0, s[64:65] offset:0 sc1
  global_load_lds_dwordx4 v0, s[64:65] offset:1024 sc1
  global_load_lds_dwordx4 v0, s[64:65] offset:2048 sc1
  global_load_lds_dwordx4 v0, s[64:65] offset:3072 sc1
  s_add_u32 s64, s64, 4096
  s_addc_u32 s65, s65, 0
  s_add_u32 m0, s22, 75776
  s_nop 0
  global_load_lds_dwordx4 v0, s[64:65] sc1
  s_cmp_eq_u32 s6, 0
  s_cbranch_scc1 L_st_b
  s_mul_i32 s20, s6, 5120
  s_lshr_b32 s21, s19, 1
  s_xor_b32 s21, s21, 1
  s_mul_i32 s22, s21, 40960
  s_add_u32 s22, s22, s20
  s_add_u32 s64, s40, s22
  s_addc_u32 s65, s41, 0
  s_add_u32 s64, s64, 163840
  s_addc_u32 s65, s65, 0
  s_add_u32 m0, s22, 71680
  s_nop 0
  global_load_lds_dwordx4 v0, s[64:65] offset:0 sc1
  global_load_lds_dwordx4 v0, s[64:65] offset:1024 sc1
  global_load_lds_dwordx4 v0, s[64:65] offset:2048 sc1
  global_load_lds_dwordx4 v0, s[64:65] offset:3072 sc1
  s_add_u32 s64, s64, 4096
  s_addc_u32 s65, s65, 0
  s_add_u32 m0, s22, 75776
  s_nop 0
  global_load_lds_dwordx4 v0, s[64:65] sc1
L_st_b:
  s_waitcnt lgkmcnt(0)
  s_barrier
  s_cmp_eq_u32 s6, 0
  s_cbranch_scc0 L_st_done
L_st_do:
  v_add_u32 v6, 153600, v0
  ds_read_b128 v[60:63], v6 offset:0
  ds_read_b128 v[64:67], v6 offset:1024
  ds_read_b128 v[68:71], v6 offset:2048
  ds_read_b128 v[72:75], v6 offset:3072
  ds_read_b128 v[76:79], v6 offset:4096
  ds_read_b128 v[80:83], v6 offset:5120
  ds_read_b128 v[84:87], v6 offset:6144
  ds_read_b128 v[88:91], v6 offset:7168
  v_mov_b32 v7, 163204
  ds_read_b32 v7, v7
  s_lshl_b32 s20, s4, 6
  v_add_u32 v100, s20, v1
  v_mov_b32 v99, s7
  v_lshlrev_b32 v6, 3, v1
  v_add_u32 v6, 161792, v6
  s_mul_i32 s21, s8, 4096
  s_add_u32 s21, s21, 655360
  s_lshl_b32 s20, s4, 7
  s_add_u32 s20, s20, s21
  v_mov_b32 v102, s20
  v_add_u32 v103, 16, v102
  s_waitcnt lgkmcnt(1)
  v_add_f32 v60, v60, v64
  v_add_f32 v61, v61, v65
  v_add_f32 v62, v62, v66
  v_add_f32 v68, v68, v72
  v_add_f32 v69, v69, v73
  v_add_f32 v70, v70, v74
  v_add_f32 v76, v76, v80
  v_add_f32 v77, v77, v81
  v_add_f32 v78, v78, v82
  v_add_f32 v84, v84, v88
  v_add_f32 v85, v85, v89
  v_add_f32 v86, v86, v90
  v_add_f32 v60, v60, v68
  v_add_f32 v61, v61, v69
  v_add_f32 v62, v62, v70
  v_add_f32 v76, v76, v84
  v_add_f32 v77, v77, v85
  v_add_f32 v78, v78, v86
  v_add_f32 v60, v60, v76
  v_add_f32 v61, v61, v77
  v_add_f32 v62, v62, v78
  v_mul_f32 v64, 0x3acccccd, v60
  v_mul_f32 v65, 0x3acccccd, v61
  v_fma_f32 v65, -v64, v64, v65
  v_cvt_pk_bf16_f32 v66, v64, v64
  v_lshlrev_b32 v66, 16, v66
  v_max_f32 v69, 0, v65
  v_cvt_pk_bf16_f32 v69, v69, v69
  v_lshlrev_b32 v69, 16, v69
  v_add_f32 v69, 0x3727c5ac, v69
  v_cvt_pk_bf16_f32 v69, v69, v69
  v_lshlrev_b32 v69, 16, v69
  v_sqrt_f32 v69, v69
  s_nop 0
  v_cvt_pk_bf16_f32 v68, v69, v69
  v_lshlrev_b32 v68, 16, v68
  v_rcp_f32 v67, v68
  s_waitcnt lgkmcnt(0)
  v_fma_f32 v97, -v66, v7, v62
  v_mul_f32 v97, v97, v67
  v_ashrrev_i32 v96, 31, v97
  v_or_b32 v96, 0x80000000, v96
  v_xor_b32 v96, v96, v97
  v_and_b32 v96, 0xfffff800, v96
  v_or_b32 v96, v96, v100
  v_lshrrev_b32 v98, 16, v66
  v_or_b32 v98, v98, v68
  s_cmp_eq_u32 s5, 0
  s_cselect_b32 s20, 1, s8
  s_cmp_eq_u32 s20, 0
  s_cbranch_scc1 L_st_nocand
  v_max_u32_dpp v76, v96, v96 row_ror:1 row_mask:0xf bank_mask:0xf
  s_nop 1
  v_max_u32_dpp v76, v76, v76 row_ror:2 row_mask:0xf bank_mask:0xf
  s_nop 1
  v_max_u32_dpp v76, v76, v76 row_ror:4 row_mask:0xf bank_mask:0xf
  s_nop 1
  v_max_u32_dpp v76, v76, v76 row_ror:8 row_mask:0xf bank_mask:0xf
  s_nop 0
  v_readlane_b32 s28, v76, 0
  v_readlane_b32 s24, v76, 16
  v_readlane_b32 s25, v76, 32
  v_readlane_b32 s26, v76, 48
  s_max_u32 s28, s28, s24
  s_max_u32 s25, s25, s26
  s_max_u32 s28, s28, s25
  v_cmp_eq_u32 s[30:31], s28, v96
  s_nop 1
  v_cndmask_b32 v77, v96, 0, s[30:31]
  s_nop 1
  v_max_u32_dpp v76, v77, v77 row_ror:1 row_mask:0xf bank_mask:0xf
  s_nop 1
  v_max_u32_dpp v76, v76, v76 row_ror:2 row_mask:0xf bank_mask:0xf
  s_nop 1
  v_max_u32_dpp v76, v76, v76 row_ror:4 row_mask:0xf bank_mask:0xf
  s_nop 1
  v_max_u32_dpp v76, v76, v76 row_ror:8 row_mask:0xf bank_mask:0xf
  s_nop 0
  v_readlane_b32 s29, v76, 0
  v_readlane_b32 s24, v76, 16
  v_readlane_b32 s25, v76, 32
  v_readlane_b32 s26, v76, 48
  s_max_u32 s29, s29, s24
  s_max_u32 s25, s25, s26
  s_max_u32 s29, s29, s25
  s_cmp_eq_u32 s5, 0
  s_nop 0
  s_cbranch_scc0 L_st_nocand
  v_cmp_eq_u32 vcc, s29, v96
  s_nop 1
  v_cndmask_b32 v102, v102, v103, vcc
  s_or_b64 exec, vcc, s[30:31]
  global_store_dwordx4 v102, v[96:99], s[60:61] sc1
  s_mov_b64 exec, -1
  s_nop 0
L_st_nocand:
  s_and_b32 s28, s28, 0x7ff
  s_and_b32 s29, s29, 0x7ff
  v_mov_b32 v76, s28
  v_mov_b32 v77, s29
  v_mov_b32 v78, 163240
  ds_write_b64 v78, v[76:77]
  ds_write_b64 v6, v[66:67] offset:512
  v_add_f32 v76, 1.0, v67
  v_sub_f32 v77, v64, v66
  v_fma_f32 v77, v77, v67, v64
  v_mul_f32 v78, v65, v76
  v_mul_f32 v78, v78, v76
  v_cvt_pk_bf16_f32 v79, v77, v77
  v_lshlrev_b32 v79, 16, v79
  v_max_f32 v82, 0, v78
  v_cvt_pk_bf16_f32 v82, v82, v82
  v_lshlrev_b32 v82, 16, v82
  v_add_f32 v82, 0x3727c5ac, v82
  v_cvt_pk_bf16_f32 v82, v82, v82
  v_lshlrev_b32 v82, 16, v82
  v_sqrt_f32 v82, v82
  s_nop 0
  v_cvt_pk_bf16_f32 v80, v82, v82
  v_lshlrev_b32 v80, 16, v80
  v_rcp_f32 v81, v80
  s_nop 0
  v_mul_f32 v76, v76, v81
  v_fma_f32 v77, v66, v67, v79
  v_mul_f32 v77, v77, v81
  ds_write_b64 v6, v[76:77]
  s_cmp_eq_u32 s8, 0
  s_cbranch_scc0 SK_l_30
  s_mul_i32 s20, s6, 5120
  s_lshr_b32 s21, s19, 1
  s_xor_b32 s21, s21, 1
  s_mul_i32 s22, s21, 40960
  s_add_u32 s22, s22, s20
  s_add_u32 s64, s40, s22
  s_addc_u32 s65, s41, 0
  s_add_u32 s64, s64, 163840
  s_addc_u32 s65, s65, 0
  s_add_u32 m0, s22, 71680
  s_nop 0
  global_load_lds_dwordx4 v0, s[64:65] offset:0 sc1
  global_load_lds_dwordx4 v0, s[64:65] offset:1024 sc1
  global_load_lds_dwordx4 v0, s[64:65] offset:2048 sc1
  global_load_lds_dwordx4 v0, s[64:65] offset:3072 sc1
  s_add_u32 s64, s64, 4096
  s_addc_u32 s65, s65, 0
  s_add_u32 m0, s22, 75776
  s_nop 0
  global_load_lds_dwordx4 v0, s[64:65] sc1
SK_l_30:
L_st_done:
  s_cmp_eq_u32 s8, 0
  s_cbranch_scc0 L_FINAL
L_S4:
  s_cmp_ge_u32 s6, 6
  s_cbranch_scc1 L_kv_b
  v_lshrrev_b32 v6, 4, v1
  v_and_b32 v6, 1, v6
  v_lshlrev_b32 v6, 2, v6
  v_and_b32 v7, 3, v1
  v_add_u32 v7, v7, v6
  s_mov_b32 s30, 0x75643120
  s_cmp_eq_u32 s17, 1
  s_cselect_b32 s30, 0x75641320, s30
  s_cmp_eq_u32 s17, 2
  s_cselect_b32 s30, 0x17645302, s30
  s_mul_i32 s21, s17, 6
  v_lshlrev_b32 v7, 2, v7
  v_lshrrev_b32 v8, v7, s30
  v_and_b32 v8, 15, v8
  v_add_u32 v8, s21, v8
  v_lshrrev_b32 v6, 5, v1
  v_lshlrev_b32 v6, 3, v6
  v_bfe_u32 v7, v1, 2, 2
  v_lshl_add_u32 v6, v7, 1, v6
  v_mul_u32_u24 v6, 160, v6
  v_lshl_add_u32 v100, v8, 3, v6
  v_add_u32 v101, 40960, v100
  s_mul_i32 s20, s18, 40960
  s_add_u32 s20, s20, 71680
  v_add_u32 v102, s20, v0
  v_and_b32 v6, 31, v1
  s_lshl_b32 s20, s18, 8
  s_add_u32 s20, s20, 161792
  v_lshl_add_u32 v84, v6, 3, s20
  v_lshrrev_b32 v7, 5, v1
  s_mul_i32 s21, s17, 96
  s_add_u32 s21, s21, 162816
  v_lshlrev_b32 v10, 2, v7
  v_lshrrev_b32 v10, v10, s30
  v_subrev_u32 v7, 1, v7
  s_mul_i32 s22, s18, 6144
  s_add_u32 s22, s22, 141312
  v_bfe_u32 v11, v10, 0, 4
  v_lshl_add_u32 v85, v11, 4, s21
  s_lshl_b32 s20, s17, 2
  s_add_u32 s20, s20, 0
  s_mul_i32 s23, s20, 11
  s_lshr_b32 s23, s23, 5
  s_mul_i32 s24, s23, 3
  s_sub_u32 s24, s20, s24
  s_mul_i32 s23, s23, 1536
  s_add_u32 s23, s23, s22
  s_lshl_b32 s25, s24, 3
  s_add_u32 s25, s25, s23
  v_add_u32 v89, s25, v0
  v_add_u32 v11, s23, v2
  s_cmp_eq_u32 s24, 2
  s_cselect_b64 vcc, -1, 0
  v_cndmask_b32 v89, v89, v11, vcc
  v_cndmask_b32 v93, -1, v7, vcc
  v_bfe_u32 v11, v10, 8, 4
  v_lshl_add_u32 v86, v11, 4, s21
  s_lshl_b32 s20, s17, 2
  s_add_u32 s20, s20, 1
  s_mul_i32 s23, s20, 11
  s_lshr_b32 s23, s23, 5
  s_mul_i32 s24, s23, 3
  s_sub_u32 s24, s20, s24
  s_mul_i32 s23, s23, 1536
  s_add_u32 s23, s23, s22
  s_lshl_b32 s25, s24, 3
  s_add_u32 s25, s25, s23
  v_add_u32 v90, s25, v0
  v_add_u32 v11, s23, v2
  s_cmp_eq_u32 s24, 2
  s_cselect_b64 vcc, -1, 0
  v_cndmask_b32 v90, v90, v11, vcc
  v_cndmask_b32 v94, -1, v7, vcc
  v_bfe_u32 v11, v10, 16, 4
  v_lshl_add_u32 v87, v11, 4, s21
  s_lshl_b32 s20, s17, 2
  s_add_u32 s20, s20, 2
  s_mul_i32 s23, s20, 11
  s_lshr_b32 s23, s23, 5
  s_mul_i32 s24, s23, 3
  s_sub_u32 s24, s20, s24
  s_mul_i32 s23, s23, 1536
  s_add_u32 s23, s23, s22
  s_lshl_b32 s25, s24, 3
  s_add_u32 s25, s25, s23
  v_add_u32 v91, s25, v0
  v_add_u32 v11, s23, v2
  s_cmp_eq_u32 s24, 2
  s_cselect_b64 vcc, -1, 0
  v_cndmask_b32 v91, v91, v11, vcc
  v_cndmask_b32 v95, -1, v7, vcc
  v_bfe_u32 v11, v10, 24, 4
  v_lshl_add_u32 v88, v11, 4, s21
  s_lshl_b32 s20, s17, 2
  s_add_u32 s20, s20, 3
  s_mul_i32 s23, s20, 11
  s_lshr_b32 s23, s23, 5
  s_mul_i32 s24, s23, 3
  s_sub_u32 s24, s20, s24
  s_mul_i32 s23, s23, 1536
  s_add_u32 s23, s23, s22
  s_lshl_b32 s25, s24, 3
  s_add_u32 s25, s25, s23
  v_add_u32 v92, s25, v0
  v_add_u32 v11, s23, v2
  s_cmp_eq_u32 s24, 2
  s_cselect_b64 vcc, -1, 0
  v_cndmask_b32 v92, v92, v11, vcc
  v_cndmask_b32 v96, -1, v7, vcc
  s_waitcnt vmcnt(5) lgkmcnt(0)
  s_barrier
  v_and_b32 v6, 31, v1
  s_lshl_b32 s20, s47, 8
  s_add_u32 s20, s20, 162304
  v_lshl_add_u32 v7, v6, 3, s20
  ds_read_b64 v[8:9], v7
  v_lshlrev_b32 v130, 16, v12
  v_and_b32 v131, 0xffff0000, v12
  v_lshlrev_b32 v132, 16, v13
  v_and_b32 v133, 0xffff0000, v13
  v_lshlrev_b32 v134, 16, v14
  v_and_b32 v135, 0xffff0000, v14
  v_lshlrev_b32 v136, 16, v15
  v_and_b32 v137, 0xffff0000, v15
  v_lshlrev_b32 v138, 16, v16
  v_and_b32 v139, 0xffff0000, v16
  v_lshlrev_b32 v140, 16, v17
  v_and_b32 v141, 0xffff0000, v17
  v_lshlrev_b32 v142, 16, v18
  v_and_b32 v143, 0xffff0000, v18
  v_lshlrev_b32 v144, 16, v19
  v_and_b32 v145, 0xffff0000, v19
  s_waitcnt lgkmcnt(0)
  v_sub_f32 v150, v130, v8
  v_sub_f32 v151, v131, v8
  v_sub_f32 v152, v132, v8
  v_sub_f32 v153, v133, v8
  v_sub_f32 v154, v134, v8
  v_sub_f32 v155, v135, v8
  v_sub_f32 v156, v136, v8
  v_sub_f32 v157, v137, v8
  v_sub_f32 v158, v138, v8
  v_sub_f32 v159, v139, v8
  v_sub_f32 v160, v140, v8
  v_sub_f32 v161, v141, v8
  v_sub_f32 v162, v142, v8
  v_sub_f32 v163, v143, v8
  v_sub_f32 v164, v144, v8
  v_sub_f32 v165, v145, v8
  v_cvt_pk_bf16_f32 v150, v150, v151
  v_cvt_pk_bf16_f32 v152, v152, v153
  v_cvt_pk_bf16_f32 v154, v154, v155
  v_cvt_pk_bf16_f32 v156, v156, v157
  v_cvt_pk_bf16_f32 v158, v158, v159
  v_cvt_pk_bf16_f32 v160, v160, v161
  v_cvt_pk_bf16_f32 v162, v162, v163
  v_cvt_pk_bf16_f32 v164, v164, v165
  v_and_b32 v151, 0xffff0000, v150
  v_lshlrev_b32 v150, 16, v150
  v_and_b32 v153, 0xffff0000, v152
  v_lshlrev_b32 v152, 16, v152
  v_and_b32 v155, 0xffff0000, v154
  v_lshlrev_b32 v154, 16, v154
  v_and_b32 v157, 0xffff0000, v156
  v_lshlrev_b32 v156, 16, v156
  v_and_b32 v159, 0xffff0000, v158
  v_lshlrev_b32 v158, 16, v158
  v_and_b32 v161, 0xffff0000, v160
  v_lshlrev_b32 v160, 16, v160
  v_and_b32 v163, 0xffff0000, v162
  v_lshlrev_b32 v162, 16, v162
  v_and_b32 v165, 0xffff0000, v164
  v_lshlrev_b32 v164, 16, v164
  v_mul_f32 v150, v150, v9
  v_mul_f32 v151, v151, v9
  v_mul_f32 v152, v152, v9
  v_mul_f32 v153, v153, v9
  v_mul_f32 v154, v154, v9
  v_mul_f32 v155, v155, v9
  v_mul_f32 v156, v156, v9
  v_mul_f32 v157, v157, v9
  v_mul_f32 v158, v158, v9
  v_mul_f32 v159, v159, v9
  v_mul_f32 v160, v160, v9
  v_mul_f32 v161, v161, v9
  v_mul_f32 v162, v162, v9
  v_mul_f32 v163, v163, v9
  v_mul_f32 v164, v164, v9
  v_mul_f32 v165, v165, v9
  v_cvt_pk_bf16_f32 v150, v150, v151
  v_cvt_pk_bf16_f32 v152, v152, v153
  v_cvt_pk_bf16_f32 v154, v154, v155
  v_cvt_pk_bf16_f32 v156, v156, v157
  v_cvt_pk_bf16_f32 v158, v158, v159
  v_cvt_pk_bf16_f32 v160, v160, v161
  v_cvt_pk_bf16_f32 v162, v162, v163
  v_cvt_pk_bf16_f32 v164, v164, v165
  v_and_b32 v151, 0xffff0000, v150
  v_lshlrev_b32 v150, 16, v150
  v_and_b32 v153, 0xffff0000, v152
  v_lshlrev_b32 v152, 16, v152
  v_and_b32 v155, 0xffff0000, v154
  v_lshlrev_b32 v154, 16, v154
  v_and_b32 v157, 0xffff0000, v156
  v_lshlrev_b32 v156, 16, v156
  v_and_b32 v159, 0xffff0000, v158
  v_lshlrev_b32 v158, 16, v158
  v_and_b32 v161, 0xffff0000, v160
  v_lshlrev_b32 v160, 16, v160
  v_and_b32 v163, 0xffff0000, v162
  v_lshlrev_b32 v162, 16, v162
  v_and_b32 v165, 0xffff0000, v164
  v_lshlrev_b32 v164, 16, v164
  v_add_f32 v130, v130, v150
  v_add_f32 v131, v131, v151
  v_add_f32 v132, v132, v152
  v_add_f32 v133, v133, v153
  v_add_f32 v134, v134, v154
  v_add_f32 v135, v135, v155
  v_add_f32 v136, v136, v156
  v_add_f32 v137, v137, v157
  v_add_f32 v138, v138, v158
  v_add_f32 v139, v139, v159
  v_add_f32 v140, v140, v160
  v_add_f32 v141, v141, v161
  v_add_f32 v142, v142, v162
  v_add_f32 v143, v143, v163
  v_add_f32 v144, v144, v164
  v_add_f32 v145, v145, v165
  v_cvt_pk_bf16_f32 v12, v130, v131
  v_cvt_pk_bf16_f32 v13, v132, v133
  v_cvt_pk_bf16_f32 v14, v134, v135
  v_cvt_pk_bf16_f32 v15, v136, v137
  v_cvt_pk_bf16_f32 v16, v138, v139
  v_cvt_pk_bf16_f32 v17, v140, v141
  v_cvt_pk_bf16_f32 v18, v142, v143
  v_cvt_pk_bf16_f32 v19, v144, v145
  s_waitcnt vmcnt(0)
  s_barrier
  s_and_b32 s20, s6, 6
  s_cmp_eq_u32 s20, 2
  s_cbranch_scc1 L_q_r_b
  ds_read_b128 v[132:135], v102 offset:0
  ds_read_b64_tr_b16 v[128:129], v100 offset:30720
  ds_read_b64_tr_b16 v[130:131], v100 offset:30880
  ds_read_b128 v[140:143], v102 offset:1024
  ds_read_b64_tr_b16 v[136:137], v100 offset:33280
  ds_read_b64_tr_b16 v[138:139], v100 offset:33440
  ds_read_b128 v[148:151], v102 offset:2048
  ds_read_b64_tr_b16 v[144:145], v100 offset:35840
  ds_read_b64_tr_b16 v[146:147], v100 offset:36000
  ds_read_b128 v[156:159], v102 offset:3072
  ds_read_b64_tr_b16 v[152:153], v100 offset:38400
  ds_read_b64_tr_b16 v[154:155], v100 offset:38560
  s_waitcnt lgkmcnt(9)
  v_mfma_f32_32x32x16_bf16 v[112:127], v[128:131], v[132:135], 0
  ds_read_b128 v[132:135], v102 offset:4096
  ds_read_b64_tr_b16 v[128:129], v101 offset:0
  ds_read_b64_tr_b16 v[130:131], v101 offset:160
  s_waitcnt lgkmcnt(9)
  v_mfma_f32_32x32x16_bf16 v[112:127], v[136:139], v[140:143], v[112:127]
  ds_read_b128 v[140:143], v102 offset:5120
  ds_read_b64_tr_b16 v[136:137], v101 offset:2560
  ds_read_b64_tr_b16 v[138:139], v101 offset:2720
  s_waitcnt lgkmcnt(9)
  v_mfma_f32_32x32x16_bf16 v[112:127], v[144:147], v[148:151], v[112:127]
  ds_read_b128 v[148:151], v102 offset:6144
  ds_read_b64_tr_b16 v[144:145], v101 offset:5120
  ds_read_b64_tr_b16 v[146:147], v101 offset:5280
  s_waitcnt lgkmcnt(9)
  v_mfma_f32_32x32x16_bf16 v[112:127], v[152:155], v[156:159], v[112:127]
  ds_read_b128 v[156:159], v102 offset:7168
  ds_read_b64_tr_b16 v[152:153], v101 offset:7680
  ds_read_b64_tr_b16 v[154:155], v101 offset:7840
  s_waitcnt lgkmcnt(9)
  v_mfma_f32_32x32x16_bf16 v[112:127], v[128:131], v[132:135], v[112:127]
  ds_read_b128 v[132:135], v102 offset:8192
  ds_read_b64_tr_b16 v[128:129], v101 offset:10240
  ds_read_b64_tr_b16 v[130:131], v101 offset:10400
  s_waitcnt lgkmcnt(9)
  v_mfma_f32_32x32x16_bf16 v[112:127], v[136:139], v[140:143], v[112:127]
  ds_read_b128 v[140:143], v102 offset:9216
  ds_read_b64_tr_b16 v[136:137], v101 offset:12800
  ds_read_b64_tr_b16 v[138:139], v101 offset:12960
  s_waitcnt lgkmcnt(9)
  v_mfma_f32_32x32x16_bf16 v[112:127], v[144:147], v[148:151], v[112:127]
  ds_read_b128 v[148:151], v102 offset:10240
  ds_read_b64_tr_b16 v[144:145], v101 offset:15360
  ds_read_b64_tr_b16 v[146:147], v101 offset:15520
  s_waitcnt lgkmcnt(9)
  v_mfma_f32_32x32x16_bf16 v[112:127], v[152:155], v[156:159], v[112:127]
  ds_read_b128 v[156:159], v102 offset:11264
  ds_read_b64_tr_b16 v[152:153], v101 offset:17920
  ds_read_b64_tr_b16 v[154:155], v101 offset:18080
  s_waitcnt lgkmcnt(9)
  v_mfma_f32_32x32x16_bf16 v[112:127], v[128:131], v[132:135], v[112:127]
  ds_read_b128 v[132:135], v102 offset:12288
  ds_read_b64_tr_b16 v[128:129], v101 offset:20480
  ds_read_b64_tr_b16 v[130:131], v101 offset:20640
  s_waitcnt lgkmcnt(9)
  v_mfma_f32_32x32x16_bf16 v[112:127], v[136:139], v[140:143], v[112:127]
  ds_read_b128 v[140:143], v102 offset:13312
  ds_read_b64_tr_b16 v[136:137], v101 offset:23040
  ds_read_b64_tr_b16 v[138:139], v101 offset:23200
  s_waitcnt lgkmcnt(9)
  v_mfma_f32_32x32x16_bf16 v[112:127], v[144:147], v[148:151], v[112:127]
  ds_read_b128 v[148:151], v102 offset:14336
  ds_read_b64_tr_b16 v[144:145], v101 offset:25600
  ds_read_b64_tr_b16 v[146:147], v101 offset:25760
  s_waitcnt lgkmcnt(9)
  v_mfma_f32_32x32x16_bf16 v[112:127], v[152:155], v[156:159], v[112:127]
  s_barrier
  ds_read_b128 v[156:159], v102 offset:15360
  ds_read_b64_tr_b16 v[152:153], v101 offset:28160
  ds_read_b64_tr_b16 v[154:155], v101 offset:28320
  s_waitcnt lgkmcnt(9)
  v_mfma_f32_32x32x16_bf16 v[112:127], v[128:131], v[132:135], v[112:127]
  s_waitcnt lgkmcnt(6)
  v_mfma_f32_32x32x16_bf16 v[112:127], v[136:139], v[140:143], v[112:127]
  s_waitcnt lgkmcnt(3)
  v_mfma_f32_32x32x16_bf16 v[112:127], v[144:147], v[148:151], v[112:127]
  s_waitcnt lgkmcnt(0)
  v_mfma_f32_32x32x16_bf16 v[112:127], v[152:155], v[156:159], v[112:127]
  s_barrier
  ds_read_b128 v[132:135], v102 offset:16384
  ds_read_b64_tr_b16 v[128:129], v100 offset:0
  ds_read_b64_tr_b16 v[130:131], v100 offset:160
  ds_read_b128 v[140:143], v102 offset:17408
  ds_read_b64_tr_b16 v[136:137], v100 offset:2560
  ds_read_b64_tr_b16 v[138:139], v100 offset:2720
  ds_read_b128 v[148:151], v102 offset:18432
  ds_read_b64_tr_b16 v[144:145], v100 offset:5120
  ds_read_b64_tr_b16 v[146:147], v100 offset:5280
  ds_read_b128 v[156:159], v102 offset:19456
  ds_read_b64_tr_b16 v[152:153], v100 offset:7680
  ds_read_b64_tr_b16 v[154:155], v100 offset:7840
  s_waitcnt lgkmcnt(9)
  v_mfma_f32_32x32x16_bf16 v[112:127], v[128:131], v[132:135], v[112:127]
  ds_read_b128 v[132:135], v102 offset:20480
  ds_read_b64_tr_b16 v[128:129], v100 offset:10240
  ds_read_b64_tr_b16 v[130:131], v100 offset:10400
  s_waitcnt lgkmcnt(9)
  v_mfma_f32_32x32x16_bf16 v[112:127], v[136:139], v[140:143], v[112:127]
  ds_read_b128 v[140:143], v102 offset:21504
  ds_read_b64_tr_b16 v[136:137], v100 offset:12800
  ds_read_b64_tr_b16 v[138:139], v100 offset:12960
  s_waitcnt lgkmcnt(9)
  v_mfma_f32_32x32x16_bf16 v[112:127], v[144:147], v[148:151], v[112:127]
  ds_read_b128 v[148:151], v102 offset:22528
  ds_read_b64_tr_b16 v[144:145], v100 offset:15360
  ds_read_b64_tr_b16 v[146:147], v100 offset:15520
  s_waitcnt lgkmcnt(9)
  v_mfma_f32_32x32x16_bf16 v[112:127], v[152:155], v[156:159], v[112:127]
  ds_read_b128 v[156:159], v102 offset:23552
  ds_read_b64_tr_b16 v[152:153], v100 offset:17920
  ds_read_b64_tr_b16 v[154:155], v100 offset:18080
  s_waitcnt lgkmcnt(9)
  v_mfma_f32_32x32x16_bf16 v[112:127], v[128:131], v[132:135], v[112:127]
  ds_read_b128 v[132:135], v102 offset:24576
  ds_read_b64_tr_b16 v[128:129], v100 offset:20480
  ds_read_b64_tr_b16 v[130:131], v100 offset:20640
  s_waitcnt lgkmcnt(9)
  v_mfma_f32_32x32x16_bf16 v[112:127], v[136:139], v[140:143], v[112:127]
  ds_read_b128 v[140:143], v102 offset:25600
  ds_read_b64_tr_b16 v[136:137], v100 offset:23040
  ds_read_b64_tr_b16 v[138:139], v100 offset:23200
  s_waitcnt lgkmcnt(9)
  v_mfma_f32_32x32x16_bf16 v[112:127], v[144:147], v[148:151], v[112:127]
  ds_read_b128 v[148:151], v102 offset:26624
  ds_read_b64_tr_b16 v[144:145], v100 offset:25600
  ds_read_b64_tr_b16 v[146:147], v100 offset:25760
  s_waitcnt lgkmcnt(9)
  v_mfma_f32_32x32x16_bf16 v[112:127], v[152:155], v[156:159], v[112:127]
  ds_read_b128 v[156:159], v102 offset:27648
  ds_read_b64_tr_b16 v[152:153], v100 offset:28160
  ds_read_b64_tr_b16 v[154:155], v100 offset:28320
  s_waitcnt lgkmcnt(9)
  v_mfma_f32_32x32x16_bf16 v[112:127], v[128:131], v[132:135], v[112:127]
  s_waitcnt lgkmcnt(6)
  v_mfma_f32_32x32x16_bf16 v[112:127], v[136:139], v[140:143], v[112:127]
  s_waitcnt lgkmcnt(3)
  v_mfma_f32_32x32x16_bf16 v[112:127], v[144:147], v[148:151], v[112:127]
  s_waitcnt lgkmcnt(0)
  v_mfma_f32_32x32x16_bf16 v[112:127], v[152:155], v[156:159], v[112:127]
  s_nop 11
  s_branch L_q_s2e_b
L_q_r_b:
  s_and_b32 s27, s6, 1
  ds_read_b128 v[132:135], v102 offset:0
  ds_read_b64_tr_b16 v[128:129], v100 offset:30720
  ds_read_b64_tr_b16 v[130:131], v100 offset:30880
  ds_read_b128 v[140:143], v102 offset:1024
  ds_read_b64_tr_b16 v[136:137], v100 offset:33280
  ds_read_b64_tr_b16 v[138:139], v100 offset:33440
  ds_read_b128 v[148:151], v102 offset:2048
  ds_read_b64_tr_b16 v[144:145], v100 offset:35840
  ds_read_b64_tr_b16 v[146:147], v100 offset:36000
  ds_read_b128 v[156:159], v102 offset:3072
  ds_read_b64_tr_b16 v[152:153], v100 offset:38400
  ds_read_b64_tr_b16 v[154:155], v100 offset:38560
  s_waitcnt lgkmcnt(9)
  v_mfma_f32_32x32x16_bf16 v[112:127], v[128:131], v[132:135], 0
  s_mul_i32 s21, s27, 40960
  s_add_u32 s21, s21, 327680
  s_add_u32 s64, s38, s21
  s_addc_u32 s65, s39, 0
  s_mul_i32 s76, s27, 5120
  s_add_u32 s76, s76, 0
  s_mov_b32 m0, s76
  s_nop 0
  global_load_lds_dwordx4 v250, s[64:65] offset:0
  ds_read_b128 v[132:135], v102 offset:4096
  ds_read_b64_tr_b16 v[128:129], v101 offset:0
  ds_read_b64_tr_b16 v[130:131], v101 offset:160
  s_waitcnt lgkmcnt(9)
  v_mfma_f32_32x32x16_bf16 v[112:127], v[136:139], v[140:143], v[112:127]
  s_mov_b32 m0, s76
  s_nop 0
  global_load_lds_dwordx4 v251, s[64:65] offset:1024
  ds_read_b128 v[140:143], v102 offset:5120
  ds_read_b64_tr_b16 v[136:137], v101 offset:2560
  ds_read_b64_tr_b16 v[138:139], v101 offset:2720
  s_waitcnt lgkmcnt(9)
  v_mfma_f32_32x32x16_bf16 v[112:127], v[144:147], v[148:151], v[112:127]
  s_mov_b32 m0, s76
  s_nop 0
  global_load_lds_dwordx4 v252, s[64:65] offset:2048
  ds_read_b128 v[148:151], v102 offset:6144
  ds_read_b64_tr_b16 v[144:145], v101 offset:5120
  ds_read_b64_tr_b16 v[146:147], v101 offset:5280
  s_waitcnt lgkmcnt(9)
  v_mfma_f32_32x32x16_bf16 v[112:127], v[152:155], v[156:159], v[112:127]
  s_mov_b32 m0, s76
  s_nop 0
  global_load_lds_dwordx4 v253, s[64:65] offset:3072
  ds_read_b128 v[156:159], v102 offset:7168
  ds_read_b64_tr_b16 v[152:153], v101 offset:7680
  ds_read_b64_tr_b16 v[154:155], v101 offset:7840
  s_waitcnt lgkmcnt(9)
  v_mfma_f32_32x32x16_bf16 v[112:127], v[128:131], v[132:135], v[112:127]
  s_add_u32 m0, s76, 4096
  s_nop 0
  global_load_lds_dwordx4 v254, s[64:65]
  ds_read_b128 v[132:135], v102 offset:8192
  ds_read_b64_tr_b16 v[128:129], v101 offset:10240
  ds_read_b64_tr_b16 v[130:131], v101 offset:10400
  s_waitcnt lgkmcnt(9)
  v_mfma_f32_32x32x16_bf16 v[112:127], v[136:139], v[140:143], v[112:127]
  s_mul_i32 s21, s27, 40960
  s_add_u32 s21, s21, 409600
  s_add_u32 s64, s38, s21
  s_addc_u32 s65, s39, 0
  s_mul_i32 s76, s27, 5120
  s_add_u32 s76, s76, 10240
  s_mov_b32 m0, s76
  s_nop 0
  global_load_lds_dwordx4 v250, s[64:65] offset:0
  ds_read_b128 v[140:143], v102 offset:9216
  ds_read_b64_tr_b16 v[136:137], v101 offset:12800
  ds_read_b64_tr_b16 v[138:139], v101 offset:12960
  s_waitcnt lgkmcnt(9)
  v_mfma_f32_32x32x16_bf16 v[112:127], v[144:147], v[148:151], v[112:127]
  s_mov_b32 m0, s76
  s_nop 0
  global_load_lds_dwordx4 v251, s[64:65] offset:1024
  ds_read_b128 v[148:151], v102 offset:10240
  ds_read_b64_tr_b16 v[144:145], v101 offset:15360
  ds_read_b64_tr_b16 v[146:147], v101 offset:15520
  s_waitcnt lgkmcnt(9)
  v_mfma_f32_32x32x16_bf16 v[112:127], v[152:155], v[156:159], v[112:127]
  s_mov_b32 m0, s76
  s_nop 0
  global_load_lds_dwordx4 v252, s[64:65] offset:2048
  ds_read_b128 v[156:159], v102 offset:11264
  ds_read_b64_tr_b16 v[152:153], v101 offset:17920
  ds_read_b64_tr_b16 v[154:155], v101 offset:18080
  s_waitcnt lgkmcnt(9)
  v_mfma_f32_32x32x16_bf16 v[112:127], v[128:131], v[132:135], v[112:127]
  s_mov_b32 m0, s76
  s_nop 0
  global_load_lds_dwordx4 v253, s[64:65] offset:3072
  ds_read_b128 v[132:135], v102 offset:12288
  ds_read_b64_tr_b16 v[128:129], v101 offset:20480
  ds_read_b64_tr_b16 v[130:131], v101 offset:20640
  s_waitcnt lgkmcnt(9)
  v_mfma_f32_32x32x16_bf16 v[112:127], v[136:139], v[140:143], v[112:127]
  s_add_u32 m0, s76, 4096
  s_nop 0
  global_load_lds_dwordx4 v254, s[64:65]
  ds_read_b128 v[140:143], v102 offset:13312
  ds_read_b64_tr_b16 v[136:137], v101 offset:23040
  ds_read_b64_tr_b16 v[138:139], v101 offset:23200
  s_waitcnt lgkmcnt(9)
  v_mfma_f32_32x32x16_bf16 v[112:127], v[144:147], v[148:151], v[112:127]
  s_mul_i32 s21, s27, 40960
  s_add_u32 s21, s21, 491520
  s_add_u32 s64, s38, s21
  s_addc_u32 s65, s39, 0
  s_mul_i32 s76, s27, 5120
  s_add_u32 s76, s76, 20480
  s_mov_b32 m0, s76
  s_nop 0
  global_load_lds_dwordx4 v250, s[64:65] offset:0
  ds_read_b128 v[148:151], v102 offset:14336
  ds_read_b64_tr_b16 v[144:145], v101 offset:25600
  ds_read_b64_tr_b16 v[146:147], v101 offset:25760
  s_waitcnt lgkmcnt(9)
  v_mfma_f32_32x32x16_bf16 v[112:127], v[152:155], v[156:159], v[112:127]
  s_mov_b32 m0, s76
  s_nop 0
  global_load_lds_dwordx4 v251, s[64:65] offset:1024
  s_mov_b32 m0, s76
  s_nop 0
  global_load_lds_dwordx4 v252, s[64:65] offset:2048
  s_mov_b32 m0, s76
  s_nop 0
  global_load_lds_dwordx4 v253, s[64:65] offset:3072
  s_add_u32 m0, s76, 4096
  s_nop 0
  global_load_lds_dwordx4 v254, s[64:65]
  s_barrier
  ds_read_b128 v[156:159], v102 offset:15360
  ds_read_b64_tr_b16 v[152:153], v101 offset:28160
  ds_read_b64_tr_b16 v[154:155], v101 offset:28320
  s_waitcnt lgkmcnt(9)
  v_mfma_f32_32x32x16_bf16 v[112:127], v[128:131], v[132:135], v[112:127]
  s_mul_i32 s21, s27, 40960
  s_add_u32 s21, s21, 573440
  s_add_u32 s64, s38, s21
  s_addc_u32 s65, s39, 0
  s_mul_i32 s76, s27, 5120
  s_add_u32 s76, s76, 30720
  s_mov_b32 m0, s76
  s_nop 0
  global_load_lds_dwordx4 v250, s[64:65] offset:0
  s_waitcnt lgkmcnt(6)
  v_mfma_f32_32x32x16_bf16 v[112:127], v[136:139], v[140:143], v[112:127]
  s_mov_b32 m0, s76
  s_nop 0
  global_load_lds_dwordx4 v251, s[64:65] offset:1024
  s_waitcnt lgkmcnt(3)
  v_mfma_f32_32x32x16_bf16 v[112:127], v[144:147], v[148:151], v[112:127]
  s_mov_b32 m0, s76
  s_nop 0
  global_load_lds_dwordx4 v252, s[64:65] offset:2048
  s_waitcnt lgkmcnt(0)
  v_mfma_f32_32x32x16_bf16 v[112:127], v[152:155], v[156:159], v[112:127]
  s_mov_b32 m0, s76
  s_nop 0
  global_load_lds_dwordx4 v253, s[64:65] offset:3072
  s_waitcnt vmcnt(4)
  s_barrier
  ds_read_b128 v[132:135], v102 offset:16384
  ds_read_b64_tr_b16 v[128:129], v100 offset:0
  ds_read_b64_tr_b16 v[130:131], v100 offset:160
  ds_read_b128 v[140:143], v102 offset:17408
  ds_read_b64_tr_b16 v[136:137], v100 offset:2560
  ds_read_b64_tr_b16 v[138:139], v100 offset:2720
  ds_read_b128 v[148:151], v102 offset:18432
  ds_read_b64_tr_b16 v[144:145], v100 offset:5120
  ds_read_b64_tr_b16 v[146:147], v100 offset:5280
  ds_read_b128 v[156:159], v102 offset:19456
  ds_read_b64_tr_b16 v[152:153], v100 offset:7680
  ds_read_b64_tr_b16 v[154:155], v100 offset:7840
  s_waitcnt lgkmcnt(9)
  v_mfma_f32_32x32x16_bf16 v[112:127], v[128:131], v[132:135], v[112:127]
  s_add_u32 m0, s76, 4096
  s_nop 0
  global_load_lds_dwordx4 v254, s[64:65]
  ds_read_b128 v[132:135], v102 offset:20480
  ds_read_b64_tr_b16 v[128:129], v100 offset:10240
  ds_read_b64_tr_b16 v[130:131], v100 offset:10400
  s_waitcnt lgkmcnt(9)
  v_mfma_f32_32x32x16_bf16 v[112:127], v[136:139], v[140:143], v[112:127]
  s_mul_i32 s21, s27, 40960
  s_add_u32 s21, s21, 655360
  s_add_u32 s64, s38, s21
  s_addc_u32 s65, s39, 0
  s_mul_i32 s76, s27, 5120
  s_add_u32 s76, s76, 40960
  s_mov_b32 m0, s76
  s_nop 0
  global_load_lds_dwordx4 v250, s[64:65] offset:0
  ds_read_b128 v[140:143], v102 offset:21504
  ds_read_b64_tr_b16 v[136:137], v100 offset:12800
  ds_read_b64_tr_b16 v[138:139], v100 offset:12960
  s_waitcnt lgkmcnt(9)
  v_mfma_f32_32x32x16_bf16 v[112:127], v[144:147], v[148:151], v[112:127]
  s_mov_b32 m0, s76
  s_nop 0
  global_load_lds_dwordx4 v251, s[64:65] offset:1024
  ds_read_b128 v[148:151], v102 offset:22528
  ds_read_b64_tr_b16 v[144:145], v100 offset:15360
  ds_read_b64_tr_b16 v[146:147], v100 offset:15520
  s_waitcnt lgkmcnt(9)
  v_mfma_f32_32x32x16_bf16 v[112:127], v[152:155], v[156:159], v[112:127]
  s_mov_b32 m0, s76
  s_nop 0
  global_load_lds_dwordx4 v252, s[64:65] offset:2048
  ds_read_b128 v[156:159], v102 offset:23552
  ds_read_b64_tr_b16 v[152:153], v100 offset:17920
  ds_read_b64_tr_b16 v[154:155], v100 offset:18080
  s_waitcnt lgkmcnt(9)
  v_mfma_f32_32x32x16_bf16 v[112:127], v[128:131], v[132:135], v[112:127]
  s_mov_b32 m0, s76
  s_nop 0
  global_load_lds_dwordx4 v253, s[64:65] offset:3072
  ds_read_b128 v[132:135], v102 offset:24576
  ds_read_b64_tr_b16 v[128:129], v100 offset:20480
  ds_read_b64_tr_b16 v[130:131], v100 offset:20640
  s_waitcnt lgkmcnt(9)
  v_mfma_f32_32x32x16_bf16 v[112:127], v[136:139], v[140:143], v[112:127]
  s_add_u32 m0, s76, 4096
  s_nop 0
  global_load_lds_dwordx4 v254, s[64:65]
  ds_read_b128 v[140:143], v102 offset:25600
  ds_read_b64_tr_b16 v[136:137], v100 offset:23040
  ds_read_b64_tr_b16 v[138:139], v100 offset:23200
  s_waitcnt lgkmcnt(9)
  v_mfma_f32_32x32x16_bf16 v[112:127], v[144:147], v[148:151], v[112:127]
  s_mul_i32 s21, s27, 40960
  s_add_u32 s21, s21, 737280
  s_add_u32 s64, s38, s21
  s_addc_u32 s65, s39, 0
  s_mul_i32 s76, s27, 5120
  s_add_u32 s76, s76, 51200
  s_mov_b32 m0, s76
  s_nop 0
  global_load_lds_dwordx4 v250, s[64:65] offset:0
  ds_read_b128 v[148:151], v102 offset:26624
  ds_read_b64_tr_b16 v[144:145], v100 offset:25600
  ds_read_b64_tr_b16 v[146:147], v100 offset:25760
  s_waitcnt lgkmcnt(9)
  v_mfma_f32_32x32x16_bf16 v[112:127], v[152:155], v[156:159], v[112:127]
  s_mov_b32 m0, s76
  s_nop 0
  global_load_lds_dwordx4 v251, s[64:65] offset:1024
  ds_read_b128 v[156:159], v102 offset:27648
  ds_read_b64_tr_b16 v[152:153], v100 offset:28160
  ds_read_b64_tr_b16 v[154:155], v100 offset:28320
  s_waitcnt lgkmcnt(9)
  v_mfma_f32_32x32x16_bf16 v[112:127], v[128:131], v[132:135], v[112:127]
  s_mov_b32 m0, s76
  s_nop 0
  global_load_lds_dwordx4 v252, s[64:65] offset:2048
  s_waitcnt lgkmcnt(6)
  v_mfma_f32_32x32x16_bf16 v[112:127], v[136:139], v[140:143], v[112:127]
  s_mov_b32 m0, s76
  s_nop 0
  global_load_lds_dwordx4 v253, s[64:65] offset:3072
  s_waitcnt lgkmcnt(3)
  v_mfma_f32_32x32x16_bf16 v[112:127], v[144:147], v[148:151], v[112:127]
  s_add_u32 m0, s76, 4096
  s_nop 0
  global_load_lds_dwordx4 v254, s[64:65]
  s_waitcnt lgkmcnt(0)
  v_mfma_f32_32x32x16_bf16 v[112:127], v[152:155], v[156:159], v[112:127]
  s_waitcnt vmcnt(0)
  s_nop 10
L_q_s2e_b:
  s_barrier
  s_and_b32 s22, s6, 3
  s_mul_i32 s20, s22, 7168
  s_add_u32 s62, s60, s20
  s_addc_u32 s63, s61, 0
  s_add_u32 s62, s62, 262144
  s_addc_u32 s63, s63, 0
  s_lshl_b32 s20, s22, 10
  s_add_u32 s20, s20, 557056
  v_lshrrev_b32 v248, 3, v1
  v_lshlrev_b32 v248, 12, v248
  v_and_b32 v249, 7, v1
  v_lshl_add_u32 v248, v249, 7, v248
  v_add_u32 v248, s20, v248
  s_mov_b32 s34, 0x01010101
  s_mov_b32 s35, 0x01010101
  v_mov_b32 v249, s7
  s_mov_b32 s10, 0
  s_mov_b64 s[100:101], 0
  s_mul_i32 s21, s8, 4096
  s_add_u32 s21, s21, 655360
  v_lshrrev_b32 v60, 1, v1
  v_lshlrev_b32 v60, 7, v60
  v_and_b32 v61, 1, v1
  v_lshl_add_u32 v60, v61, 4, v60
  v_add_u32 v60, s21, v60
  global_load_dwordx4 v[64:67], v60, s[60:61] sc1
  ds_read_b128 v[132:135], v102 offset:28672
  ds_read_b64_tr_b16 v[128:129], v100 offset:30720
  ds_read_b64_tr_b16 v[130:131], v100 offset:30880
  ds_read_b128 v[140:143], v102 offset:29696
  ds_read_b64_tr_b16 v[136:137], v100 offset:33280
  ds_read_b64_tr_b16 v[138:139], v100 offset:33440
  ds_read_b128 v[148:151], v102 offset:30720
  ds_read_b64_tr_b16 v[144:145], v100 offset:35840
  ds_read_b64_tr_b16 v[146:147], v100 offset:36000
  ds_read_b128 v[156:159], v102 offset:31744
  ds_read_b64_tr_b16 v[152:153], v100 offset:38400
  ds_read_b64_tr_b16 v[154:155], v100 offset:38560
  s_waitcnt lgkmcnt(9)
  v_mfma_f32_32x32x16_bf16 v[112:127], v[128:131], v[132:135], v[112:127]
  ds_read_b128 v[132:135], v102 offset:32768
  ds_read_b64_tr_b16 v[128:129], v101 offset:0
  ds_read_b64_tr_b16 v[130:131], v101 offset:160
  s_waitcnt lgkmcnt(9)
  v_mfma_f32_32x32x16_bf16 v[112:127], v[136:139], v[140:143], v[112:127]
  ds_read_b128 v[140:143], v102 offset:33792
  ds_read_b64_tr_b16 v[136:137], v101 offset:2560
  ds_read_b64_tr_b16 v[138:139], v101 offset:2720
  s_waitcnt lgkmcnt(9)
  v_mfma_f32_32x32x16_bf16 v[112:127], v[144:147], v[148:151], v[112:127]
  ds_read_b128 v[148:151], v102 offset:34816
  ds_read_b64_tr_b16 v[144:145], v101 offset:5120
  ds_read_b64_tr_b16 v[146:147], v101 offset:5280
  s_waitcnt lgkmcnt(9)
  v_mfma_f32_32x32x16_bf16 v[112:127], v[152:155], v[156:159], v[112:127]
  ds_read_b128 v[156:159], v102 offset:35840
  ds_read_b64_tr_b16 v[152:153], v101 offset:7680
  ds_read_b64_tr_b16 v[154:155], v101 offset:7840
  s_waitcnt lgkmcnt(9)
  v_mfma_f32_32x32x16_bf16 v[112:127], v[128:131], v[132:135], v[112:127]
  ds_read_b128 v[132:135], v102 offset:36864
  ds_read_b64_tr_b16 v[128:129], v101 offset:10240
  ds_read_b64_tr_b16 v[130:131], v101 offset:10400
  s_waitcnt lgkmcnt(9)
  v_mfma_f32_32x32x16_bf16 v[112:127], v[136:139], v[140:143], v[112:127]
  ds_read_b128 v[140:143], v102 offset:37888
  ds_read_b64_tr_b16 v[136:137], v101 offset:12800
  ds_read_b64_tr_b16 v[138:139], v101 offset:12960
  s_waitcnt lgkmcnt(9)
  v_mfma_f32_32x32x16_bf16 v[112:127], v[144:147], v[148:151], v[112:127]
  ds_read_b128 v[148:151], v102 offset:38912
  ds_read_b64_tr_b16 v[144:145], v101 offset:15360
  ds_read_b64_tr_b16 v[146:147], v101 offset:15520
  s_waitcnt lgkmcnt(9)
  v_mfma_f32_32x32x16_bf16 v[112:127], v[152:155], v[156:159], v[112:127]
  ds_read_b128 v[156:159], v102 offset:39936
  ds_read_b64_tr_b16 v[152:153], v101 offset:17920
  ds_read_b64_tr_b16 v[154:155], v101 offset:18080
  s_waitcnt lgkmcnt(9)
  v_mfma_f32_32x32x16_bf16 v[112:127], v[128:131], v[132:135], v[112:127]
  s_waitcnt lgkmcnt(6)
  v_mfma_f32_32x32x16_bf16 v[112:127], v[136:139], v[140:143], v[112:127]
  s_waitcnt lgkmcnt(3)
  v_mfma_f32_32x32x16_bf16 v[112:127], v[144:147], v[148:151], v[112:127]
  s_waitcnt lgkmcnt(0)
  v_mfma_f32_32x32x16_bf16 v[112:127], v[152:155], v[156:159], v[112:127]
  ds_read_b64 v[8:9], v84
  s_barrier
  ds_read_b128 v[128:131], v85
  ds_read_b128 v[132:135], v86
  ds_read_b128 v[136:139], v87
  ds_read_b128 v[140:143], v88
  s_waitcnt lgkmcnt(0)
  v_mul_f32 v8, 0x3ea52b5c, v8
  v_mul_f32 v9, 0x3ea52b5c, v9
  v_mul_f32 v128, v9, v128
  v_mul_f32 v129, v9, v129
  v_mul_f32 v130, v9, v130
  v_mul_f32 v131, v9, v131
  v_mul_f32 v132, v9, v132
  v_mul_f32 v133, v9, v133
  v_mul_f32 v134, v9, v134
  v_mul_f32 v135, v9, v135
  v_mul_f32 v136, v9, v136
  v_mul_f32 v137, v9, v137
  v_mul_f32 v138, v9, v138
  v_mul_f32 v139, v9, v139
  v_mul_f32 v140, v9, v140
  v_mul_f32 v141, v9, v141
  v_mul_f32 v142, v9, v142
  v_mul_f32 v143, v9, v143
  v_fma_f32 v112, v8, v112, -v128
  v_fma_f32 v113, v8, v113, -v129
  v_fma_f32 v114, v8, v114, -v130
  v_fma_f32 v115, v8, v115, -v131
  v_fma_f32 v116, v8, v116, -v132
  v_fma_f32 v117, v8, v117, -v133
  v_fma_f32 v118, v8, v118, -v134
  v_fma_f32 v119, v8, v119, -v135
  v_fma_f32 v120, v8, v120, -v136
  v_fma_f32 v121, v8, v121, -v137
  v_fma_f32 v122, v8, v122, -v138
  v_fma_f32 v123, v8, v123, -v139
  v_fma_f32 v124, v8, v124, -v140
  v_fma_f32 v125, v8, v125, -v141
  v_fma_f32 v126, v8, v126, -v142
  v_fma_f32 v127, v8, v127, -v143
  v_cvt_pk_bf16_f32 v112, v112, v113
  v_cvt_pk_bf16_f32 v113, v114, v115
  v_cvt_pk_bf16_f32 v114, v116, v117
  v_cvt_pk_bf16_f32 v115, v118, v119
  v_cvt_pk_bf16_f32 v116, v120, v121
  v_cvt_pk_bf16_f32 v117, v122, v123
  v_cvt_pk_bf16_f32 v118, v124, v125
  v_cvt_pk_bf16_f32 v119, v126, v127
  v_and_b32 v112, v112, v93
  v_and_b32 v113, v113, v93
  v_and_b32 v114, v114, v94
  v_and_b32 v115, v115, v94
  v_and_b32 v116, v116, v95
  v_and_b32 v117, v117, v95
  v_and_b32 v118, v118, v96
  v_and_b32 v119, v119, v96
  ds_write_b64 v89, v[112:113]
  ds_write_b64 v90, v[114:115]
  ds_write_b64 v91, v[116:117]
  ds_write_b64 v92, v[118:119]
  s_waitcnt lgkmcnt(0)
  s_barrier
  s_mov_b32 s20, 0
  s_branch PC_33
PL_31:
  global_load_dwordx4 v[64:67], v60, s[60:61] sc1
PC_33:
  s_waitcnt vmcnt(0)
  v_cmp_ne_u32 vcc, s7, v67
  s_nop 4
  s_cbranch_vccz PD_32
  s_sleep 4
  s_add_u32 s20, s20, 1
  s_cmp_lt_u32 s20, s9
  s_cbranch_scc1 PL_31
  s_mov_b32 s9, 0
PD_32:
  global_load_dwordx2 v[240:241], v248, s[60:61] sc1
  v_max_u32_dpp v61, v64, v64 row_ror:1 row_mask:0xf bank_mask:0xf
  s_nop 1
  v_max_u32_dpp v61, v61, v61 row_ror:2 row_mask:0xf bank_mask:0xf
  s_nop 1
  v_max_u32_dpp v61, v61, v61 row_ror:4 row_mask:0xf bank_mask:0xf
  s_nop 1
  v_max_u32_dpp v61, v61, v61 row_ror:8 row_mask:0xf bank_mask:0xf
  s_nop 0
  v_readlane_b32 s28, v61, 0
  v_readlane_b32 s24, v61, 16
  v_readlane_b32 s25, v61, 32
  v_readlane_b32 s26, v61, 48
  s_max_u32 s28, s28, s24
  s_max_u32 s25, s25, s26
  s_max_u32 s28, s28, s25
  v_cmp_eq_u32 vcc, s28, v64
  s_and_b32 s12, s28, 0x7ff
  s_ff1_i32_b64 s29, vcc
  v_cndmask_b32 v64, v64, 0, vcc
  v_readlane_b32 s96, v65, s29
  v_readlane_b32 s98, v66, s29
  v_max_u32_dpp v61, v64, v64 row_ror:1 row_mask:0xf bank_mask:0xf
  s_nop 1
  v_max_u32_dpp v61, v61, v61 row_ror:2 row_mask:0xf bank_mask:0xf
  s_nop 1
  v_max_u32_dpp v61, v61, v61 row_ror:4 row_mask:0xf bank_mask:0xf
  s_nop 1
  v_max_u32_dpp v61, v61, v61 row_ror:8 row_mask:0xf bank_mask:0xf
  s_nop 0
  v_readlane_b32 s28, v61, 0
  v_readlane_b32 s24, v61, 16
  v_readlane_b32 s25, v61, 32
  v_readlane_b32 s26, v61, 48
  s_max_u32 s28, s28, s24
  s_max_u32 s25, s25, s26
  s_max_u32 s28, s28, s25
  v_cmp_eq_u32 vcc, s28, v64
  s_and_b32 s13, s28, 0x7ff
  s_ff1_i32_b64 s29, vcc
  v_cndmask_b32 v64, v64, 0, vcc
  v_readlane_b32 s97, v65, s29
  v_readlane_b32 s99, v66, s29
  s_lshr_b32 s20, s12, 6
  s_lshr_b32 s21, s13, 6
  s_cmp_eq_u32 s20, s4
  s_cselect_b32 s15, 1, 0
  s_cmp_eq_u32 s21, s4
  s_cselect_b32 s15, 1, s15
  s_lshl_b32 s22, s4, 2
  s_add_u32 s22, s22, s19
  s_lshr_b32 s20, s12, 4
  s_lshr_b32 s21, s13, 4
  s_cmp_eq_u32 s20, s22
  s_cselect_b32 s14, 1, 0
  s_cmp_eq_u32 s21, s22
  s_cselect_b32 s14, 1, s14
  s_cmp_lt_u32 s75, 40
  s_cselect_b32 s16, 1, s15
  v_lshrrev_b32 v61, 3, v1
  v_lshlrev_b32 v61, 4, v61
  v_bfe_u32 v62, v1, 1, 2
  v_add_u32 v61, v61, v62
  s_and_b32 s20, s6, 3
  s_lshl_b32 s20, s20, 2
  v_add_u32 v61, s20, v61
  s_lshr_b32 s20, s12, 4
  s_lshr_b32 s21, s13, 4
  v_cmp_eq_u32 vcc, s20, v61
  v_cmp_eq_u32 s[24:25], s21, v61
  s_nop 0
  s_or_b64 vcc, vcc, s[24:25]
  v_add_u32 v62, 2, v249
  v_cndmask_b32 v249, v249, v62, vcc
  s_cmp_eq_u32 s10, 0
  s_nop 0
  s_cbranch_scc0 L_try_34
  s_waitcnt vmcnt(0)
  v_cmp_eq_u32 vcc, v249, v240
  v_cmp_eq_u32 s[24:25], v249, v241
  s_nop 0
  s_and_b64 s[24:25], s[24:25], vcc
  s_lshr_b64 s[26:27], s[24:25], 4
  s_and_b64 s[24:25], s[24:25], s[26:27]
  s_lshr_b64 s[26:27], s[24:25], 2
  s_and_b64 s[24:25], s[24:25], s[26:27]
  s_lshr_b64 s[26:27], s[24:25], 1
  s_and_b64 s[24:25], s[24:25], s[26:27]
  s_mov_b64 s[100:101], s[24:25]
  s_and_b64 s[24:25], s[24:25], s[34:35]
  s_cbranch_scc0 L_try_34
  s_ff1_i32_b64 s20, s[24:25]
  s_bitset0_b64 s[34:35], s20
  s_mul_i32 s20, s20, 3584
  s_add_u32 s66, s62, s20
  s_addc_u32 s67, s63, 0
  global_load_dwordx4 v[212:215], v0, s[66:67] sc1
  global_load_dwordx2 v[216:217], v5, s[66:67] sc1
  global_load_dwordx4 v[218:221], v4, s[66:67] offset:1536 sc1
  global_load_dwordx4 v[222:225], v4, s[66:67] offset:2560 sc1
  s_mov_b32 s10, 1
L_try_34:
  s_branch L_q_go
L_kv_b:
  v_and_b32 v6, 15, v1
  v_lshrrev_b32 v7, 4, v1
  s_lshr_b32 s20, s19, 1
  s_mul_i32 s20, s20, 40960
  s_add_u32 s20, s20, 71680
  s_and_b32 s21, s19, 1
  s_lshl_b32 s21, s21, 4
  v_add_u32 v8, s21, v6
  v_lshrrev_b32 v9, 1, v7
  v_lshlrev_b32 v9, 10, v9
  v_and_b32 v10, 1, v7
  v_lshl_add_u32 v9, v10, 9, v9
  v_lshl_add_u32 v9, v8, 4, v9
  v_add_u32 v60, s20, v9
  v_bfe_u32 v9, v1, 2, 2
  v_lshl_add_u32 v9, v7, 3, v9
  v_mul_u32_u24 v9, 40, v9
  v_and_b32 v10, 3, v1
  s_cmp_eq_u32 s6, 6
  s_cselect_b32 s22, 0, 4
  s_cselect_b32 s23, 3, 0
  v_and_b32 v10, s23, v10
  v_add_u32 v10, s22, v10
  v_lshl_add_u32 v64, v10, 3, v9
  v_mov_b32 v116, 0x3f803f80
  v_mov_b32 v117, 0x3f803f80
  v_mov_b32 v118, 0x3f803f80
  v_mov_b32 v119, 0x3f803f80
  s_lshr_b32 s20, s19, 1
  s_lshl_b32 s21, s4, 1
  s_add_u32 s20, s20, s21
  s_mul_i32 s20, s20, 3584
  s_add_u32 s68, s60, s20
  s_addc_u32 s69, s61, 0
  s_add_u32 s68, s68, 262144
  s_addc_u32 s69, s69, 0
  s_lshl_b32 s20, s19, 7
  s_add_u32 s20, s20, 161792
  v_lshrrev_b32 v10, 1, v7
  v_and_b32 v11, 1, v7
  s_bitcmp1_b32 s5, 0
  s_nop 0
  s_cbranch_scc1 L_kvV0_b
  v_lshl_add_u32 v66, v6, 3, s20
  v_lshl_add_u32 v65, v10, 5, v8
  v_lshlrev_b32 v65, 4, v65
  v_lshl_add_u32 v65, v11, 3, v65
  v_lshl_add_u32 v9, v7, 5, v8
  v_lshlrev_b32 v9, 3, v9
  v_add_u32 v9, 1024, v9
  s_cmp_eq_u32 s6, 6
  s_nop 0
  s_cbranch_scc1 L_kvA_b
  v_mov_b32 v65, v9
  s_nop 1
  s_branch L_kvA_b
L_kvV0_b:
  v_lshl_add_u32 v66, v7, 5, s20
  v_and_b32 v65, 3, v6
  v_bfe_u32 v9, v6, 2, 1
  v_lshl_add_u32 v65, v9, 3, v65
  v_bfe_u32 v9, v6, 3, 1
  v_lshl_add_u32 v65, v9, 2, v65
  s_cmp_eq_u32 s6, 6
  s_nop 0
  s_cbranch_scc1 L_kvV1_b
  v_add_u32 v65, 16, v6
  s_nop 1
L_kvV1_b:
  v_lshl_add_u32 v65, v10, 5, v65
  v_lshlrev_b32 v65, 4, v65
  v_lshl_add_u32 v65, v11, 3, v65
  s_and_b32 s20, s19, 1
  s_lshl_b32 s20, s20, 10
  s_add_u32 s20, s20, 1536
  v_add_u32 v65, s20, v65
  s_nop 1
L_kvA_b:
  s_lshl_b32 s20, s3, 7
  s_lshl_b32 s21, s6, 2
  s_add_u32 s20, s20, s21
  s_add_u32 s20, s20, 557032
  v_mov_b32 v114, s20
  s_sub_u32 s27, s6, 6
  v_mfma_f32_16x16x16_bf16 v[16:19], v[20:21], v[116:117], 0
  v_mfma_f32_16x16x16_bf16 v[16:19], v[22:23], v[116:117], v[16:19]
  v_mfma_f32_16x16x16_bf16 v[16:19], v[24:25], v[116:117], v[16:19]
  v_mfma_f32_16x16x16_bf16 v[16:19], v[26:27], v[116:117], v[16:19]
  v_mfma_f32_16x16x16_bf16 v[16:19], v[28:29], v[116:117], v[16:19]
  v_mfma_f32_16x16x16_bf16 v[16:19], v[30:31], v[116:117], v[16:19]
  v_mfma_f32_16x16x16_bf16 v[16:19], v[32:33], v[116:117], v[16:19]
  v_mfma_f32_16x16x16_bf16 v[16:19], v[34:35], v[116:117], v[16:19]
  v_mfma_f32_16x16x16_bf16 v[16:19], v[36:37], v[116:117], v[16:19]
  v_mfma_f32_16x16x16_bf16 v[16:19], v[38:39], v[116:117], v[16:19]
  v_mfma_f32_16x16x16_bf16 v[16:19], v[40:41], v[116:117], v[16:19]
  v_mfma_f32_16x16x16_bf16 v[16:19], v[42:43], v[116:117], v[16:19]
  v_mfma_f32_16x16x16_bf16 v[16:19], v[44:45], v[116:117], v[16:19]
  v_mfma_f32_16x16x16_bf16 v[16:19], v[46:47], v[116:117], v[16:19]
  v_mfma_f32_16x16x16_bf16 v[16:19], v[48:49], v[116:117], v[16:19]
  v_mfma_f32_16x16x16_bf16 v[16:19], v[50:51], v[116:117], v[16:19]
  v_mfma_f32_16x16x16_bf16 v[16:19], v[52:53], v[116:117], v[16:19]
  v_mfma_f32_16x16x16_bf16 v[16:19], v[54:55], v[116:117], v[16:19]
  v_mfma_f32_16x16x16_bf16 v[16:19], v[56:57], v[116:117], v[16:19]
  v_mfma_f32_16x16x16_bf16 v[16:19], v[58:59], v[116:117], v[16:19]
  s_waitcnt vmcnt(5)
  s_barrier
  s_bitcmp1_b32 s5, 0
  s_nop 4
  s_cbranch_scc1 L_kvV_b
  ds_read_b128 v[76:79], v60 offset:0
  ds_read_b64_tr_b16 v[72:73], v64 offset:0
  ds_read_b64_tr_b16 v[74:75], v64 offset:160
  ds_read_b128 v[84:87], v60 offset:2048
  ds_read_b64_tr_b16 v[80:81], v64 offset:1280
  ds_read_b64_tr_b16 v[82:83], v64 offset:1440
  ds_read_b128 v[92:95], v60 offset:4096
  ds_read_b64_tr_b16 v[88:89], v64 offset:2560
  ds_read_b64_tr_b16 v[90:91], v64 offset:2720
  ds_read_b128 v[100:103], v60 offset:6144
  ds_read_b64_tr_b16 v[96:97], v64 offset:3840
  ds_read_b64_tr_b16 v[98:99], v64 offset:4000
  ds_read_b128 v[108:111], v60 offset:8192
  ds_read_b64_tr_b16 v[104:105], v64 offset:5120
  ds_read_b64_tr_b16 v[106:107], v64 offset:5280
  s_waitcnt lgkmcnt(12)
  v_mfma_f32_16x16x32_bf16 v[68:71], v[72:75], v[76:79], 0
  ds_read_b128 v[76:79], v60 offset:10240
  ds_read_b64_tr_b16 v[72:73], v64 offset:6400
  ds_read_b64_tr_b16 v[74:75], v64 offset:6560
  s_waitcnt lgkmcnt(12)
  v_mfma_f32_16x16x32_bf16 v[120:123], v[80:83], v[84:87], 0
  ds_read_b128 v[84:87], v60 offset:12288
  ds_read_b64_tr_b16 v[80:81], v64 offset:7680
  ds_read_b64_tr_b16 v[82:83], v64 offset:7840
  s_waitcnt lgkmcnt(12)
  v_mfma_f32_16x16x32_bf16 v[68:71], v[88:91], v[92:95], v[68:71]
  ds_read_b128 v[92:95], v60 offset:14336
  ds_read_b64_tr_b16 v[88:89], v64 offset:8960
  ds_read_b64_tr_b16 v[90:91], v64 offset:9120
  s_waitcnt lgkmcnt(12)
  v_mfma_f32_16x16x32_bf16 v[120:123], v[96:99], v[100:103], v[120:123]
  ds_read_b128 v[100:103], v60 offset:16384
  ds_read_b64_tr_b16 v[96:97], v64 offset:10240
  ds_read_b64_tr_b16 v[98:99], v64 offset:10400
  s_waitcnt lgkmcnt(12)
  v_mfma_f32_16x16x32_bf16 v[68:71], v[104:107], v[108:111], v[68:71]
  ds_read_b128 v[108:111], v60 offset:18432
  ds_read_b64_tr_b16 v[104:105], v64 offset:11520
  ds_read_b64_tr_b16 v[106:107], v64 offset:11680
  s_waitcnt lgkmcnt(12)
  v_mfma_f32_16x16x32_bf16 v[120:123], v[72:75], v[76:79], v[120:123]
  ds_read_b128 v[76:79], v60 offset:20480
  ds_read_b64_tr_b16 v[72:73], v64 offset:12800
  ds_read_b64_tr_b16 v[74:75], v64 offset:12960
  s_waitcnt lgkmcnt(12)
  v_mfma_f32_16x16x32_bf16 v[68:71], v[80:83], v[84:87], v[68:71]
  ds_read_b128 v[84:87], v60 offset:22528
  ds_read_b64_tr_b16 v[80:81], v64 offset:14080
  ds_read_b64_tr_b16 v[82:83], v64 offset:14240
  s_waitcnt lgkmcnt(12)
  v_mfma_f32_16x16x32_bf16 v[120:123], v[88:91], v[92:95], v[120:123]
  ds_read_b128 v[92:95], v60 offset:24576
  ds_read_b64_tr_b16 v[88:89], v64 offset:15360
  ds_read_b64_tr_b16 v[90:91], v64 offset:15520
  s_waitcnt lgkmcnt(12)
  v_mfma_f32_16x16x32_bf16 v[68:71], v[96:99], v[100:103], v[68:71]
  ds_read_b128 v[100:103], v60 offset:26624
  ds_read_b64_tr_b16 v[96:97], v64 offset:16640
  ds_read_b64_tr_b16 v[98:99], v64 offset:16800
  s_waitcnt lgkmcnt(12)
  v_mfma_f32_16x16x32_bf16 v[120:123], v[104:107], v[108:111], v[120:123]
  ds_read_b128 v[108:111], v60 offset:28672
  ds_read_b64_tr_b16 v[104:105], v64 offset:17920
  ds_read_b64_tr_b16 v[106:107], v64 offset:18080
  s_waitcnt lgkmcnt(12)
  v_mfma_f32_16x16x32_bf16 v[68:71], v[72:75], v[76:79], v[68:71]
  ds_read_b128 v[76:79], v60 offset:30720
  ds_read_b64_tr_b16 v[72:73], v64 offset:19200
  ds_read_b64_tr_b16 v[74:75], v64 offset:19360
  s_waitcnt lgkmcnt(12)
  v_mfma_f32_16x16x32_bf16 v[120:123], v[80:83], v[84:87], v[120:123]
  ds_read_b128 v[84:87], v60 offset:32768
  ds_read_b64_tr_b16 v[80:81], v64 offset:20480
  ds_read_b64_tr_b16 v[82:83], v64 offset:20640
  s_waitcnt lgkmcnt(12)
  v_mfma_f32_16x16x32_bf16 v[68:71], v[88:91], v[92:95], v[68:71]
  ds_read_b128 v[92:95], v60 offset:34816
  ds_read_b64_tr_b16 v[88:89], v64 offset:21760
  ds_read_b64_tr_b16 v[90:91], v64 offset:21920
  s_waitcnt lgkmcnt(12)
  v_mfma_f32_16x16x32_bf16 v[120:123], v[96:99], v[100:103], v[120:123]
  ds_read_b128 v[100:103], v60 offset:36864
  ds_read_b64_tr_b16 v[96:97], v64 offset:23040
  ds_read_b64_tr_b16 v[98:99], v64 offset:23200
  s_waitcnt lgkmcnt(12)
  v_mfma_f32_16x16x32_bf16 v[68:71], v[104:107], v[108:111], v[68:71]
  ds_read_b128 v[108:111], v60 offset:38912
  ds_read_b64_tr_b16 v[104:105], v64 offset:24320
  ds_read_b64_tr_b16 v[106:107], v64 offset:24480
  s_waitcnt lgkmcnt(12)
  v_mfma_f32_16x16x32_bf16 v[120:123], v[72:75], v[76:79], v[120:123]
  s_waitcnt lgkmcnt(9)
  v_mfma_f32_16x16x32_bf16 v[68:71], v[80:83], v[84:87], v[68:71]
  s_waitcnt lgkmcnt(6)
  v_mfma_f32_16x16x32_bf16 v[120:123], v[88:91], v[92:95], v[120:123]
  s_waitcnt lgkmcnt(3)
  v_mfma_f32_16x16x32_bf16 v[68:71], v[96:99], v[100:103], v[68:71]
  s_waitcnt lgkmcnt(0)
  v_mfma_f32_16x16x32_bf16 v[120:123], v[104:107], v[108:111], v[120:123]
  s_waitcnt vmcnt(0)
  s_barrier
  ds_read_b64 v[72:73], v66
  s_nop 4
  v_add_f32 v68, v68, v120
  v_add_f32 v69, v69, v121
  v_add_f32 v70, v70, v122
  v_add_f32 v71, v71, v123
  v_cmp_gt_u32 vcc, 16, v1
  s_waitcnt lgkmcnt(0)
  v_mul_f32 v74, v73, v12
  v_mul_f32 v75, v73, v13
  v_mul_f32 v76, v73, v14
  v_mul_f32 v77, v73, v15
  v_fma_f32 v68, v72, v68, -v74
  v_fma_f32 v69, v72, v69, -v75
  v_fma_f32 v70, v72, v70, -v76
  v_fma_f32 v71, v72, v71, -v77
  v_cvt_pk_bf16_f32 v72, v68, v69
  v_cvt_pk_bf16_f32 v73, v70, v71
  s_cmp_eq_u32 s6, 6
  s_nop 0
  s_cbranch_scc1 L_kvst_b
  v_cndmask_b32 v72, v116, v72, vcc
  v_cndmask_b32 v73, 0, v73, vcc
  s_mov_b64 exec, 0xffffffff
  s_nop 0
  s_branch L_kvst_b
L_kvV_b:
  ds_read_b128 v[76:79], v60 offset:0
  ds_read_b64_tr_b16 v[72:73], v64 offset:0
  ds_read_b64_tr_b16 v[74:75], v64 offset:160
  ds_read_b128 v[84:87], v60 offset:2048
  ds_read_b64_tr_b16 v[80:81], v64 offset:1280
  ds_read_b64_tr_b16 v[82:83], v64 offset:1440
  ds_read_b128 v[92:95], v60 offset:4096
  ds_read_b64_tr_b16 v[88:89], v64 offset:2560
  ds_read_b64_tr_b16 v[90:91], v64 offset:2720
  ds_read_b128 v[100:103], v60 offset:6144
  ds_read_b64_tr_b16 v[96:97], v64 offset:3840
  ds_read_b64_tr_b16 v[98:99], v64 offset:4000
  ds_read_b128 v[108:111], v60 offset:8192
  ds_read_b64_tr_b16 v[104:105], v64 offset:5120
  ds_read_b64_tr_b16 v[106:107], v64 offset:5280
  s_waitcnt lgkmcnt(12)
  v_mfma_f32_16x16x32_bf16 v[68:71], v[76:79], v[72:75], 0
  ds_read_b128 v[76:79], v60 offset:10240
  ds_read_b64_tr_b16 v[72:73], v64 offset:6400
  ds_read_b64_tr_b16 v[74:75], v64 offset:6560
  s_waitcnt lgkmcnt(12)
  v_mfma_f32_16x16x32_bf16 v[120:123], v[84:87], v[80:83], 0
  ds_read_b128 v[84:87], v60 offset:12288
  ds_read_b64_tr_b16 v[80:81], v64 offset:7680
  ds_read_b64_tr_b16 v[82:83], v64 offset:7840
  s_waitcnt lgkmcnt(12)
  v_mfma_f32_16x16x32_bf16 v[68:71], v[92:95], v[88:91], v[68:71]
  ds_read_b128 v[92:95], v60 offset:14336
  ds_read_b64_tr_b16 v[88:89], v64 offset:8960
  ds_read_b64_tr_b16 v[90:91], v64 offset:9120
  s_waitcnt lgkmcnt(12)
  v_mfma_f32_16x16x32_bf16 v[120:123], v[100:103], v[96:99], v[120:123]
  ds_read_b128 v[100:103], v60 offset:16384
  ds_read_b64_tr_b16 v[96:97], v64 offset:10240
  ds_read_b64_tr_b16 v[98:99], v64 offset:10400
  s_waitcnt lgkmcnt(12)
  v_mfma_f32_16x16x32_bf16 v[68:71], v[108:111], v[104:107], v[68:71]
  ds_read_b128 v[108:111], v60 offset:18432
  ds_read_b64_tr_b16 v[104:105], v64 offset:11520
  ds_read_b64_tr_b16 v[106:107], v64 offset:11680
  s_waitcnt lgkmcnt(12)
  v_mfma_f32_16x16x32_bf16 v[120:123], v[76:79], v[72:75], v[120:123]
  ds_read_b128 v[76:79], v60 offset:20480
  ds_read_b64_tr_b16 v[72:73], v64 offset:12800
  ds_read_b64_tr_b16 v[74:75], v64 offset:12960
  s_waitcnt lgkmcnt(12)
  v_mfma_f32_16x16x32_bf16 v[68:71], v[84:87], v[80:83], v[68:71]
  ds_read_b128 v[84:87], v60 offset:22528
  ds_read_b64_tr_b16 v[80:81], v64 offset:14080
  ds_read_b64_tr_b16 v[82:83], v64 offset:14240
  s_waitcnt lgkmcnt(12)
  v_mfma_f32_16x16x32_bf16 v[120:123], v[92:95], v[88:91], v[120:123]
  ds_read_b128 v[92:95], v60 offset:24576
  ds_read_b64_tr_b16 v[88:89], v64 offset:15360
  ds_read_b64_tr_b16 v[90:91], v64 offset:15520
  s_waitcnt lgkmcnt(12)
  v_mfma_f32_16x16x32_bf16 v[68:71], v[100:103], v[96:99], v[68:71]
  ds_read_b128 v[100:103], v60 offset:26624
  ds_read_b64_tr_b16 v[96:97], v64 offset:16640
  ds_read_b64_tr_b16 v[98:99], v64 offset:16800
  s_waitcnt lgkmcnt(12)
  v_mfma_f32_16x16x32_bf16 v[120:123], v[108:111], v[104:107], v[120:123]
  ds_read_b128 v[108:111], v60 offset:28672
  ds_read_b64_tr_b16 v[104:105], v64 offset:17920
  ds_read_b64_tr_b16 v[106:107], v64 offset:18080
  s_waitcnt lgkmcnt(12)
  v_mfma_f32_16x16x32_bf16 v[68:71], v[76:79], v[72:75], v[68:71]
  ds_read_b128 v[76:79], v60 offset:30720
  ds_read_b64_tr_b16 v[72:73], v64 offset:19200
  ds_read_b64_tr_b16 v[74:75], v64 offset:19360
  s_waitcnt lgkmcnt(12)
  v_mfma_f32_16x16x32_bf16 v[120:123], v[84:87], v[80:83], v[120:123]
  ds_read_b128 v[84:87], v60 offset:32768
  ds_read_b64_tr_b16 v[80:81], v64 offset:20480
  ds_read_b64_tr_b16 v[82:83], v64 offset:20640
  s_waitcnt lgkmcnt(12)
  v_mfma_f32_16x16x32_bf16 v[68:71], v[92:95], v[88:91], v[68:71]
  ds_read_b128 v[92:95], v60 offset:34816
  ds_read_b64_tr_b16 v[88:89], v64 offset:21760
  ds_read_b64_tr_b16 v[90:91], v64 offset:21920
  s_waitcnt lgkmcnt(12)
  v_mfma_f32_16x16x32_bf16 v[120:123], v[100:103], v[96:99], v[120:123]
  ds_read_b128 v[100:103], v60 offset:36864
  ds_read_b64_tr_b16 v[96:97], v64 offset:23040
  ds_read_b64_tr_b16 v[98:99], v64 offset:23200
  s_waitcnt lgkmcnt(12)
  v_mfma_f32_16x16x32_bf16 v[68:71], v[108:111], v[104:107], v[68:71]
  ds_read_b128 v[108:111], v60 offset:38912
  ds_read_b64_tr_b16 v[104:105], v64 offset:24320
  ds_read_b64_tr_b16 v[106:107], v64 offset:24480
  s_waitcnt lgkmcnt(12)
  v_mfma_f32_16x16x32_bf16 v[120:123], v[76:79], v[72:75], v[120:123]
  s_waitcnt lgkmcnt(9)
  v_mfma_f32_16x16x32_bf16 v[68:71], v[84:87], v[80:83], v[68:71]
  s_waitcnt lgkmcnt(6)
  v_mfma_f32_16x16x32_bf16 v[120:123], v[92:95], v[88:91], v[120:123]
  s_waitcnt lgkmcnt(3)
  v_mfma_f32_16x16x32_bf16 v[68:71], v[100:103], v[96:99], v[68:71]
  s_waitcnt lgkmcnt(0)
  v_mfma_f32_16x16x32_bf16 v[120:123], v[108:111], v[104:107], v[120:123]
  s_waitcnt vmcnt(0)
  s_barrier
  ds_read_b128 v[72:75], v66
  ds_read_b128 v[76:79], v66 offset:16
  s_nop 3
  v_add_f32 v68, v68, v120
  v_add_f32 v69, v69, v121
  v_add_f32 v70, v70, v122
  v_add_f32 v71, v71, v123
  v_cmp_eq_u32 vcc, 4, v6
  s_nop 1
  v_cndmask_b32 v80, 0, v116, vcc
  v_cmp_gt_u32 vcc, 4, v6
  s_waitcnt lgkmcnt(0)
  v_mul_f32 v73, v73, v12
  v_mul_f32 v75, v75, v12
  v_mul_f32 v77, v77, v12
  v_mul_f32 v79, v79, v12
  v_fma_f32 v68, v72, v68, -v73
  v_fma_f32 v69, v74, v69, -v75
  v_fma_f32 v70, v76, v70, -v77
  v_fma_f32 v71, v78, v71, -v79
  v_cvt_pk_bf16_f32 v72, v68, v69
  v_cvt_pk_bf16_f32 v73, v70, v71
  s_cmp_eq_u32 s6, 6
  s_nop 0
  s_cbranch_scc1 L_kvst_b
  v_cndmask_b32 v72, v80, v72, vcc
  v_cndmask_b32 v73, v80, v73, vcc
  s_nop 1
L_kvst_b:
  global_store_dwordx2 v65, v[72:73], s[68:69] sc1
  s_mov_b64 exec, -1
  s_and_b32 s22, s6, 3
  s_mul_i32 s20, s22, 7168
  s_add_u32 s62, s60, s20
  s_addc_u32 s63, s61, 0
  s_add_u32 s62, s62, 262144
  s_addc_u32 s63, s63, 0
  s_lshl_b32 s20, s22, 10
  s_add_u32 s20, s20, 557056
  v_lshrrev_b32 v248, 3, v1
  v_lshlrev_b32 v248, 12, v248
  v_and_b32 v249, 7, v1
  v_lshl_add_u32 v248, v249, 7, v248
  v_add_u32 v248, s20, v248
  s_mov_b32 s34, 0x01010101
  s_mov_b32 s35, 0x01010101
  v_mov_b32 v249, s7
  s_mov_b32 s10, 0
  s_mov_b64 s[100:101], 0
  s_barrier
  s_waitcnt vmcnt(0)
  v_mov_b32 v11, s7
  s_mov_b64 exec, 1
  global_store_dword v114, v11, s[60:61] sc1
  s_mov_b64 exec, -1
  s_barrier
  s_mul_i32 s21, s8, 4096
  s_add_u32 s21, s21, 655360
  v_lshrrev_b32 v60, 1, v1
  v_lshlrev_b32 v60, 7, v60
  v_and_b32 v61, 1, v1
  v_lshl_add_u32 v60, v61, 4, v60
  v_add_u32 v60, s21, v60
  global_load_dwordx4 v[64:67], v60, s[60:61] sc1
  s_barrier
  s_cmp_lt_u32 s75, 40
  s_cbranch_scc1 L_kv_fd
  s_setprio 3
  s_mov_b32 s20, 0
  s_branch PC_37
PL_35:
  global_load_dwordx4 v[64:67], v60, s[60:61] sc1
PC_37:
  s_waitcnt vmcnt(0)
  v_cmp_ne_u32 vcc, s7, v67
  s_nop 4
  s_cbranch_vccz PD_36
  s_sleep 4
  s_add_u32 s20, s20, 1
  s_cmp_lt_u32 s20, s9
  s_cbranch_scc1 PL_35
  s_mov_b32 s9, 0
PD_36:
  global_load_dwordx2 v[240:241], v248, s[60:61] sc1
  v_max_u32_dpp v61, v64, v64 row_ror:1 row_mask:0xf bank_mask:0xf
  s_nop 1
  v_max_u32_dpp v61, v61, v61 row_ror:2 row_mask:0xf bank_mask:0xf
  s_nop 1
  v_max_u32_dpp v61, v61, v61 row_ror:4 row_mask:0xf bank_mask:0xf
  s_nop 1
  v_max_u32_dpp v61, v61, v61 row_ror:8 row_mask:0xf bank_mask:0xf
  s_nop 0
  v_readlane_b32 s28, v61, 0
  v_readlane_b32 s24, v61, 16
  v_readlane_b32 s25, v61, 32
  v_readlane_b32 s26, v61, 48
  s_max_u32 s28, s28, s24
  s_max_u32 s25, s25, s26
  s_max_u32 s28, s28, s25
  v_cmp_eq_u32 vcc, s28, v64
  s_and_b32 s12, s28, 0x7ff
  s_ff1_i32_b64 s29, vcc
  v_cndmask_b32 v64, v64, 0, vcc
  v_readlane_b32 s96, v65, s29
  v_readlane_b32 s98, v66, s29
  v_max_u32_dpp v61, v64, v64 row_ror:1 row_mask:0xf bank_mask:0xf
  s_nop 1
  v_max_u32_dpp v61, v61, v61 row_ror:2 row_mask:0xf bank_mask:0xf
  s_nop 1
  v_max_u32_dpp v61, v61, v61 row_ror:4 row_mask:0xf bank_mask:0xf
  s_nop 1
  v_max_u32_dpp v61, v61, v61 row_ror:8 row_mask:0xf bank_mask:0xf
  s_nop 0
  v_readlane_b32 s28, v61, 0
  v_readlane_b32 s24, v61, 16
  v_readlane_b32 s25, v61, 32
  v_readlane_b32 s26, v61, 48
  s_max_u32 s28, s28, s24
  s_max_u32 s25, s25, s26
  s_max_u32 s28, s28, s25
  v_cmp_eq_u32 vcc, s28, v64
  s_and_b32 s13, s28, 0x7ff
  s_ff1_i32_b64 s29, vcc
  v_cndmask_b32 v64, v64, 0, vcc
  v_readlane_b32 s97, v65, s29
  v_readlane_b32 s99, v66, s29
  v_mov_b32 v64, s12
  v_mov_b32 v65, s13
  v_mov_b32 v66, s96
  v_mov_b32 v67, s97
  v_mov_b32 v68, s98
  v_mov_b32 v69, s99
  v_and_b32 v6, 15, v1
  v_lshrrev_b32 v7, 4, v1
  v_cmp_eq_u32 vcc, 1, v6
  s_nop 1
  v_cndmask_b32 v60, v64, v65, vcc
  v_cndmask_b32 v70, v68, v69, vcc
  v_bfe_u32 v62, v60, 5, 1
  v_mul_u32_u24 v62, 40960, v62
  v_and_b32 v61, 31, v60
  v_lshl_add_u32 v61, v61, 4, v62
  v_lshrrev_b32 v62, 6, v60
  v_mul_u32_u24 v62, 0x54400, v62
  v_add_u32 v61, v61, v62
  v_lshrrev_b32 v62, 1, v7
  v_lshl_add_u32 v61, v62, 9, v61
  v_and_b32 v62, 1, v7
  v_lshl_add_u32 v61, v62, 3, v61
  s_sub_u32 s20, s6, 6
  s_mul_i32 s20, s20, 20480
  s_add_u32 s64, s72, s20
  s_addc_u32 s65, s73, 0
  global_load_dwordx2 v[140:141], v61, s[64:65] offset:0 sc1
  global_load_dwordx2 v[142:143], v61, s[64:65] offset:1024 sc1
  global_load_dwordx2 v[144:145], v61, s[64:65] offset:2048 sc1
  global_load_dwordx2 v[146:147], v61, s[64:65] offset:3072 sc1
  s_add_u32 s64, s64, 4096
  s_addc_u32 s65, s65, 0
  global_load_dwordx2 v[148:149], v61, s[64:65] offset:0 sc1
  global_load_dwordx2 v[150:151], v61, s[64:65] offset:1024 sc1
  global_load_dwordx2 v[152:153], v61, s[64:65] offset:2048 sc1
  global_load_dwordx2 v[154:155], v61, s[64:65] offset:3072 sc1
  s_add_u32 s64, s64, 4096
  s_addc_u32 s65, s65, 0
  global_load_dwordx2 v[156:157], v61, s[64:65] offset:0 sc1
  global_load_dwordx2 v[158:159], v61, s[64:65] offset:1024 sc1
  global_load_dwordx2 v[160:161], v61, s[64:65] offset:2048 sc1
  global_load_dwordx2 v[162:163], v61, s[64:65] offset:3072 sc1
  s_add_u32 s64, s64, 4096
  s_addc_u32 s65, s65, 0
  global_load_dwordx2 v[164:165], v61, s[64:65] offset:0 sc1
  global_load_dwordx2 v[166:167], v61, s[64:65] offset:1024 sc1
  global_load_dwordx2 v[168:169], v61, s[64:65] offset:2048 sc1
  global_load_dwordx2 v[170:171], v61, s[64:65] offset:3072 sc1
  s_add_u32 s64, s64, 4096
  s_addc_u32 s65, s65, 0
  global_load_dwordx2 v[172:173], v61, s[64:65] offset:0 sc1
  global_load_dwordx2 v[174:175], v61, s[64:65] offset:1024 sc1
  global_load_dwordx2 v[176:177], v61, s[64:65] offset:2048 sc1
  global_load_dwordx2 v[178:179], v61, s[64:65] offset:3072 sc1
  v_and_b32 v71, 0xffff0000, v70
  v_lshlrev_b32 v70, 16, v70
  s_lshr_b32 s20, s12, 6
  s_lshr_b32 s21, s13, 6
  s_cmp_eq_u32 s20, s4
  s_cselect_b32 s15, 1, 0
  s_cmp_eq_u32 s21, s4
  s_cselect_b32 s15, 1, s15
  s_lshl_b32 s22, s4, 2
  s_add_u32 s22, s22, s19
  s_lshr_b32 s20, s12, 4
  s_lshr_b32 s21, s13, 4
  s_cmp_eq_u32 s20, s22
  s_cselect_b32 s14, 1, 0
  s_cmp_eq_u32 s21, s22
  s_cselect_b32 s14, 1, s14
  s_cmp_lt_u32 s75, 40
  s_cselect_b32 s16, 1, s15
  v_lshrrev_b32 v61, 3, v1
  v_lshlrev_b32 v61, 4, v61
  v_bfe_u32 v62, v1, 1, 2
  v_add_u32 v61, v61, v62
  s_and_b32 s20, s6, 3
  s_lshl_b32 s20, s20, 2
  v_add_u32 v61, s20, v61
  s_lshr_b32 s20, s12, 4
  s_lshr_b32 s21, s13, 4
  v_cmp_eq_u32 vcc, s20, v61
  v_cmp_eq_u32 s[24:25], s21, v61
  s_nop 0
  s_or_b64 vcc, vcc, s[24:25]
  v_add_u32 v62, 2, v249
  v_cndmask_b32 v249, v249, v62, vcc
  s_cmp_eq_u32 s10, 0
  s_nop 0
  s_cbranch_scc0 L_try_38
  s_waitcnt vmcnt(20)
  v_cmp_eq_u32 vcc, v249, v240
  v_cmp_eq_u32 s[24:25], v249, v241
  s_nop 0
  s_and_b64 s[24:25], s[24:25], vcc
  s_lshr_b64 s[26:27], s[24:25], 4
  s_and_b64 s[24:25], s[24:25], s[26:27]
  s_lshr_b64 s[26:27], s[24:25], 2
  s_and_b64 s[24:25], s[24:25], s[26:27]
  s_lshr_b64 s[26:27], s[24:25], 1
  s_and_b64 s[24:25], s[24:25], s[26:27]
  s_mov_b64 s[100:101], s[24:25]
  s_and_b64 s[24:25], s[24:25], s[34:35]
  s_cbranch_scc0 L_try_38
  s_ff1_i32_b64 s20, s[24:25]
  s_bitset0_b64 s[34:35], s20
  s_mul_i32 s20, s20, 3584
  s_add_u32 s66, s62, s20
  s_addc_u32 s67, s63, 0
  global_load_dwordx4 v[212:215], v0, s[66:67] sc1
  global_load_dwordx2 v[216:217], v5, s[66:67] sc1
  global_load_dwordx4 v[218:221], v4, s[66:67] offset:1536 sc1
  global_load_dwordx4 v[222:225], v4, s[66:67] offset:2560 sc1
  s_mov_b32 s10, 1
L_try_38:
  s_waitcnt vmcnt(19)
  v_mfma_f32_16x16x16_bf16 v[72:75], v[20:21], v[140:141], 0
  s_waitcnt vmcnt(18)
  v_mfma_f32_16x16x16_bf16 v[76:79], v[22:23], v[142:143], 0
  s_waitcnt vmcnt(17)
  v_mfma_f32_16x16x16_bf16 v[72:75], v[24:25], v[144:145], v[72:75]
  s_waitcnt vmcnt(16)
  v_mfma_f32_16x16x16_bf16 v[76:79], v[26:27], v[146:147], v[76:79]
  s_waitcnt vmcnt(15)
  v_mfma_f32_16x16x16_bf16 v[72:75], v[28:29], v[148:149], v[72:75]
  s_waitcnt vmcnt(14)
  v_mfma_f32_16x16x16_bf16 v[76:79], v[30:31], v[150:151], v[76:79]
  s_waitcnt vmcnt(13)
  v_mfma_f32_16x16x16_bf16 v[72:75], v[32:33], v[152:153], v[72:75]
  s_waitcnt vmcnt(12)
  v_mfma_f32_16x16x16_bf16 v[76:79], v[34:35], v[154:155], v[76:79]
  s_waitcnt vmcnt(11)
  v_mfma_f32_16x16x16_bf16 v[72:75], v[36:37], v[156:157], v[72:75]
  s_waitcnt vmcnt(10)
  v_mfma_f32_16x16x16_bf16 v[76:79], v[38:39], v[158:159], v[76:79]
  s_waitcnt vmcnt(9)
  v_mfma_f32_16x16x16_bf16 v[72:75], v[40:41], v[160:161], v[72:75]
  s_waitcnt vmcnt(8)
  v_mfma_f32_16x16x16_bf16 v[76:79], v[42:43], v[162:163], v[76:79]
  s_waitcnt vmcnt(7)
  v_mfma_f32_16x16x16_bf16 v[72:75], v[44:45], v[164:165], v[72:75]
  s_waitcnt vmcnt(6)
  v_mfma_f32_16x16x16_bf16 v[76:79], v[46:47], v[166:167], v[76:79]
  s_waitcnt vmcnt(5)
  v_mfma_f32_16x16x16_bf16 v[72:75], v[48:49], v[168:169], v[72:75]
  s_waitcnt vmcnt(4)
  v_mfma_f32_16x16x16_bf16 v[76:79], v[50:51], v[170:171], v[76:79]
  s_waitcnt vmcnt(3)
  v_mfma_f32_16x16x16_bf16 v[72:75], v[52:53], v[172:173], v[72:75]
  s_waitcnt vmcnt(2)
  v_mfma_f32_16x16x16_bf16 v[76:79], v[54:55], v[174:175], v[76:79]
  s_waitcnt vmcnt(1)
  v_mfma_f32_16x16x16_bf16 v[72:75], v[56:57], v[176:177], v[72:75]
  s_waitcnt vmcnt(0)
  v_mfma_f32_16x16x16_bf16 v[76:79], v[58:59], v[178:179], v[76:79]
  v_add_u32 v62, 160768, v0
  s_nop 6
  v_add_f32 v72, v72, v76
  v_add_f32 v73, v73, v77
  v_add_f32 v74, v74, v78
  v_add_f32 v75, v75, v79
  v_fma_f32 v72, -v70, v16, v72
  v_fma_f32 v73, -v70, v17, v73
  v_fma_f32 v74, -v70, v18, v74
  v_fma_f32 v75, -v70, v19, v75
  v_mov_b32 v80, 163216
  s_add_u32 s23, s7, s8
  s_cmp_eq_u32 s6, 7
  s_cbranch_scc0 L_gu_w_39
  s_cmp_lt_u32 s75, 40
  s_cbranch_scc1 L_gu_w_39
  ds_write_b128 v62, v[72:75]
  v_mov_b32 v81, s23
  s_waitcnt lgkmcnt(0)
  ds_write_b32 v80, v81
L_gu_w_39:
  s_cmp_eq_u32 s6, 6
  s_cbranch_scc0 L_gu_e_40
  s_cmp_lt_u32 s74, 216
  s_cbranch_scc0 L_gu_e_40
  v_rcp_f32 v71, v71
  s_mov_b32 s22, 0
  s_nop 0
L_gu_s_41:
  ds_read_b32 v81, v80
  s_add_u32 s22, s22, 1
  s_waitcnt lgkmcnt(0)
  v_cmp_ne_u32 vcc, s23, v81
  s_cmp_lt_u32 s22, s9
  s_cselect_b64 s[24:25], -1, 0
  s_and_b64 vcc, vcc, s[24:25]
  s_nop 1
  s_cbranch_vccnz L_gu_s_41
  ds_read_b128 v[76:79], v62
  s_mul_i32 s21, s8, 16384
  s_add_u32 s21, s21, 671744
  s_lshl_b32 s20, s74, 6
  s_add_u32 s20, s20, s21
  v_lshlrev_b32 v62, 5, v6
  v_lshl_add_u32 v62, v7, 4, v62
  v_add_u32 v62, s20, v62
  s_waitcnt lgkmcnt(0)
  v_add_f32 v72, v72, v76
  v_add_f32 v73, v73, v77
  v_add_f32 v74, v74, v78
  v_add_f32 v75, v75, v79
  v_mul_f32 v72, v72, v71
  v_mul_f32 v73, v73, v71
  v_mul_f32 v74, v74, v71
  v_mul_f32 v75, v75, v71
  v_cvt_pk_bf16_f32 v72, v72, v72
  v_cvt_pk_bf16_f32 v73, v73, v73
  v_cvt_pk_bf16_f32 v74, v74, v74
  v_cvt_pk_bf16_f32 v75, v75, v75
  v_lshlrev_b32 v72, 16, v72
  v_lshlrev_b32 v73, 16, v73
  v_lshlrev_b32 v74, 16, v74
  v_lshlrev_b32 v75, 16, v75
  v_mov_b32 v76, v72
  v_mov_b32 v77, v73
  v_mov_b32 v78, v74
  v_mov_b32 v79, v75
  v_mul_f32 v80, 0xbfb8aa3b, v72
  v_mul_f32 v81, 0xbfb8aa3b, v73
  v_mul_f32 v82, 0xbfb8aa3b, v74
  v_mul_f32 v83, 0xbfb8aa3b, v75
  v_exp_f32 v80, v80
  v_exp_f32 v81, v81
  v_exp_f32 v82, v82
  v_exp_f32 v83, v83
  v_permlane32_swap_b32 v72, v76
  v_permlane32_swap_b32 v73, v77
  v_permlane32_swap_b32 v74, v78
  v_permlane32_swap_b32 v75, v79
  v_add_f32 v80, 1.0, v80
  v_add_f32 v81, 1.0, v81
  v_add_f32 v82, 1.0, v82
  v_add_f32 v83, 1.0, v83
  v_rcp_f32 v80, v80
  v_rcp_f32 v81, v81
  v_rcp_f32 v82, v82
  v_rcp_f32 v83, v83
  v_mul_f32 v72, v72, v80
  v_mul_f32 v73, v73, v81
  v_mul_f32 v74, v74, v82
  v_mul_f32 v75, v75, v83
  v_cvt_pk_bf16_f32 v72, v72, v72
  v_cvt_pk_bf16_f32 v73, v73, v73
  v_cvt_pk_bf16_f32 v74, v74, v74
  v_cvt_pk_bf16_f32 v75, v75, v75
  v_lshlrev_b32 v72, 16, v72
  v_lshlrev_b32 v73, 16, v73
  v_lshlrev_b32 v74, 16, v74
  v_lshlrev_b32 v75, 16, v75
  v_mul_f32 v72, v72, v76
  v_mul_f32 v73, v73, v77
  v_mul_f32 v74, v74, v78
  v_mul_f32 v75, v75, v79
  v_cvt_pk_bf16_f32 v72, v72, v73
  v_cvt_pk_bf16_f32 v73, v74, v75
  v_mov_b32 v74, s7
  v_mov_b32 v75, s7
  s_mov_b64 exec, 0x30003
  global_store_dwordx4 v62, v[72:75], s[60:61] sc1
  s_mov_b64 exec, -1
  s_nop 0
L_gu_e_40:
  s_setprio 0
  s_barrier
  s_barrier
  s_branch L_q_go
L_kv_fd:
  s_barrier
  s_barrier
  s_mov_b32 s20, 0
  s_branch PC_44
PL_42:
  global_load_dwordx4 v[64:67], v60, s[60:61] sc1
PC_44:
  s_waitcnt vmcnt(0)
  v_cmp_ne_u32 vcc, s7, v67
  s_nop 4
  s_cbranch_vccz PD_43
  s_sleep 4
  s_add_u32 s20, s20, 1
  s_cmp_lt_u32 s20, s9
  s_cbranch_scc1 PL_42
  s_mov_b32 s9, 0
PD_43:
  global_load_dwordx2 v[240:241], v248, s[60:61] sc1
  v_max_u32_dpp v61, v64, v64 row_ror:1 row_mask:0xf bank_mask:0xf
  s_nop 1
  v_max_u32_dpp v61, v61, v61 row_ror:2 row_mask:0xf bank_mask:0xf
  s_nop 1
  v_max_u32_dpp v61, v61, v61 row_ror:4 row_mask:0xf bank_mask:0xf
  s_nop 1
  v_max_u32_dpp v61, v61, v61 row_ror:8 row_mask:0xf bank_mask:0xf
  s_nop 0
  v_readlane_b32 s28, v61, 0
  v_readlane_b32 s24, v61, 16
  v_readlane_b32 s25, v61, 32
  v_readlane_b32 s26, v61, 48
  s_max_u32 s28, s28, s24
  s_max_u32 s25, s25, s26
  s_max_u32 s28, s28, s25
  v_cmp_eq_u32 vcc, s28, v64
  s_and_b32 s12, s28, 0x7ff
  s_ff1_i32_b64 s29, vcc
  v_cndmask_b32 v64, v64, 0, vcc
  v_readlane_b32 s96, v65, s29
  v_readlane_b32 s98, v66, s29
  v_max_u32_dpp v61, v64, v64 row_ror:1 row_mask:0xf bank_mask:0xf
  s_nop 1
  v_max_u32_dpp v61, v61, v61 row_ror:2 row_mask:0xf bank_mask:0xf
  s_nop 1
  v_max_u32_dpp v61, v61, v61 row_ror:4 row_mask:0xf bank_mask:0xf
  s_nop 1
  v_max_u32_dpp v61, v61, v61 row_ror:8 row_mask:0xf bank_mask:0xf
  s_nop 0
  v_readlane_b32 s28, v61, 0
  v_readlane_b32 s24, v61, 16
  v_readlane_b32 s25, v61, 32
  v_readlane_b32 s26, v61, 48
  s_max_u32 s28, s28, s24
  s_max_u32 s25, s25, s26
  s_max_u32 s28, s28, s25
  v_cmp_eq_u32 vcc, s28, v64
  s_and_b32 s13, s28, 0x7ff
  s_ff1_i32_b64 s29, vcc
  v_cndmask_b32 v64, v64, 0, vcc
  v_readlane_b32 s97, v65, s29
  v_readlane_b32 s99, v66, s29
  s_lshr_b32 s20, s12, 6
  s_lshr_b32 s21, s13, 6
  s_cmp_eq_u32 s20, s4
  s_cselect_b32 s15, 1, 0
  s_cmp_eq_u32 s21, s4
  s_cselect_b32 s15, 1, s15
  s_lshl_b32 s22, s4, 2
  s_add_u32 s22, s22, s19
  s_lshr_b32 s20, s12, 4
  s_lshr_b32 s21, s13, 4
  s_cmp_eq_u32 s20, s22
  s_cselect_b32 s14, 1, 0
  s_cmp_eq_u32 s21, s22
  s_cselect_b32 s14, 1, s14
  s_cmp_lt_u32 s75, 40
  s_cselect_b32 s16, 1, s15
  v_lshrrev_b32 v61, 3, v1
  v_lshlrev_b32 v61, 4, v61
  v_bfe_u32 v62, v1, 1, 2
  v_add_u32 v61, v61, v62
  s_and_b32 s20, s6, 3
  s_lshl_b32 s20, s20, 2
  v_add_u32 v61, s20, v61
  s_lshr_b32 s20, s12, 4
  s_lshr_b32 s21, s13, 4
  v_cmp_eq_u32 vcc, s20, v61
  v_cmp_eq_u32 s[24:25], s21, v61
  s_nop 0
  s_or_b64 vcc, vcc, s[24:25]
  v_add_u32 v62, 2, v249
  v_cndmask_b32 v249, v249, v62, vcc
  s_cmp_eq_u32 s10, 0
  s_nop 0
  s_cbranch_scc0 L_try_45
  s_waitcnt vmcnt(0)
  v_cmp_eq_u32 vcc, v249, v240
  v_cmp_eq_u32 s[24:25], v249, v241
  s_nop 0
  s_and_b64 s[24:25], s[24:25], vcc
  s_lshr_b64 s[26:27], s[24:25], 4
  s_and_b64 s[24:25], s[24:25], s[26:27]
  s_lshr_b64 s[26:27], s[24:25], 2
  s_and_b64 s[24:25], s[24:25], s[26:27]
  s_lshr_b64 s[26:27], s[24:25], 1
  s_and_b64 s[24:25], s[24:25], s[26:27]
  s_mov_b64 s[100:101], s[24:25]
  s_and_b64 s[24:25], s[24:25], s[34:35]
  s_cbranch_scc0 L_try_45
  s_ff1_i32_b64 s20, s[24:25]
  s_bitset0_b64 s[34:35], s20
  s_mul_i32 s20, s20, 3584
  s_add_u32 s66, s62, s20
  s_addc_u32 s67, s63, 0
  global_load_dwordx4 v[212:215], v0, s[66:67] sc1
  global_load_dwordx2 v[216:217], v5, s[66:67] sc1
  global_load_dwordx4 v[218:221], v4, s[66:67] offset:1536 sc1
  global_load_dwordx4 v[222:225], v4, s[66:67] offset:2560 sc1
  s_mov_b32 s10, 1
L_try_45:
  s_setprio 0
  s_cmp_eq_u32 s15, 0
  s_cbranch_scc1 L_q_go
  s_and_b32 s27, s6, 1
  s_mul_i32 s21, s27, 40960
  s_add_u32 s21, s21, 0
  s_add_u32 s64, s38, s21
  s_addc_u32 s65, s39, 0
  s_mul_i32 s76, s27, 5120
  s_add_u32 s76, s76, 71680
  s_mov_b32 m0, s76
  s_nop 0
  global_load_lds_dwordx4 v250, s[64:65] offset:0
  s_mov_b32 m0, s76
  s_nop 0
  global_load_lds_dwordx4 v251, s[64:65] offset:1024
  s_mov_b32 m0, s76
  s_nop 0
  global_load_lds_dwordx4 v252, s[64:65] offset:2048
  s_mov_b32 m0, s76
  s_nop 0
  global_load_lds_dwordx4 v253, s[64:65] offset:3072
  s_add_u32 m0, s76, 4096
  s_nop 0
  global_load_lds_dwordx4 v254, s[64:65]
  s_mul_i32 s21, s27, 40960
  s_add_u32 s21, s21, 81920
  s_add_u32 s64, s38, s21
  s_addc_u32 s65, s39, 0
  s_mul_i32 s76, s27, 5120
  s_add_u32 s76, s76, 81920
  s_mov_b32 m0, s76
  s_nop 0
  global_load_lds_dwordx4 v250, s[64:65] offset:0
  s_mov_b32 m0, s76
  s_nop 0
  global_load_lds_dwordx4 v251, s[64:65] offset:1024
  s_mov_b32 m0, s76
  s_nop 0
  global_load_lds_dwordx4 v252, s[64:65] offset:2048
  s_mov_b32 m0, s76
  s_nop 0
  global_load_lds_dwordx4 v253, s[64:65] offset:3072
  s_add_u32 m0, s76, 4096
  s_nop 0
  global_load_lds_dwordx4 v254, s[64:65]
  s_mul_i32 s21, s27, 40960
  s_add_u32 s21, s21, 163840
  s_add_u32 s64, s38, s21
  s_addc_u32 s65, s39, 0
  s_mul_i32 s76, s27, 5120
  s_add_u32 s76, s76, 92160
  s_mov_b32 m0, s76
  s_nop 0
  global_load_lds_dwordx4 v250, s[64:65] offset:0
  s_mov_b32 m0, s76
  s_nop 0
  global_load_lds_dwordx4 v251, s[64:65] offset:1024
  s_mov_b32 m0, s76
  s_nop 0
  global_load_lds_dwordx4 v252, s[64:65] offset:2048
  s_mov_b32 m0, s76
  s_nop 0
  global_load_lds_dwordx4 v253, s[64:65] offset:3072
  s_add_u32 m0, s76, 4096
  s_nop 0
  global_load_lds_dwordx4 v254, s[64:65]
  s_cmp_eq_u32 s14, 0
  s_cbranch_scc1 L_q_go
  s_sub_u32 s21, s6, 6
  s_mul_i32 s21, s21, 12288
  s_add_u32 s64, s70, s21
  s_addc_u32 s65, s71, 0
  s_add_u32 m0, s21, 102400
  s_nop 0
  global_load_lds_dwordx4 v0, s[64:65] offset:0
  global_load_lds_dwordx4 v0, s[64:65] offset:1024
  global_load_lds_dwordx4 v0, s[64:65] offset:2048
  global_load_lds_dwordx4 v0, s[64:65] offset:3072
  s_add_u32 s64, s64, 4096
  s_addc_u32 s65, s65, 0
  s_add_u32 m0, s21, 106496
  s_nop 0
  global_load_lds_dwordx4 v0, s[64:65] offset:0
  global_load_lds_dwordx4 v0, s[64:65] offset:1024
  global_load_lds_dwordx4 v0, s[64:65] offset:2048
  global_load_lds_dwordx4 v0, s[64:65] offset:3072
  s_add_u32 s64, s64, 4096
  s_addc_u32 s65, s65, 0
  s_add_u32 m0, s21, 110592
  s_nop 0
  global_load_lds_dwordx4 v0, s[64:65] offset:0
  global_load_lds_dwordx4 v0, s[64:65] offset:1024
  global_load_lds_dwordx4 v0, s[64:65] offset:2048
  global_load_lds_dwordx4 v0, s[64:65] offset:3072
  s_add_u32 s64, s64, 4096
  s_addc_u32 s65, s65, 0
  s_add_u32 m0, s21, 114688
  s_nop 0
  global_load_lds_dwordx4 v0, s[64:65] offset:0
  s_branch L_q_go
L_q_go:
  s_cmp_eq_u32 s16, 0
  s_cbranch_scc1 L_S4_go
  s_cmp_lt_u32 s75, 40
  s_cbranch_scc0 L_dn_skipg
  s_cmp_ge_u32 s6, 6
  s_cbranch_scc1 L_dn_bg
  s_mul_i32 s21, s8, 16384
  s_add_u32 s21, s21, 671744
  s_add_u32 s64, s60, s21
  s_addc_u32 s65, s61, 0
  s_min_u32 s20, s6, 5
  s_mul_i32 s20, s20, 144
  v_add_u32 v6, s20, v1
  v_add_u32 v7, 64, v6
  v_min_u32 v86, 15, v1
  s_add_u32 s20, s20, 128
  v_add_u32 v86, s20, v86
  v_lshlrev_b32 v8, 4, v6
  v_lshlrev_b32 v9, 4, v86
  global_load_dwordx2 v[240:241], v248, s[60:61] sc1
  global_load_dwordx4 v[72:75], v8, s[64:65] sc1
  global_load_dwordx4 v[76:79], v8, s[64:65] offset:1024 sc1
  global_load_dwordx4 v[100:103], v9, s[64:65] sc1
  v_mov_b32 v64, s12
  v_mov_b32 v65, s13
  v_mov_b32 v66, s96
  v_mov_b32 v67, s97
  v_mov_b32 v68, s98
  v_mov_b32 v69, s99
  v_and_b32 v60, 15, v1
  v_lshrrev_b32 v61, 4, v1
  v_cmp_eq_u32 vcc, 1, v60
  s_nop 1
  v_cndmask_b32 v62, v64, v65, vcc
  v_cndmask_b32 v66, v66, v67, vcc
  v_cndmask_b32 v68, v68, v69, vcc
  v_bfe_u32 v70, v62, 5, 1
  v_mul_u32_u24 v70, 40960, v70
  v_and_b32 v63, 31, v62
  v_lshl_add_u32 v63, v63, 4, v70
  v_lshrrev_b32 v70, 6, v62
  v_mul_u32_u24 v70, 0x54400, v70
  v_add_u32 v63, v63, v70
  s_mov_b32 s22, s75
  s_lshl_b32 s20, s22, 10
  v_and_b32 v70, 1, v61
  v_lshl_add_u32 v63, v70, 3, v63
  v_lshrrev_b32 v70, 1, v61
  v_lshl_add_u32 v63, v70, 9, v63
  v_add_u32 v63, s20, v63
  global_load_dwordx2 v[70:71], v63, s[72:73] sc1
  v_lshrrev_b32 v80, 2, v6
  v_lshlrev_b32 v80, 4, v80
  v_and_b32 v81, 1, v6
  v_lshl_add_u32 v80, v81, 3, v80
  v_bfe_u32 v81, v6, 1, 1
  v_mul_u32_u24 v81, 3456, v81
  v_add_u32 v80, v80, v81
  v_add_u32 v10, 153600, v80
  v_lshrrev_b32 v80, 2, v7
  v_lshlrev_b32 v80, 4, v80
  v_and_b32 v81, 1, v7
  v_lshl_add_u32 v80, v81, 3, v80
  v_bfe_u32 v81, v7, 1, 1
  v_mul_u32_u24 v81, 3456, v81
  v_add_u32 v80, v80, v81
  v_add_u32 v11, 153600, v80
  v_lshrrev_b32 v80, 2, v86
  v_lshlrev_b32 v80, 4, v80
  v_and_b32 v81, 1, v86
  v_lshl_add_u32 v80, v81, 3, v80
  v_bfe_u32 v81, v86, 1, 1
  v_mul_u32_u24 v81, 3456, v81
  v_add_u32 v80, v80, v81
  v_add_u32 v87, 153600, v80
  v_and_b32 v82, 1, v60
  v_mul_u32_u24 v82, 3456, v82
  v_lshl_add_u32 v82, v61, 4, v82
  s_mul_i32 s20, s6, 576
  s_add_u32 s20, s20, 153600
  v_add_u32 v82, s20, v82
  v_lshlrev_b32 v83, 6, v60
  v_lshl_add_u32 v83, v61, 4, v83
  v_add_u32 v84, 160768, v83
  s_lshl_b32 s20, s6, 7
  v_add_u32 v85, s20, v84
  v_cvt_pk_bf16_f32 v66, v66, v66
  v_lshlrev_b32 v66, 16, v66
  v_mul_f32 v66, 0xbfb8aa3b, v66
  v_exp_f32 v66, v66
  s_nop 0
  v_add_f32 v66, 1.0, v66
  v_rcp_f32 v66, v66
  s_nop 0
  v_cvt_pk_bf16_f32 v66, v66, v66
  v_lshlrev_b32 v66, 16, v66
  v_and_b32 v69, 0xffff0000, v68
  v_lshlrev_b32 v68, 16, v68
  v_rcp_f32 v69, v69
  s_mov_b32 s20, 0
  s_nop 0
  s_branch PC_48
PL_46:
  global_load_dwordx4 v[72:75], v8, s[64:65] sc1
  global_load_dwordx4 v[76:79], v8, s[64:65] offset:1024 sc1
  global_load_dwordx4 v[100:103], v9, s[64:65] sc1
PC_48:
  s_waitcnt vmcnt(0)
  v_cmp_ne_u32 vcc, s7, v74
  v_cmp_ne_u32 s[24:25], s7, v78
  s_nop 0
  s_or_b64 vcc, vcc, s[24:25]
  v_cmp_ne_u32 s[24:25], s7, v102
  s_nop 0
  s_or_b64 vcc, vcc, s[24:25]
  s_nop 2
  s_cbranch_vccz PD_47
  s_add_u32 s20, s20, 1
  s_cmp_lt_u32 s20, s9
  s_cbranch_scc1 PL_46
  s_mov_b32 s9, 0
PD_47:
  ds_write_b64 v10, v[72:73]
  ds_write_b64 v11, v[76:77]
  ds_write_b64 v87, v[100:101]
  s_cmp_eq_u32 s10, 0
  s_cbranch_scc0 L_try_49
  v_cmp_eq_u32 vcc, v249, v240
  v_cmp_eq_u32 s[24:25], v249, v241
  s_nop 0
  s_and_b64 s[24:25], s[24:25], vcc
  s_lshr_b64 s[26:27], s[24:25], 4
  s_and_b64 s[24:25], s[24:25], s[26:27]
  s_lshr_b64 s[26:27], s[24:25], 2
  s_and_b64 s[24:25], s[24:25], s[26:27]
  s_lshr_b64 s[26:27], s[24:25], 1
  s_and_b64 s[24:25], s[24:25], s[26:27]
  s_mov_b64 s[100:101], s[24:25]
  s_and_b64 s[24:25], s[24:25], s[34:35]
  s_cbranch_scc0 L_try_49
  s_ff1_i32_b64 s20, s[24:25]
  s_bitset0_b64 s[34:35], s20
  s_mul_i32 s20, s20, 3584
  s_add_u32 s66, s62, s20
  s_addc_u32 s67, s63, 0
  global_load_dwordx4 v[212:215], v0, s[66:67] sc1
  global_load_dwordx2 v[216:217], v5, s[66:67] sc1
  global_load_dwordx4 v[218:221], v4, s[66:67] offset:1536 sc1
  global_load_dwordx4 v[222:225], v4, s[66:67] offset:2560 sc1
  s_mov_b32 s10, 1
L_try_49:
  v_lshlrev_b32 v90, 16, v70
  v_and_b32 v91, 0xffff0000, v70
  v_lshlrev_b32 v92, 16, v71
  v_and_b32 v93, 0xffff0000, v71
  v_sub_f32 v94, v90, v68
  v_sub_f32 v95, v91, v68
  v_sub_f32 v96, v92, v68
  v_sub_f32 v97, v93, v68
  v_cvt_pk_bf16_f32 v94, v94, v94
  v_lshlrev_b32 v94, 16, v94
  v_cvt_pk_bf16_f32 v95, v95, v95
  v_lshlrev_b32 v95, 16, v95
  v_cvt_pk_bf16_f32 v96, v96, v96
  v_lshlrev_b32 v96, 16, v96
  v_cvt_pk_bf16_f32 v97, v97, v97
  v_lshlrev_b32 v97, 16, v97
  v_mul_f32 v94, v94, v69
  v_mul_f32 v95, v95, v69
  v_mul_f32 v96, v96, v69
  v_mul_f32 v97, v97, v69
  v_cvt_pk_bf16_f32 v94, v94, v94
  v_lshlrev_b32 v94, 16, v94
  v_cvt_pk_bf16_f32 v95, v95, v95
  v_lshlrev_b32 v95, 16, v95
  v_cvt_pk_bf16_f32 v96, v96, v96
  v_lshlrev_b32 v96, 16, v96
  v_cvt_pk_bf16_f32 v97, v97, v97
  v_lshlrev_b32 v97, 16, v97
  s_waitcnt lgkmcnt(0)
  ds_read_b128 v[140:143], v82 offset:0
  ds_read_b128 v[144:147], v82 offset:64
  ds_read_b128 v[148:151], v82 offset:128
  ds_read_b128 v[152:155], v82 offset:192
  ds_read_b128 v[156:159], v82 offset:256
  ds_read_b128 v[160:163], v82 offset:320
  ds_read_b128 v[164:167], v82 offset:384
  ds_read_b128 v[168:171], v82 offset:448
  ds_read_b128 v[172:175], v82 offset:512
  s_waitcnt lgkmcnt(8)
  v_mfma_f32_16x16x32_bf16 v[72:75], v[20:23], v[140:143], 0
  s_waitcnt lgkmcnt(7)
  v_mfma_f32_16x16x32_bf16 v[72:75], v[24:27], v[144:147], v[72:75]
  s_waitcnt lgkmcnt(6)
  v_mfma_f32_16x16x32_bf16 v[72:75], v[28:31], v[148:151], v[72:75]
  s_waitcnt lgkmcnt(5)
  v_mfma_f32_16x16x32_bf16 v[72:75], v[32:35], v[152:155], v[72:75]
  s_waitcnt lgkmcnt(4)
  v_mfma_f32_16x16x32_bf16 v[72:75], v[36:39], v[156:159], v[72:75]
  s_waitcnt lgkmcnt(3)
  v_mfma_f32_16x16x32_bf16 v[72:75], v[40:43], v[160:163], v[72:75]
  s_waitcnt lgkmcnt(2)
  v_mfma_f32_16x16x32_bf16 v[72:75], v[44:47], v[164:167], v[72:75]
  s_waitcnt lgkmcnt(1)
  v_mfma_f32_16x16x32_bf16 v[72:75], v[48:51], v[168:171], v[72:75]
  s_waitcnt lgkmcnt(0)
  v_mfma_f32_16x16x32_bf16 v[72:75], v[52:55], v[172:175], v[72:75]
  s_mov_b32 exec_lo, 0x30003
  s_mov_b32 exec_hi, 0x30003
  s_nop 5
  ds_write_b128 v85, v[72:75]
  s_mov_b64 exec, -1
  s_waitcnt lgkmcnt(0)
L_dn_bg:
  s_barrier
  s_cmp_eq_u32 s6, 0
  s_cbranch_scc0 L_dn_skipg
  s_mov_b32 exec_lo, 0x30003
  s_mov_b32 exec_hi, 0x30003
  ds_read_b128 v[140:143], v84 offset:0
  ds_read_b128 v[144:147], v84 offset:128
  ds_read_b128 v[148:151], v84 offset:256
  ds_read_b128 v[152:155], v84 offset:384
  ds_read_b128 v[156:159], v84 offset:512
  ds_read_b128 v[160:163], v84 offset:640
  v_mov_b32 v74, s7
  v_mov_b32 v75, s7
  s_lshl_b32 s20, s22, 7
  s_add_u32 s20, s20, 704512
  v_add_u32 v8, s20, v83
  s_waitcnt lgkmcnt(0)
  v_add_f32 v140, v140, v144
  v_add_f32 v141, v141, v145
  v_add_f32 v142, v142, v146
  v_add_f32 v143, v143, v147
  v_add_f32 v148, v148, v152
  v_add_f32 v149, v149, v153
  v_add_f32 v150, v150, v154
  v_add_f32 v151, v151, v155
  v_add_f32 v156, v156, v160
  v_add_f32 v157, v157, v161
  v_add_f32 v158, v158, v162
  v_add_f32 v159, v159, v163
  v_add_f32 v140, v140, v148
  v_add_f32 v141, v141, v149
  v_add_f32 v142, v142, v150
  v_add_f32 v143, v143, v151
  v_add_f32 v140, v140, v156
  v_add_f32 v141, v141, v157
  v_add_f32 v142, v142, v158
  v_add_f32 v143, v143, v159
  v_cvt_pk_bf16_f32 v140, v140, v140
  v_lshlrev_b32 v140, 16, v140
  v_cvt_pk_bf16_f32 v141, v141, v141
  v_lshlrev_b32 v141, 16, v141
  v_cvt_pk_bf16_f32 v142, v142, v142
  v_lshlrev_b32 v142, 16, v142
  v_cvt_pk_bf16_f32 v143, v143, v143
  v_lshlrev_b32 v143, 16, v143
  v_mul_f32 v140, v140, v66
  v_mul_f32 v141, v141, v66
  v_mul_f32 v142, v142, v66
  v_mul_f32 v143, v143, v66
  v_cvt_pk_bf16_f32 v140, v140, v140
  v_lshlrev_b32 v140, 16, v140
  v_cvt_pk_bf16_f32 v141, v141, v141
  v_lshlrev_b32 v141, 16, v141
  v_cvt_pk_bf16_f32 v142, v142, v142
  v_lshlrev_b32 v142, 16, v142
  v_cvt_pk_bf16_f32 v143, v143, v143
  v_lshlrev_b32 v143, 16, v143
  v_add_f32 v140, v140, v94
  v_add_f32 v141, v141, v95
  v_add_f32 v142, v142, v96
  v_add_f32 v143, v143, v97
  v_cvt_pk_bf16_f32 v140, v140, v140
  v_lshlrev_b32 v140, 16, v140
  v_cvt_pk_bf16_f32 v141, v141, v141
  v_lshlrev_b32 v141, 16, v141
  v_cvt_pk_bf16_f32 v142, v142, v142
  v_lshlrev_b32 v142, 16, v142
  v_cvt_pk_bf16_f32 v143, v143, v143
  v_lshlrev_b32 v143, 16, v143
  v_add_f32 v140, v140, v90
  v_add_f32 v141, v141, v91
  v_add_f32 v142, v142, v92
  v_add_f32 v143, v143, v93
  v_cvt_pk_bf16_f32 v72, v140, v141
  v_cvt_pk_bf16_f32 v73, v142, v143
  global_store_dwordx4 v8, v[72:75], s[60:61] sc1
  s_mov_b64 exec, -1
  s_nop 0
L_dn_skipg:
  s_cmp_eq_u32 s15, 0
  s_cbranch_scc1 L_norefill
  s_cmp_lt_u32 s75, 40
  s_cbranch_scc1 L_norefill
  s_and_b32 s27, s6, 1
  s_cmp_ge_u32 s6, 6
  s_cbranch_scc1 L_rf67
  s_lshr_b32 s28, s6, 1
  s_add_u32 s29, s28, 7
  s_mul_i32 s21, s27, 40960
  s_mul_i32 s22, s28, 81920
  s_add_u32 s21, s21, s22
  s_add_u32 s64, s38, s21
  s_addc_u32 s65, s39, 0
  s_mul_i32 s76, s27, 5120
  s_mul_i32 s22, s29, 10240
  s_add_u32 s76, s76, s22
  s_mov_b32 m0, s76
  s_nop 0
  global_load_lds_dwordx4 v250, s[64:65] offset:0
  s_mov_b32 m0, s76
  s_nop 0
  global_load_lds_dwordx4 v251, s[64:65] offset:1024
  s_mov_b32 m0, s76
  s_nop 0
  global_load_lds_dwordx4 v252, s[64:65] offset:2048
  s_mov_b32 m0, s76
  s_nop 0
  global_load_lds_dwordx4 v253, s[64:65] offset:3072
  s_add_u32 m0, s76, 4096
  s_nop 0
  global_load_lds_dwordx4 v254, s[64:65]
  s_branch L_norefill
L_rf67:
  s_cmp_eq_u32 s14, 0
  s_cbranch_scc1 L_norefill
  s_sub_u32 s21, s6, 6
  s_mul_i32 s21, s21, 12288
  s_add_u32 s64, s70, s21
  s_addc_u32 s65, s71, 0
  s_add_u32 m0, s21, 102400
  s_nop 0
  global_load_lds_dwordx4 v0, s[64:65] offset:0
  global_load_lds_dwordx4 v0, s[64:65] offset:1024
  global_load_lds_dwordx4 v0, s[64:65] offset:2048
  global_load_lds_dwordx4 v0, s[64:65] offset:3072
  s_add_u32 s64, s64, 4096
  s_addc_u32 s65, s65, 0
  s_add_u32 m0, s21, 106496
  s_nop 0
  global_load_lds_dwordx4 v0, s[64:65] offset:0
  global_load_lds_dwordx4 v0, s[64:65] offset:1024
  global_load_lds_dwordx4 v0, s[64:65] offset:2048
  global_load_lds_dwordx4 v0, s[64:65] offset:3072
  s_add_u32 s64, s64, 4096
  s_addc_u32 s65, s65, 0
  s_add_u32 m0, s21, 110592
  s_nop 0
  global_load_lds_dwordx4 v0, s[64:65] offset:0
  global_load_lds_dwordx4 v0, s[64:65] offset:1024
  global_load_lds_dwordx4 v0, s[64:65] offset:2048
  global_load_lds_dwordx4 v0, s[64:65] offset:3072
  s_add_u32 s64, s64, 4096
  s_addc_u32 s65, s65, 0
  s_add_u32 m0, s21, 114688
  s_nop 0
  global_load_lds_dwordx4 v0, s[64:65] offset:0
L_norefill:
  s_cmp_eq_u32 s15, 0
  s_cbranch_scc1 L_S4_go
  s_lshl_b32 s20, s6, 6
  v_add_u32 v6, s20, v1
  v_min_u32 v6, 319, v6
  v_lshlrev_b32 v7, 4, v6
  v_add_u32 v7, 704512, v7
  global_load_dwordx2 v[240:241], v248, s[60:61] sc1
  global_load_dwordx4 v[72:75], v7, s[60:61] sc1
  v_mov_b32 v64, s12
  v_mov_b32 v65, s13
  v_mov_b32 v66, s96
  v_mov_b32 v67, s97
  v_mov_b32 v68, s98
  v_mov_b32 v69, s99
  v_lshrrev_b32 v8, 3, v6
  v_lshlrev_b32 v8, 5, v8
  v_and_b32 v9, 3, v6
  v_lshl_add_u32 v8, v9, 3, v8
  v_bfe_u32 v9, v6, 2, 1
  v_mul_u32_u24 v9, 1280, v9
  v_add_u32 v8, v8, v9
  v_add_u32 v11, 153600, v8
  v_and_b32 v60, 15, v1
  v_lshrrev_b32 v61, 4, v1
  v_and_b32 v8, 1, v60
  v_cmp_eq_u32 vcc, 1, v8
  s_nop 1
  v_cndmask_b32 v62, v64, v65, vcc
  v_mul_u32_u24 v63, 1280, v8
  v_lshl_add_u32 v63, v61, 4, v63
  v_add_u32 v63, 153600, v63
  v_lshlrev_b32 v70, 3, v8
  v_add_u32 v70, 163424, v70
  v_bfe_u32 v9, v1, 2, 2
  v_and_b32 v10, 3, v1
  s_cmp_ge_u32 s6, 5
  s_nop 0
  s_cbranch_scc1 L_fx_a5
  v_lshlrev_b32 v66, 1, v9
  v_lshl_add_u32 v66, v61, 3, v66
  v_mul_u32_u24 v66, 160, v66
  v_lshl_add_u32 v66, v10, 3, v66
  s_lshl_b32 s20, s6, 5
  v_add_u32 v66, s20, v66
  v_add_u32 v67, 61440, v66
  s_lshl_b32 s20, s6, 2
  v_add_u32 v8, s20, v61
  v_lshlrev_b32 v68, 4, v8
  v_add_u32 v68, 162816, v68
  v_mul_u32_u24 v9, 205, v8
  v_lshrrev_b32 v9, 10, v9
  v_mul_u32_u24 v10, 5, v9
  v_sub_u32 v8, v8, v10
  v_mul_u32_u24 v9, 1536, v9
  v_bfe_u32 v10, v62, 5, 1
  v_mul_u32_u24 v10, 6144, v10
  v_add_u32 v9, v9, v10
  v_add_u32 v9, 141312, v9
  v_and_b32 v10, 31, v62
  v_lshrrev_b32 v69, 1, v8
  v_lshl_add_u32 v69, v69, 5, v10
  v_lshlrev_b32 v69, 4, v69
  v_and_b32 v71, 1, v8
  v_lshl_add_u32 v69, v71, 3, v69
  v_lshlrev_b32 v10, 3, v10
  v_add_u32 v10, 1024, v10
  v_cmp_eq_u32 vcc, 4, v8
  s_nop 1
  v_cndmask_b32 v69, v69, v10, vcc
  v_add_u32 v69, v69, v9
  v_lshrrev_b32 v8, 6, v62
  v_cmp_eq_u32 vcc, s4, v8
  v_cmp_gt_u32 s[24:25], 2, v60
  s_nop 0
  s_and_b64 s[30:31], vcc, s[24:25]
  s_nop 2
  s_branch L_fx_poll
L_fx_a5:
  v_lshl_add_u32 v66, v61, 3, v9
  v_mul_u32_u24 v66, 40, v66
  s_cmp_eq_u32 s6, 6
  s_cselect_b32 s22, 0, 4
  s_cselect_b32 s23, 3, 0
  v_and_b32 v10, s23, v10
  v_add_u32 v10, s22, v10
  v_lshl_add_u32 v66, v10, 3, v66
  v_add_u32 v66, 102400, v66
  s_nop 1
L_fx_poll:
  s_waitcnt vmcnt(0)
  s_barrier
  s_cmp_eq_u32 s6, 5
  s_cbranch_scc1 L_fx_wd
  s_cmp_ge_u32 s6, 6
  s_cbranch_scc1 L_fx_wk
  ds_read_b64_tr_b16 v[120:121], v67 offset:10240
  ds_read_b64_tr_b16 v[122:123], v67 offset:10400
  ds_read_b64_tr_b16 v[124:125], v67 offset:15360
  ds_read_b64_tr_b16 v[126:127], v67 offset:15520
  ds_read_b64_tr_b16 v[128:129], v67 offset:20480
  ds_read_b64_tr_b16 v[130:131], v67 offset:20640
  ds_read_b64_tr_b16 v[132:133], v67 offset:25600
  ds_read_b64_tr_b16 v[134:135], v67 offset:25760
  ds_read_b64_tr_b16 v[136:137], v67 offset:30720
  ds_read_b64_tr_b16 v[138:139], v67 offset:30880
  ds_read_b64_tr_b16 v[140:141], v67 offset:35840
  ds_read_b64_tr_b16 v[142:143], v67 offset:36000
  ds_read_b64_tr_b16 v[144:145], v67 offset:0
  ds_read_b64_tr_b16 v[146:147], v67 offset:160
  ds_read_b64_tr_b16 v[148:149], v67 offset:5120
  ds_read_b64_tr_b16 v[150:151], v67 offset:5280
  ds_read_b64_tr_b16 v[152:153], v66 offset:0
  ds_read_b64_tr_b16 v[154:155], v66 offset:160
  ds_read_b64_tr_b16 v[156:157], v66 offset:5120
  ds_read_b64_tr_b16 v[158:159], v66 offset:5280
  ds_read_b64_tr_b16 v[160:161], v66 offset:10240
  ds_read_b64_tr_b16 v[162:163], v66 offset:10400
  ds_read_b64_tr_b16 v[164:165], v66 offset:15360
  ds_read_b64_tr_b16 v[166:167], v66 offset:15520
  ds_read_b64_tr_b16 v[168:169], v66 offset:20480
  ds_read_b64_tr_b16 v[170:171], v66 offset:20640
  ds_read_b64_tr_b16 v[172:173], v66 offset:25600
  ds_read_b64_tr_b16 v[174:175], v66 offset:25760
  ds_read_b64_tr_b16 v[176:177], v66 offset:30720
  ds_read_b64_tr_b16 v[178:179], v66 offset:30880
  ds_read_b64_tr_b16 v[180:181], v66 offset:35840
  ds_read_b64_tr_b16 v[182:183], v66 offset:36000
  ds_read_b64_tr_b16 v[184:185], v66 offset:40960
  ds_read_b64_tr_b16 v[186:187], v66 offset:41120
  ds_read_b64_tr_b16 v[188:189], v66 offset:46080
  ds_read_b64_tr_b16 v[190:191], v66 offset:46240
  ds_read_b64_tr_b16 v[192:193], v66 offset:51200
  ds_read_b64_tr_b16 v[194:195], v66 offset:51360
  ds_read_b64_tr_b16 v[196:197], v66 offset:56320
  ds_read_b64_tr_b16 v[198:199], v66 offset:56480
  ds_read_b128 v[80:83], v68
  s_branch L_fx_wd
L_fx_wk:
  ds_read_b64_tr_b16 v[120:121], v66 offset:0
  ds_read_b64_tr_b16 v[122:123], v66 offset:160
  ds_read_b64_tr_b16 v[124:125], v66 offset:1280
  ds_read_b64_tr_b16 v[126:127], v66 offset:1440
  ds_read_b64_tr_b16 v[128:129], v66 offset:2560
  ds_read_b64_tr_b16 v[130:131], v66 offset:2720
  ds_read_b64_tr_b16 v[132:133], v66 offset:3840
  ds_read_b64_tr_b16 v[134:135], v66 offset:4000
  ds_read_b64_tr_b16 v[136:137], v66 offset:5120
  ds_read_b64_tr_b16 v[138:139], v66 offset:5280
  ds_read_b64_tr_b16 v[140:141], v66 offset:6400
  ds_read_b64_tr_b16 v[142:143], v66 offset:6560
  ds_read_b64_tr_b16 v[144:145], v66 offset:7680
  ds_read_b64_tr_b16 v[146:147], v66 offset:7840
  ds_read_b64_tr_b16 v[148:149], v66 offset:8960
  ds_read_b64_tr_b16 v[150:151], v66 offset:9120
  ds_read_b64_tr_b16 v[152:153], v66 offset:10240
  ds_read_b64_tr_b16 v[154:155], v66 offset:10400
  ds_read_b64_tr_b16 v[156:157], v66 offset:11520
  ds_read_b64_tr_b16 v[158:159], v66 offset:11680
  ds_read_b64_tr_b16 v[160:161], v66 offset:12800
  ds_read_b64_tr_b16 v[162:163], v66 offset:12960
  ds_read_b64_tr_b16 v[164:165], v66 offset:14080
  ds_read_b64_tr_b16 v[166:167], v66 offset:14240
  ds_read_b64_tr_b16 v[168:169], v66 offset:15360
  ds_read_b64_tr_b16 v[170:171], v66 offset:15520
  ds_read_b64_tr_b16 v[172:173], v66 offset:16640
  ds_read_b64_tr_b16 v[174:175], v66 offset:16800
  ds_read_b64_tr_b16 v[176:177], v66 offset:17920
  ds_read_b64_tr_b16 v[178:179], v66 offset:18080
  ds_read_b64_tr_b16 v[180:181], v66 offset:19200
  ds_read_b64_tr_b16 v[182:183], v66 offset:19360
  ds_read_b64_tr_b16 v[184:185], v66 offset:20480
  ds_read_b64_tr_b16 v[186:187], v66 offset:20640
  ds_read_b64_tr_b16 v[188:189], v66 offset:21760
  ds_read_b64_tr_b16 v[190:191], v66 offset:21920
  ds_read_b64_tr_b16 v[192:193], v66 offset:23040
  ds_read_b64_tr_b16 v[194:195], v66 offset:23200
  ds_read_b64_tr_b16 v[196:197], v66 offset:24320
  ds_read_b64_tr_b16 v[198:199], v66 offset:24480
L_fx_wd:
  s_cmp_eq_u32 s10, 0
  s_cbranch_scc0 L_try_50
  v_cmp_eq_u32 vcc, v249, v240
  v_cmp_eq_u32 s[24:25], v249, v241
  s_nop 0
  s_and_b64 s[24:25], s[24:25], vcc
  s_lshr_b64 s[26:27], s[24:25], 4
  s_and_b64 s[24:25], s[24:25], s[26:27]
  s_lshr_b64 s[26:27], s[24:25], 2
  s_and_b64 s[24:25], s[24:25], s[26:27]
  s_lshr_b64 s[26:27], s[24:25], 1
  s_and_b64 s[24:25], s[24:25], s[26:27]
  s_mov_b64 s[100:101], s[24:25]
  s_and_b64 s[24:25], s[24:25], s[34:35]
  s_cbranch_scc0 L_try_50
  s_ff1_i32_b64 s20, s[24:25]
  s_bitset0_b64 s[34:35], s20
  s_mul_i32 s20, s20, 3584
  s_add_u32 s66, s62, s20
  s_addc_u32 s67, s63, 0
  global_load_dwordx4 v[212:215], v0, s[66:67] sc1
  global_load_dwordx2 v[216:217], v5, s[66:67] sc1
  global_load_dwordx4 v[218:221], v4, s[66:67] offset:1536 sc1
  global_load_dwordx4 v[222:225], v4, s[66:67] offset:2560 sc1
  s_mov_b32 s10, 1
L_try_50:
  v_mov_b32 v9, 0x3f803f80
  s_lshl_b32 s20, s6, 4
  s_add_u32 s20, s20, 163456
  v_bfe_u32 v8, v1, 2, 1
  v_lshl_add_u32 v8, v8, 3, s20
  v_and_b32 v70, 1, v60
  v_lshlrev_b32 v70, 3, v70
  v_add_u32 v70, 163456, v70
  s_mov_b32 s20, 0
  s_nop 0
  s_branch PC_53
PL_51:
  global_load_dwordx4 v[72:75], v7, s[60:61] sc1
PC_53:
  s_waitcnt vmcnt(0)
  v_cmp_ne_u32 vcc, s7, v74
  s_nop 4
  s_cbranch_vccz PD_52
  s_sleep 2
  s_add_u32 s20, s20, 1
  s_cmp_lt_u32 s20, s9
  s_cbranch_scc1 PL_51
  s_mov_b32 s9, 0
PD_52:
  ds_write_b64 v11, v[72:73]
  v_dot2_f32_bf16 v76, v72, v9, 0
  v_dot2_f32_bf16 v77, v72, v72, 0
  v_dot2_f32_bf16 v76, v73, v9, v76
  v_dot2_f32_bf16 v77, v73, v73, v77
  s_nop 1
  v_add_f32_dpp v76, v76, v76 quad_perm:[1,0,3,2] row_mask:0xf bank_mask:0xf
  v_add_f32_dpp v77, v77, v77 quad_perm:[1,0,3,2] row_mask:0xf bank_mask:0xf
  s_nop 0
  v_add_f32_dpp v76, v76, v76 quad_perm:[2,3,0,1] row_mask:0xf bank_mask:0xf
  v_add_f32_dpp v77, v77, v77 quad_perm:[2,3,0,1] row_mask:0xf bank_mask:0xf
  s_nop 0
  v_add_f32_dpp v76, v76, v76 row_ror:8 row_mask:0xf bank_mask:0xf
  v_add_f32_dpp v77, v77, v77 row_ror:8 row_mask:0xf bank_mask:0xf
  v_mov_b32 v78, v76
  v_mov_b32 v79, v77
  s_nop 0
  v_permlane16_swap_b32 v76, v78
  v_permlane16_swap_b32 v77, v79
  v_add_f32 v76, v76, v78
  v_add_f32 v77, v77, v79
  v_mov_b32 v78, v76
  v_mov_b32 v79, v77
  s_nop 0
  v_permlane32_swap_b32 v76, v78
  v_permlane32_swap_b32 v77, v79
  v_add_f32 v76, v76, v78
  v_add_f32 v77, v77, v79
  ds_write_b64 v8, v[76:77]
  s_waitcnt lgkmcnt(0)
  s_barrier
  s_cmp_eq_u32 s6, 5
  s_cbranch_scc1 L_fx_res
  s_cmp_ge_u32 s6, 6
  s_cbranch_scc0 L_fx_go
  s_cmp_eq_u32 s14, 0
  s_cbranch_scc1 L_fx_done
L_fx_go:
  ds_read_b64 v[100:101], v70 offset:0
  ds_read_b64 v[102:103], v70 offset:16
  ds_read_b64 v[104:105], v70 offset:32
  ds_read_b64 v[106:107], v70 offset:48
  ds_read_b64 v[108:109], v70 offset:64
  s_cmp_ge_u32 s6, 6
  s_cbranch_scc1 L_fx_kvdo
  ds_read_b128 v[200:203], v63 offset:0
  ds_read_b128 v[204:207], v63 offset:64
  ds_read_b128 v[208:211], v63 offset:128
  ds_read_b128 v[88:91], v63 offset:192
  ds_read_b128 v[92:95], v63 offset:256
  ds_read_b128 v[96:99], v63 offset:320
  ds_read_b128 v[116:119], v63 offset:384
  s_waitcnt lgkmcnt(6)
  v_mfma_f32_16x16x32_bf16 v[76:79], v[120:123], v[200:203], 0
  v_add_f32 v100, v100, v102
  v_add_f32 v101, v101, v103
  v_add_f32 v104, v104, v106
  v_add_f32 v105, v105, v107
  v_add_f32 v100, v100, v104
  v_add_f32 v101, v101, v105
  v_add_f32 v100, v100, v108
  v_add_f32 v101, v101, v109
  v_mul_f32 v102, 0x3acccccd, v100
  v_mul_f32 v103, 0x3acccccd, v101
  v_fma_f32 v103, -v102, v102, v103
  ds_read_b128 v[200:203], v63 offset:448
  s_waitcnt lgkmcnt(6)
  v_mfma_f32_16x16x32_bf16 v[72:75], v[124:127], v[204:207], 0
  ds_read_b128 v[204:207], v63 offset:512
  s_waitcnt lgkmcnt(6)
  v_mfma_f32_16x16x32_bf16 v[76:79], v[128:131], v[208:211], v[76:79]
  v_cvt_pk_bf16_f32 v104, v102, v102
  v_lshlrev_b32 v104, 16, v104
  v_max_f32 v106, 0, v103
  v_cvt_pk_bf16_f32 v106, v106, v106
  v_lshlrev_b32 v106, 16, v106
  v_add_f32 v106, 0x3727c5ac, v106
  v_cvt_pk_bf16_f32 v106, v106, v106
  v_lshlrev_b32 v106, 16, v106
  v_sqrt_f32 v106, v106
  s_nop 0
  v_cvt_pk_bf16_f32 v105, v106, v106
  v_lshlrev_b32 v105, 16, v105
  v_rcp_f32 v84, v105
  s_nop 0
  v_mul_f32 v85, v104, v84
  ds_read_b128 v[208:211], v63 offset:576
  s_waitcnt lgkmcnt(6)
  v_mfma_f32_16x16x32_bf16 v[72:75], v[132:135], v[88:91], v[72:75]
  ds_read_b128 v[88:91], v63 offset:640
  s_waitcnt lgkmcnt(6)
  v_mfma_f32_16x16x32_bf16 v[76:79], v[136:139], v[92:95], v[76:79]
  ds_read_b128 v[92:95], v63 offset:704
  s_waitcnt lgkmcnt(6)
  v_mfma_f32_16x16x32_bf16 v[72:75], v[140:143], v[96:99], v[72:75]
  ds_read_b128 v[96:99], v63 offset:768
  s_waitcnt lgkmcnt(6)
  v_mfma_f32_16x16x32_bf16 v[76:79], v[144:147], v[116:119], v[76:79]
  ds_read_b128 v[116:119], v63 offset:832
  s_waitcnt lgkmcnt(6)
  v_mfma_f32_16x16x32_bf16 v[72:75], v[148:151], v[200:203], v[72:75]
  ds_read_b128 v[200:203], v63 offset:896
  s_waitcnt lgkmcnt(6)
  v_mfma_f32_16x16x32_bf16 v[76:79], v[152:155], v[204:207], v[76:79]
  ds_read_b128 v[204:207], v63 offset:960
  s_waitcnt lgkmcnt(6)
  v_mfma_f32_16x16x32_bf16 v[72:75], v[156:159], v[208:211], v[72:75]
  ds_read_b128 v[208:211], v63 offset:1024
  s_waitcnt lgkmcnt(6)
  v_mfma_f32_16x16x32_bf16 v[76:79], v[160:163], v[88:91], v[76:79]
  ds_read_b128 v[88:91], v63 offset:1088
  s_waitcnt lgkmcnt(6)
  v_mfma_f32_16x16x32_bf16 v[72:75], v[164:167], v[92:95], v[72:75]
  ds_read_b128 v[92:95], v63 offset:1152
  s_waitcnt lgkmcnt(6)
  v_mfma_f32_16x16x32_bf16 v[76:79], v[168:171], v[96:99], v[76:79]
  ds_read_b128 v[96:99], v63 offset:1216
  s_waitcnt lgkmcnt(6)
  v_mfma_f32_16x16x32_bf16 v[72:75], v[172:175], v[116:119], v[72:75]
  s_waitcnt lgkmcnt(5)
  v_mfma_f32_16x16x32_bf16 v[76:79], v[176:179], v[200:203], v[76:79]
  s_waitcnt lgkmcnt(4)
  v_mfma_f32_16x16x32_bf16 v[72:75], v[180:183], v[204:207], v[72:75]
  s_waitcnt lgkmcnt(3)
  v_mfma_f32_16x16x32_bf16 v[76:79], v[184:187], v[208:211], v[76:79]
  s_waitcnt lgkmcnt(2)
  v_mfma_f32_16x16x32_bf16 v[72:75], v[188:191], v[88:91], v[72:75]
  s_waitcnt lgkmcnt(1)
  v_mfma_f32_16x16x32_bf16 v[76:79], v[192:195], v[92:95], v[76:79]
  s_waitcnt lgkmcnt(0)
  v_mfma_f32_16x16x32_bf16 v[72:75], v[196:199], v[96:99], v[72:75]
  s_nop 7
  v_add_f32 v76, v76, v72
  v_add_f32 v77, v77, v73
  v_add_f32 v78, v78, v74
  v_add_f32 v79, v79, v75
  v_mul_f32 v84, 0x3ea52b5c, v84
  v_mul_f32 v85, 0x3ea52b5c, v85
  v_mul_f32 v80, v85, v80
  v_mul_f32 v81, v85, v81
  v_mul_f32 v82, v85, v82
  v_mul_f32 v83, v85, v83
  v_fma_f32 v76, v84, v76, -v80
  v_fma_f32 v77, v84, v77, -v81
  v_fma_f32 v78, v84, v78, -v82
  v_fma_f32 v79, v84, v79, -v83
  v_cvt_pk_bf16_f32 v76, v76, v77
  v_cvt_pk_bf16_f32 v77, v78, v79
  s_mov_b64 exec, s[30:31]
  ds_write_b64 v69, v[76:77]
  s_mov_b64 exec, -1
  s_branch L_fx_res
L_fx_kvdo:
  s_lshl_b32 s22, s4, 2
  s_add_u32 s22, s22, s19
  s_bitcmp1_b32 s5, 0
  s_cbranch_scc1 L_fx_v
  v_lshrrev_b32 v8, 4, v62
  v_cmp_eq_u32 vcc, s22, v8
  v_cmp_gt_u32 s[24:25], 2, v60
  s_nop 0
  s_and_b64 s[30:31], vcc, s[24:25]
  v_and_b32 v10, 31, v62
  v_lshrrev_b32 v8, 1, v61
  v_lshl_add_u32 v8, v8, 5, v10
  v_lshlrev_b32 v8, 4, v8
  v_and_b32 v9, 1, v61
  v_lshl_add_u32 v8, v9, 3, v8
  s_cmp_eq_u32 s6, 6
  s_nop 0
  s_cbranch_scc1 L_fx_k6
  v_lshlrev_b32 v8, 3, v10
  v_add_u32 v8, 1024, v8
  s_and_b64 s[30:31], s[30:31], 3
  s_nop 0
L_fx_k6:
  ds_read_b128 v[200:203], v63 offset:0
  ds_read_b128 v[204:207], v63 offset:64
  ds_read_b128 v[208:211], v63 offset:128
  ds_read_b128 v[88:91], v63 offset:192
  ds_read_b128 v[92:95], v63 offset:256
  ds_read_b128 v[96:99], v63 offset:320
  ds_read_b128 v[116:119], v63 offset:384
  s_waitcnt lgkmcnt(6)
  v_mfma_f32_16x16x32_bf16 v[76:79], v[120:123], v[200:203], 0
  v_add_f32 v100, v100, v102
  v_add_f32 v101, v101, v103
  v_add_f32 v104, v104, v106
  v_add_f32 v105, v105, v107
  v_add_f32 v100, v100, v104
  v_add_f32 v101, v101, v105
  v_add_f32 v100, v100, v108
  v_add_f32 v101, v101, v109
  v_mul_f32 v102, 0x3acccccd, v100
  v_mul_f32 v103, 0x3acccccd, v101
  v_fma_f32 v103, -v102, v102, v103
  ds_read_b128 v[200:203], v63 offset:448
  s_waitcnt lgkmcnt(6)
  v_mfma_f32_16x16x32_bf16 v[72:75], v[124:127], v[204:207], 0
  ds_read_b128 v[204:207], v63 offset:512
  s_waitcnt lgkmcnt(6)
  v_mfma_f32_16x16x32_bf16 v[76:79], v[128:131], v[208:211], v[76:79]
  v_cvt_pk_bf16_f32 v104, v102, v102
  v_lshlrev_b32 v104, 16, v104
  v_max_f32 v106, 0, v103
  v_cvt_pk_bf16_f32 v106, v106, v106
  v_lshlrev_b32 v106, 16, v106
  v_add_f32 v106, 0x3727c5ac, v106
  v_cvt_pk_bf16_f32 v106, v106, v106
  v_lshlrev_b32 v106, 16, v106
  v_sqrt_f32 v106, v106
  s_nop 0
  v_cvt_pk_bf16_f32 v105, v106, v106
  v_lshlrev_b32 v105, 16, v105
  v_rcp_f32 v84, v105
  s_nop 0
  v_mul_f32 v85, v104, v84
  ds_read_b128 v[208:211], v63 offset:576
  s_waitcnt lgkmcnt(6)
  v_mfma_f32_16x16x32_bf16 v[72:75], v[132:135], v[88:91], v[72:75]
  ds_read_b128 v[88:91], v63 offset:640
  s_waitcnt lgkmcnt(6)
  v_mfma_f32_16x16x32_bf16 v[76:79], v[136:139], v[92:95], v[76:79]
  ds_read_b128 v[92:95], v63 offset:704
  s_waitcnt lgkmcnt(6)
  v_mfma_f32_16x16x32_bf16 v[72:75], v[140:143], v[96:99], v[72:75]
  ds_read_b128 v[96:99], v63 offset:768
  s_waitcnt lgkmcnt(6)
  v_mfma_f32_16x16x32_bf16 v[76:79], v[144:147], v[116:119], v[76:79]
  ds_read_b128 v[116:119], v63 offset:832
  s_waitcnt lgkmcnt(6)
  v_mfma_f32_16x16x32_bf16 v[72:75], v[148:151], v[200:203], v[72:75]
  ds_read_b128 v[200:203], v63 offset:896
  s_waitcnt lgkmcnt(6)
  v_mfma_f32_16x16x32_bf16 v[76:79], v[152:155], v[204:207], v[76:79]
  ds_read_b128 v[204:207], v63 offset:960
  s_waitcnt lgkmcnt(6)
  v_mfma_f32_16x16x32_bf16 v[72:75], v[156:159], v[208:211], v[72:75]
  ds_read_b128 v[208:211], v63 offset:1024
  s_waitcnt lgkmcnt(6)
  v_mfma_f32_16x16x32_bf16 v[76:79], v[160:163], v[88:91], v[76:79]
  ds_read_b128 v[88:91], v63 offset:1088
  s_waitcnt lgkmcnt(6)
  v_mfma_f32_16x16x32_bf16 v[72:75], v[164:167], v[92:95], v[72:75]
  ds_read_b128 v[92:95], v63 offset:1152
  s_waitcnt lgkmcnt(6)
  v_mfma_f32_16x16x32_bf16 v[76:79], v[168:171], v[96:99], v[76:79]
  ds_read_b128 v[96:99], v63 offset:1216
  s_waitcnt lgkmcnt(6)
  v_mfma_f32_16x16x32_bf16 v[72:75], v[172:175], v[116:119], v[72:75]
  s_waitcnt lgkmcnt(5)
  v_mfma_f32_16x16x32_bf16 v[76:79], v[176:179], v[200:203], v[76:79]
  s_waitcnt lgkmcnt(4)
  v_mfma_f32_16x16x32_bf16 v[72:75], v[180:183], v[204:207], v[72:75]
  s_waitcnt lgkmcnt(3)
  v_mfma_f32_16x16x32_bf16 v[76:79], v[184:187], v[208:211], v[76:79]
  s_waitcnt lgkmcnt(2)
  v_mfma_f32_16x16x32_bf16 v[72:75], v[188:191], v[88:91], v[72:75]
  s_waitcnt lgkmcnt(1)
  v_mfma_f32_16x16x32_bf16 v[76:79], v[192:195], v[92:95], v[76:79]
  s_waitcnt lgkmcnt(0)
  v_mfma_f32_16x16x32_bf16 v[72:75], v[196:199], v[96:99], v[72:75]
  s_nop 7
  v_add_f32 v76, v76, v72
  v_add_f32 v77, v77, v73
  v_add_f32 v78, v78, v74
  v_add_f32 v79, v79, v75
  v_mul_f32 v80, v85, v12
  v_mul_f32 v81, v85, v13
  v_mul_f32 v82, v85, v14
  v_mul_f32 v83, v85, v15
  v_fma_f32 v76, v84, v76, -v80
  v_fma_f32 v77, v84, v77, -v81
  v_fma_f32 v78, v84, v78, -v82
  v_fma_f32 v79, v84, v79, -v83
  v_cvt_pk_bf16_f32 v76, v76, v77
  v_cvt_pk_bf16_f32 v77, v78, v79
  s_mov_b64 exec, s[30:31]
  global_store_dwordx2 v8, v[76:77], s[68:69] sc1
  s_branch L_fx_flag
L_fx_v:
  v_and_b32 v8, 3, v60
  v_bfe_u32 v9, v60, 2, 1
  v_lshl_add_u32 v8, v9, 3, v8
  v_bfe_u32 v9, v60, 3, 1
  v_lshl_add_u32 v8, v9, 2, v8
  s_mov_b64 s[30:31], 0xffff
  s_cmp_eq_u32 s6, 6
  s_cbranch_scc1 L_fx_v6
  v_add_u32 v8, 16, v60
  s_mov_b64 s[30:31], 15
  s_nop 0
L_fx_v6:
  v_lshlrev_b32 v8, 4, v8
  s_and_b32 s20, s19, 1
  s_lshl_b32 s20, s20, 10
  s_add_u32 s23, s20, 1536
  ds_read_b128 v[200:203], v63 offset:0
  ds_read_b128 v[204:207], v63 offset:64
  ds_read_b128 v[208:211], v63 offset:128
  ds_read_b128 v[88:91], v63 offset:192
  ds_read_b128 v[92:95], v63 offset:256
  ds_read_b128 v[96:99], v63 offset:320
  ds_read_b128 v[116:119], v63 offset:384
  s_waitcnt lgkmcnt(6)
  v_mfma_f32_16x16x32_bf16 v[76:79], v[200:203], v[120:123], 0
  v_add_f32 v100, v100, v102
  v_add_f32 v101, v101, v103
  v_add_f32 v104, v104, v106
  v_add_f32 v105, v105, v107
  v_add_f32 v100, v100, v104
  v_add_f32 v101, v101, v105
  v_add_f32 v100, v100, v108
  v_add_f32 v101, v101, v109
  v_mul_f32 v102, 0x3acccccd, v100
  v_mul_f32 v103, 0x3acccccd, v101
  v_fma_f32 v103, -v102, v102, v103
  ds_read_b128 v[200:203], v63 offset:448
  s_waitcnt lgkmcnt(6)
  v_mfma_f32_16x16x32_bf16 v[72:75], v[204:207], v[124:127], 0
  ds_read_b128 v[204:207], v63 offset:512
  s_waitcnt lgkmcnt(6)
  v_mfma_f32_16x16x32_bf16 v[76:79], v[208:211], v[128:131], v[76:79]
  v_cvt_pk_bf16_f32 v104, v102, v102
  v_lshlrev_b32 v104, 16, v104
  v_max_f32 v106, 0, v103
  v_cvt_pk_bf16_f32 v106, v106, v106
  v_lshlrev_b32 v106, 16, v106
  v_add_f32 v106, 0x3727c5ac, v106
  v_cvt_pk_bf16_f32 v106, v106, v106
  v_lshlrev_b32 v106, 16, v106
  v_sqrt_f32 v106, v106
  s_nop 0
  v_cvt_pk_bf16_f32 v105, v106, v106
  v_lshlrev_b32 v105, 16, v105
  v_rcp_f32 v84, v105
  s_nop 0
  v_mul_f32 v85, v104, v84
  ds_read_b128 v[208:211], v63 offset:576
  s_waitcnt lgkmcnt(6)
  v_mfma_f32_16x16x32_bf16 v[72:75], v[88:91], v[132:135], v[72:75]
  ds_read_b128 v[88:91], v63 offset:640
  s_waitcnt lgkmcnt(6)
  v_mfma_f32_16x16x32_bf16 v[76:79], v[92:95], v[136:139], v[76:79]
  ds_read_b128 v[92:95], v63 offset:704
  s_waitcnt lgkmcnt(6)
  v_mfma_f32_16x16x32_bf16 v[72:75], v[96:99], v[140:143], v[72:75]
  ds_read_b128 v[96:99], v63 offset:768
  s_waitcnt lgkmcnt(6)
  v_mfma_f32_16x16x32_bf16 v[76:79], v[116:119], v[144:147], v[76:79]
  ds_read_b128 v[116:119], v63 offset:832
  s_waitcnt lgkmcnt(6)
  v_mfma_f32_16x16x32_bf16 v[72:75], v[200:203], v[148:151], v[72:75]
  ds_read_b128 v[200:203], v63 offset:896
  s_waitcnt lgkmcnt(6)
  v_mfma_f32_16x16x32_bf16 v[76:79], v[204:207], v[152:155], v[76:79]
  ds_read_b128 v[204:207], v63 offset:960
  s_waitcnt lgkmcnt(6)
  v_mfma_f32_16x16x32_bf16 v[72:75], v[208:211], v[156:159], v[72:75]
  ds_read_b128 v[208:211], v63 offset:1024
  s_waitcnt lgkmcnt(6)
  v_mfma_f32_16x16x32_bf16 v[76:79], v[88:91], v[160:163], v[76:79]
  ds_read_b128 v[88:91], v63 offset:1088
  s_waitcnt lgkmcnt(6)
  v_mfma_f32_16x16x32_bf16 v[72:75], v[92:95], v[164:167], v[72:75]
  ds_read_b128 v[92:95], v63 offset:1152
  s_waitcnt lgkmcnt(6)
  v_mfma_f32_16x16x32_bf16 v[76:79], v[96:99], v[168:171], v[76:79]
  ds_read_b128 v[96:99], v63 offset:1216
  s_waitcnt lgkmcnt(6)
  v_mfma_f32_16x16x32_bf16 v[72:75], v[116:119], v[172:175], v[72:75]
  s_waitcnt lgkmcnt(5)
  v_mfma_f32_16x16x32_bf16 v[76:79], v[200:203], v[176:179], v[76:79]
  s_waitcnt lgkmcnt(4)
  v_mfma_f32_16x16x32_bf16 v[72:75], v[204:207], v[180:183], v[72:75]
  s_waitcnt lgkmcnt(3)
  v_mfma_f32_16x16x32_bf16 v[76:79], v[208:211], v[184:187], v[76:79]
  s_waitcnt lgkmcnt(2)
  v_mfma_f32_16x16x32_bf16 v[72:75], v[88:91], v[188:191], v[72:75]
  s_waitcnt lgkmcnt(1)
  v_mfma_f32_16x16x32_bf16 v[76:79], v[92:95], v[192:195], v[76:79]
  s_waitcnt lgkmcnt(0)
  v_mfma_f32_16x16x32_bf16 v[72:75], v[96:99], v[196:199], v[72:75]
  s_nop 7
  v_add_f32 v76, v76, v72
  v_add_f32 v77, v77, v73
  v_add_f32 v78, v78, v74
  v_add_f32 v79, v79, v75
  v_readlane_b32 s24, v84, 0
  v_readlane_b32 s25, v85, 0
  s_nop 1
  v_mul_f32 v80, s25, v12
  v_fma_f32 v80, s24, v76, -v80
  v_cvt_pk_bf16_f32 v80, v80, v80
  s_bfe_u32 s20, s12, 0x10003
  s_lshl_b32 s20, s20, 9
  s_and_b32 s21, s12, 7
  s_lshl_b32 s21, s21, 1
  s_add_u32 s20, s20, s21
  s_add_u32 s20, s20, s23
  v_add_u32 v9, s20, v8
  s_lshr_b32 s20, s12, 4
  s_cmp_eq_u32 s20, s22
  s_cbranch_scc0 L_fx_vs0
  s_mov_b64 exec, s[30:31]
  global_store_short v9, v80, s[68:69] sc1
  s_mov_b64 exec, -1
L_fx_vs0:
  v_readlane_b32 s24, v84, 1
  v_readlane_b32 s25, v85, 1
  s_nop 1
  v_mul_f32 v80, s25, v12
  v_fma_f32 v80, s24, v77, -v80
  v_cvt_pk_bf16_f32 v80, v80, v80
  s_bfe_u32 s20, s13, 0x10003
  s_lshl_b32 s20, s20, 9
  s_and_b32 s21, s13, 7
  s_lshl_b32 s21, s21, 1
  s_add_u32 s20, s20, s21
  s_add_u32 s20, s20, s23
  v_add_u32 v9, s20, v8
  s_lshr_b32 s20, s13, 4
  s_cmp_eq_u32 s20, s22
  s_cbranch_scc0 L_fx_vs1
  s_mov_b64 exec, s[30:31]
  global_store_short v9, v80, s[68:69] sc1
  s_mov_b64 exec, -1
L_fx_vs1:
L_fx_flag:
  s_mov_b64 exec, -1
  v_mov_b32 v10, v114
  s_mov_b32 s14, 2
  s_barrier
  s_branch L_S4_go
L_fx_res:
  s_lshl_b32 s20, s4, 6
  s_lshl_b32 s21, s47, 5
  s_add_u32 s20, s20, s21
  v_and_b32 v7, 31, v1
  v_add_u32 v7, s20, v7
  v_cmp_eq_u32 vcc, s13, v7
  v_cmp_eq_u32 s[24:25], s12, v7
  s_mul_i32 s20, s5, 160
  s_lshl_b32 s21, s46, 6
  s_add_u32 s20, s20, s21
  s_add_u32 s20, s20, 153600
  v_lshrrev_b32 v6, 5, v1
  v_lshl_add_u32 v6, v6, 4, s20
  v_add_u32 v7, 1280, v6
  v_cndmask_b32 v6, v6, v7, vcc
  ds_read_b128 v[72:75], v6
  ds_read_b128 v[76:79], v6 offset:32
  s_or_b64 vcc, vcc, s[24:25]
  s_waitcnt lgkmcnt(0)
  v_cndmask_b32 v12, v12, v72, vcc
  v_cndmask_b32 v13, v13, v73, vcc
  v_cndmask_b32 v14, v14, v74, vcc
  v_cndmask_b32 v15, v15, v75, vcc
  v_cndmask_b32 v16, v16, v76, vcc
  v_cndmask_b32 v17, v17, v77, vcc
  v_cndmask_b32 v18, v18, v78, vcc
  v_cndmask_b32 v19, v19, v79, vcc
  s_nop 1
L_fx_done:
  s_waitcnt lgkmcnt(0)
  s_barrier
L_S4_go:
  s_cmp_eq_u32 s10, 0
  s_cbranch_scc0 L_must_54
  global_load_dwordx2 v[240:241], v248, s[60:61] sc1
  s_waitcnt vmcnt(0)
  s_and_b64 s[24:25], s[100:101], s[34:35]
  s_cmp_eq_u64 s[24:25], s[34:35]
  s_cbranch_scc1 SK_nbp_55
  v_cmp_eq_u32 vcc, v249, v240
  v_cmp_eq_u32 s[24:25], v249, v241
  s_nop 0
  s_and_b64 s[24:25], s[24:25], vcc
  s_lshr_b64 s[26:27], s[24:25], 4
  s_and_b64 s[24:25], s[24:25], s[26:27]
  s_lshr_b64 s[26:27], s[24:25], 2
  s_and_b64 s[24:25], s[24:25], s[26:27]
  s_lshr_b64 s[26:27], s[24:25], 1
  s_and_b64 s[24:25], s[24:25], s[26:27]
  s_mov_b64 s[100:101], s[24:25]
  s_and_b64 s[24:25], s[24:25], s[34:35]
  s_cbranch_scc1 SK_nbp_55
  s_mov_b32 s20, 0
L_nbpp_55:
  global_load_dwordx2 v[240:241], v248, s[60:61] sc1
  s_waitcnt vmcnt(0)
  v_cmp_eq_u32 vcc, v249, v240
  v_cmp_eq_u32 s[24:25], v249, v241
  s_nop 0
  s_and_b64 s[24:25], s[24:25], vcc
  s_lshr_b64 s[26:27], s[24:25], 4
  s_and_b64 s[24:25], s[24:25], s[26:27]
  s_lshr_b64 s[26:27], s[24:25], 2
  s_and_b64 s[24:25], s[24:25], s[26:27]
  s_lshr_b64 s[26:27], s[24:25], 1
  s_and_b64 s[24:25], s[24:25], s[26:27]
  s_mov_b64 s[100:101], s[24:25]
  s_and_b64 s[24:25], s[24:25], s[34:35]
  s_cbranch_scc1 SK_nbp_55
  s_add_u32 s20, s20, 1
  s_cmp_lt_u32 s20, s9
  s_cbranch_scc1 L_nbpp_55
  s_mov_b32 s9, 0
  s_mov_b64 s[24:25], s[34:35]
SK_nbp_55:
  s_ff1_i32_b64 s20, s[24:25]
  s_bitset0_b64 s[34:35], s20
  s_mul_i32 s20, s20, 3584
  s_add_u32 s66, s62, s20
  s_addc_u32 s67, s63, 0
  global_load_dwordx4 v[212:215], v0, s[66:67] sc1
  global_load_dwordx2 v[216:217], v5, s[66:67] sc1
  global_load_dwordx4 v[218:221], v4, s[66:67] offset:1536 sc1
  global_load_dwordx4 v[222:225], v4, s[66:67] offset:2560 sc1
L_must_54:
L_S4_done:
  s_mov_b32 s8, 1
  s_branch L_ATT
L_FINAL:
  s_mul_i32 s21, s8, 4096
  s_add_u32 s21, s21, 655360
  v_lshrrev_b32 v60, 1, v1
  v_lshlrev_b32 v60, 7, v60
  v_and_b32 v61, 1, v1
  v_lshl_add_u32 v60, v61, 4, v60
  v_add_u32 v60, s21, v60
  global_load_dwordx4 v[64:67], v60, s[60:61] sc1
  s_cmp_ge_u32 s6, 6
  s_cbranch_scc1 L_f_kv
  s_waitcnt lgkmcnt(0)
  s_barrier
  v_mov_b32 v62, 163240
  ds_read_b64 v[62:63], v62
  v_and_b32 v6, 31, v1
  s_lshl_b32 s20, s47, 8
  s_add_u32 s20, s20, 162304
  v_lshl_add_u32 v7, v6, 3, s20
  ds_read_b64 v[8:9], v7
  v_lshlrev_b32 v130, 16, v12
  v_and_b32 v131, 0xffff0000, v12
  v_lshlrev_b32 v132, 16, v13
  v_and_b32 v133, 0xffff0000, v13
  v_lshlrev_b32 v134, 16, v14
  v_and_b32 v135, 0xffff0000, v14
  v_lshlrev_b32 v136, 16, v15
  v_and_b32 v137, 0xffff0000, v15
  v_lshlrev_b32 v138, 16, v16
  v_and_b32 v139, 0xffff0000, v16
  v_lshlrev_b32 v140, 16, v17
  v_and_b32 v141, 0xffff0000, v17
  v_lshlrev_b32 v142, 16, v18
  v_and_b32 v143, 0xffff0000, v18
  v_lshlrev_b32 v144, 16, v19
  v_and_b32 v145, 0xffff0000, v19
  s_waitcnt lgkmcnt(0)
  v_sub_f32 v150, v130, v8
  v_sub_f32 v151, v131, v8
  v_sub_f32 v152, v132, v8
  v_sub_f32 v153, v133, v8
  v_sub_f32 v154, v134, v8
  v_sub_f32 v155, v135, v8
  v_sub_f32 v156, v136, v8
  v_sub_f32 v157, v137, v8
  v_sub_f32 v158, v138, v8
  v_sub_f32 v159, v139, v8
  v_sub_f32 v160, v140, v8
  v_sub_f32 v161, v141, v8
  v_sub_f32 v162, v142, v8
  v_sub_f32 v163, v143, v8
  v_sub_f32 v164, v144, v8
  v_sub_f32 v165, v145, v8
  v_cvt_pk_bf16_f32 v150, v150, v151
  v_cvt_pk_bf16_f32 v152, v152, v153
  v_cvt_pk_bf16_f32 v154, v154, v155
  v_cvt_pk_bf16_f32 v156, v156, v157
  v_cvt_pk_bf16_f32 v158, v158, v159
  v_cvt_pk_bf16_f32 v160, v160, v161
  v_cvt_pk_bf16_f32 v162, v162, v163
  v_cvt_pk_bf16_f32 v164, v164, v165
  v_and_b32 v151, 0xffff0000, v150
  v_lshlrev_b32 v150, 16, v150
  v_and_b32 v153, 0xffff0000, v152
  v_lshlrev_b32 v152, 16, v152
  v_and_b32 v155, 0xffff0000, v154
  v_lshlrev_b32 v154, 16, v154
  v_and_b32 v157, 0xffff0000, v156
  v_lshlrev_b32 v156, 16, v156
  v_and_b32 v159, 0xffff0000, v158
  v_lshlrev_b32 v158, 16, v158
  v_and_b32 v161, 0xffff0000, v160
  v_lshlrev_b32 v160, 16, v160
  v_and_b32 v163, 0xffff0000, v162
  v_lshlrev_b32 v162, 16, v162
  v_and_b32 v165, 0xffff0000, v164
  v_lshlrev_b32 v164, 16, v164
  v_mul_f32 v150, v150, v9
  v_mul_f32 v151, v151, v9
  v_mul_f32 v152, v152, v9
  v_mul_f32 v153, v153, v9
  v_mul_f32 v154, v154, v9
  v_mul_f32 v155, v155, v9
  v_mul_f32 v156, v156, v9
  v_mul_f32 v157, v157, v9
  v_mul_f32 v158, v158, v9
  v_mul_f32 v159, v159, v9
  v_mul_f32 v160, v160, v9
  v_mul_f32 v161, v161, v9
  v_mul_f32 v162, v162, v9
  v_mul_f32 v163, v163, v9
  v_mul_f32 v164, v164, v9
  v_mul_f32 v165, v165, v9
  v_cvt_pk_bf16_f32 v150, v150, v151
  v_cvt_pk_bf16_f32 v152, v152, v153
  v_cvt_pk_bf16_f32 v154, v154, v155
  v_cvt_pk_bf16_f32 v156, v156, v157
  v_cvt_pk_bf16_f32 v158, v158, v159
  v_cvt_pk_bf16_f32 v160, v160, v161
  v_cvt_pk_bf16_f32 v162, v162, v163
  v_cvt_pk_bf16_f32 v164, v164, v165
  v_and_b32 v151, 0xffff0000, v150
  v_lshlrev_b32 v150, 16, v150
  v_and_b32 v153, 0xffff0000, v152
  v_lshlrev_b32 v152, 16, v152
  v_and_b32 v155, 0xffff0000, v154
  v_lshlrev_b32 v154, 16, v154
  v_and_b32 v157, 0xffff0000, v156
  v_lshlrev_b32 v156, 16, v156
  v_and_b32 v159, 0xffff0000, v158
  v_lshlrev_b32 v158, 16, v158
  v_and_b32 v161, 0xffff0000, v160
  v_lshlrev_b32 v160, 16, v160
  v_and_b32 v163, 0xffff0000, v162
  v_lshlrev_b32 v162, 16, v162
  v_and_b32 v165, 0xffff0000, v164
  v_lshlrev_b32 v164, 16, v164
  v_add_f32 v130, v130, v150
  v_add_f32 v131, v131, v151
  v_add_f32 v132, v132, v152
  v_add_f32 v133, v133, v153
  v_add_f32 v134, v134, v154
  v_add_f32 v135, v135, v155
  v_add_f32 v136, v136, v156
  v_add_f32 v137, v137, v157
  v_add_f32 v138, v138, v158
  v_add_f32 v139, v139, v159
  v_add_f32 v140, v140, v160
  v_add_f32 v141, v141, v161
  v_add_f32 v142, v142, v162
  v_add_f32 v143, v143, v163
  v_add_f32 v144, v144, v164
  v_add_f32 v145, v145, v165
  v_cvt_pk_bf16_f32 v12, v130, v131
  v_cvt_pk_bf16_f32 v13, v132, v133
  v_cvt_pk_bf16_f32 v14, v134, v135
  v_cvt_pk_bf16_f32 v15, v136, v137
  v_cvt_pk_bf16_f32 v16, v138, v139
  v_cvt_pk_bf16_f32 v17, v140, v141
  v_cvt_pk_bf16_f32 v18, v142, v143
  v_cvt_pk_bf16_f32 v19, v144, v145
  s_lshl_b32 s20, s4, 6
  s_lshl_b32 s21, s47, 5
  s_add_u32 s20, s20, s21
  v_and_b32 v7, 31, v1
  v_add_u32 v7, s20, v7
  v_mul_u32_u24 v8, 1280, v7
  v_lshrrev_b32 v9, 5, v1
  v_lshl_add_u32 v8, v9, 4, v8
  s_mul_i32 s20, s5, 160
  s_lshl_b32 s21, s46, 6
  s_add_u32 s20, s20, s21
  v_add_u32 v8, s20, v8
  v_cmp_ne_u32 vcc, v62, v7
  v_cmp_ne_u32 s[30:31], v63, v7
  s_nop 0
  s_and_b64 s[30:31], vcc, s[30:31]
  s_mov_b64 exec, s[30:31]
  global_store_dwordx4 v8, v[12:15], s[56:57]
  s_cmp_eq_u32 s46, 2
  s_nop 0
  s_cbranch_scc1 L_f_o0
  global_store_dwordx4 v8, v[16:19], s[56:57] offset:32
  s_nop 1
L_f_o0:
  s_mov_b64 exec, -1
  s_mov_b32 s20, 0
  s_branch PC_58
PL_56:
  global_load_dwordx4 v[64:67], v60, s[60:61] sc1
PC_58:
  s_waitcnt vmcnt(0)
  v_cmp_ne_u32 vcc, s7, v67
  s_nop 4
  s_cbranch_vccz PD_57
  s_sleep 4
  s_add_u32 s20, s20, 1
  s_cmp_lt_u32 s20, s9
  s_cbranch_scc1 PL_56
  s_mov_b32 s9, 0
PD_57:
  v_max_u32_dpp v61, v64, v64 row_ror:1 row_mask:0xf bank_mask:0xf
  s_nop 1
  v_max_u32_dpp v61, v61, v61 row_ror:2 row_mask:0xf bank_mask:0xf
  s_nop 1
  v_max_u32_dpp v61, v61, v61 row_ror:4 row_mask:0xf bank_mask:0xf
  s_nop 1
  v_max_u32_dpp v61, v61, v61 row_ror:8 row_mask:0xf bank_mask:0xf
  s_nop 0
  v_readlane_b32 s28, v61, 0
  v_readlane_b32 s24, v61, 16
  v_readlane_b32 s25, v61, 32
  v_readlane_b32 s26, v61, 48
  s_max_u32 s28, s28, s24
  s_max_u32 s25, s25, s26
  s_max_u32 s28, s28, s25
  v_cmp_eq_u32 vcc, s28, v64
  s_and_b32 s12, s28, 0x7ff
  s_ff1_i32_b64 s29, vcc
  v_cndmask_b32 v64, v64, 0, vcc
  v_readlane_b32 s96, v65, s29
  v_readlane_b32 s98, v66, s29
  v_max_u32_dpp v61, v64, v64 row_ror:1 row_mask:0xf bank_mask:0xf
  s_nop 1
  v_max_u32_dpp v61, v61, v61 row_ror:2 row_mask:0xf bank_mask:0xf
  s_nop 1
  v_max_u32_dpp v61, v61, v61 row_ror:4 row_mask:0xf bank_mask:0xf
  s_nop 1
  v_max_u32_dpp v61, v61, v61 row_ror:8 row_mask:0xf bank_mask:0xf
  s_nop 0
  v_readlane_b32 s28, v61, 0
  v_readlane_b32 s24, v61, 16
  v_readlane_b32 s25, v61, 32
  v_readlane_b32 s26, v61, 48
  s_max_u32 s28, s28, s24
  s_max_u32 s25, s25, s26
  s_max_u32 s28, s28, s25
  v_cmp_eq_u32 vcc, s28, v64
  s_and_b32 s13, s28, 0x7ff
  s_ff1_i32_b64 s29, vcc
  v_cndmask_b32 v64, v64, 0, vcc
  v_readlane_b32 s97, v65, s29
  v_readlane_b32 s99, v66, s29
  v_mov_b32 v64, s12
  v_mov_b32 v65, s13
  v_mov_b32 v66, s96
  v_mov_b32 v67, s97
  v_mov_b32 v68, s98
  v_mov_b32 v69, s99
  v_cmp_ne_u32 vcc, v64, v7
  v_cmp_ne_u32 s[24:25], v65, v7
  s_nop 0
  s_and_b64 s[24:25], vcc, s[24:25]
  s_andn2_b64 exec, s[24:25], s[30:31]
  s_nop 1
  s_cbranch_execz L_f_o1
  global_store_dwordx4 v8, v[12:15], s[56:57]
  s_cmp_eq_u32 s46, 2
  s_nop 0
  s_cbranch_scc1 L_f_o1
  global_store_dwordx4 v8, v[16:19], s[56:57] offset:32
  s_nop 1
L_f_o1:
  s_mov_b64 exec, -1
  s_branch L_f_down
L_f_kv:
  s_mov_b32 s32, -1
  s_cmp_lt_u32 s75, 40
  s_cbranch_scc1 L_f_kv2
  v_lshrrev_b32 v62, 1, v1
  s_lshr_b32 s20, s12, 6
  s_lshr_b32 s21, s13, 6
  v_cmp_eq_u32 vcc, s20, v62
  v_cmp_eq_u32 s[32:33], s21, v62
  s_nop 0
  s_or_b64 s[32:33], vcc, s[32:33]
  s_mov_b32 s20, 0
  s_nop 1
  s_branch PC_61
PL_59:
  global_load_dwordx4 v[64:67], v60, s[60:61] sc1
PC_61:
  s_waitcnt vmcnt(0)
  v_cmp_ne_u32 vcc, s7, v67
  s_nop 0
  s_andn2_b64 vcc, vcc, s[32:33]
  s_nop 2
  s_cbranch_vccz PD_60
  s_sleep 4
  s_add_u32 s20, s20, 1
  s_cmp_lt_u32 s20, s9
  s_cbranch_scc1 PL_59
  s_mov_b32 s9, 0
PD_60:
  v_cndmask_b32 v64, v64, 0, s[32:33]
  s_nop 1
  v_max_u32_dpp v61, v64, v64 row_ror:1 row_mask:0xf bank_mask:0xf
  s_nop 1
  v_max_u32_dpp v61, v61, v61 row_ror:2 row_mask:0xf bank_mask:0xf
  s_nop 1
  v_max_u32_dpp v61, v61, v61 row_ror:4 row_mask:0xf bank_mask:0xf
  s_nop 1
  v_max_u32_dpp v61, v61, v61 row_ror:8 row_mask:0xf bank_mask:0xf
  s_nop 0
  v_readlane_b32 s28, v61, 0
  v_readlane_b32 s24, v61, 16
  v_readlane_b32 s25, v61, 32
  v_readlane_b32 s26, v61, 48
  s_max_u32 s28, s28, s24
  s_max_u32 s25, s25, s26
  s_max_u32 s28, s28, s25
  v_cmp_eq_u32 vcc, s28, v64
  s_and_b32 s12, s28, 0x7ff
  s_ff1_i32_b64 s29, vcc
  v_cndmask_b32 v64, v64, 0, vcc
  v_readlane_b32 s96, v65, s29
  v_readlane_b32 s98, v66, s29
  v_max_u32_dpp v61, v64, v64 row_ror:1 row_mask:0xf bank_mask:0xf
  s_nop 1
  v_max_u32_dpp v61, v61, v61 row_ror:2 row_mask:0xf bank_mask:0xf
  s_nop 1
  v_max_u32_dpp v61, v61, v61 row_ror:4 row_mask:0xf bank_mask:0xf
  s_nop 1
  v_max_u32_dpp v61, v61, v61 row_ror:8 row_mask:0xf bank_mask:0xf
  s_nop 0
  v_readlane_b32 s28, v61, 0
  v_readlane_b32 s24, v61, 16
  v_readlane_b32 s25, v61, 32
  v_readlane_b32 s26, v61, 48
  s_max_u32 s28, s28, s24
  s_max_u32 s25, s25, s26
  s_max_u32 s28, s28, s25
  v_cmp_eq_u32 vcc, s28, v64
  s_and_b32 s13, s28, 0x7ff
  s_ff1_i32_b64 s29, vcc
  v_cndmask_b32 v64, v64, 0, vcc
  v_readlane_b32 s97, v65, s29
  v_readlane_b32 s99, v66, s29
  s_lshl_b32 s32, s13, 11
  s_or_b32 s32, s32, s12
  v_mov_b32 v86, v60
  v_mov_b32 v64, s12
  v_mov_b32 v65, s13
  v_mov_b32 v66, s96
  v_mov_b32 v67, s97
  v_mov_b32 v68, s98
  v_mov_b32 v69, s99
  v_and_b32 v6, 15, v1
  v_lshrrev_b32 v7, 4, v1
  v_cmp_eq_u32 vcc, 1, v6
  s_nop 1
  v_cndmask_b32 v60, v64, v65, vcc
  v_cndmask_b32 v70, v68, v69, vcc
  v_bfe_u32 v62, v60, 5, 1
  v_mul_u32_u24 v62, 40960, v62
  v_and_b32 v61, 31, v60
  v_lshl_add_u32 v61, v61, 4, v62
  v_lshrrev_b32 v62, 6, v60
  v_mul_u32_u24 v62, 0x54400, v62
  v_add_u32 v61, v61, v62
  v_lshrrev_b32 v62, 1, v7
  v_lshl_add_u32 v61, v62, 9, v61
  v_and_b32 v62, 1, v7
  v_lshl_add_u32 v61, v62, 3, v61
  s_sub_u32 s20, s6, 6
  s_mul_i32 s20, s20, 20480
  s_add_u32 s64, s72, s20
  s_addc_u32 s65, s73, 0
  global_load_dwordx2 v[140:141], v61, s[64:65] offset:0 sc1
  global_load_dwordx2 v[142:143], v61, s[64:65] offset:1024 sc1
  global_load_dwordx2 v[144:145], v61, s[64:65] offset:2048 sc1
  global_load_dwordx2 v[146:147], v61, s[64:65] offset:3072 sc1
  s_add_u32 s64, s64, 4096
  s_addc_u32 s65, s65, 0
  global_load_dwordx2 v[148:149], v61, s[64:65] offset:0 sc1
  global_load_dwordx2 v[150:151], v61, s[64:65] offset:1024 sc1
  global_load_dwordx2 v[152:153], v61, s[64:65] offset:2048 sc1
  global_load_dwordx2 v[154:155], v61, s[64:65] offset:3072 sc1
  s_add_u32 s64, s64, 4096
  s_addc_u32 s65, s65, 0
  global_load_dwordx2 v[156:157], v61, s[64:65] offset:0 sc1
  global_load_dwordx2 v[158:159], v61, s[64:65] offset:1024 sc1
  global_load_dwordx2 v[160:161], v61, s[64:65] offset:2048 sc1
  global_load_dwordx2 v[162:163], v61, s[64:65] offset:3072 sc1
  s_add_u32 s64, s64, 4096
  s_addc_u32 s65, s65, 0
  global_load_dwordx2 v[164:165], v61, s[64:65] offset:0 sc1
  global_load_dwordx2 v[166:167], v61, s[64:65] offset:1024 sc1
  global_load_dwordx2 v[168:169], v61, s[64:65] offset:2048 sc1
  global_load_dwordx2 v[170:171], v61, s[64:65] offset:3072 sc1
  s_add_u32 s64, s64, 4096
  s_addc_u32 s65, s65, 0
  global_load_dwordx2 v[172:173], v61, s[64:65] offset:0 sc1
  global_load_dwordx2 v[174:175], v61, s[64:65] offset:1024 sc1
  global_load_dwordx2 v[176:177], v61, s[64:65] offset:2048 sc1
  global_load_dwordx2 v[178:179], v61, s[64:65] offset:3072 sc1
  v_and_b32 v71, 0xffff0000, v70
  v_lshlrev_b32 v70, 16, v70
  s_waitcnt vmcnt(19)
  v_mfma_f32_16x16x16_bf16 v[72:75], v[20:21], v[140:141], 0
  s_waitcnt vmcnt(18)
  v_mfma_f32_16x16x16_bf16 v[76:79], v[22:23], v[142:143], 0
  s_waitcnt vmcnt(17)
  v_mfma_f32_16x16x16_bf16 v[72:75], v[24:25], v[144:145], v[72:75]
  s_waitcnt vmcnt(16)
  v_mfma_f32_16x16x16_bf16 v[76:79], v[26:27], v[146:147], v[76:79]
  s_waitcnt vmcnt(15)
  v_mfma_f32_16x16x16_bf16 v[72:75], v[28:29], v[148:149], v[72:75]
  s_waitcnt vmcnt(14)
  v_mfma_f32_16x16x16_bf16 v[76:79], v[30:31], v[150:151], v[76:79]
  s_waitcnt vmcnt(13)
  v_mfma_f32_16x16x16_bf16 v[72:75], v[32:33], v[152:153], v[72:75]
  s_waitcnt vmcnt(12)
  v_mfma_f32_16x16x16_bf16 v[76:79], v[34:35], v[154:155], v[76:79]
  s_waitcnt vmcnt(11)
  v_mfma_f32_16x16x16_bf16 v[72:75], v[36:37], v[156:157], v[72:75]
  s_waitcnt vmcnt(10)
  v_mfma_f32_16x16x16_bf16 v[76:79], v[38:39], v[158:159], v[76:79]
  s_waitcnt vmcnt(9)
  v_mfma_f32_16x16x16_bf16 v[72:75], v[40:41], v[160:161], v[72:75]
  s_waitcnt vmcnt(8)
  v_mfma_f32_16x16x16_bf16 v[76:79], v[42:43], v[162:163], v[76:79]
  s_waitcnt vmcnt(7)
  v_mfma_f32_16x16x16_bf16 v[72:75], v[44:45], v[164:165], v[72:75]
  s_waitcnt vmcnt(6)
  v_mfma_f32_16x16x16_bf16 v[76:79], v[46:47], v[166:167], v[76:79]
  s_waitcnt vmcnt(5)
  v_mfma_f32_16x16x16_bf16 v[72:75], v[48:49], v[168:169], v[72:75]
  s_waitcnt vmcnt(4)
  v_mfma_f32_16x16x16_bf16 v[76:79], v[50:51], v[170:171], v[76:79]
  s_waitcnt vmcnt(3)
  v_mfma_f32_16x16x16_bf16 v[72:75], v[52:53], v[172:173], v[72:75]
  s_waitcnt vmcnt(2)
  v_mfma_f32_16x16x16_bf16 v[76:79], v[54:55], v[174:175], v[76:79]
  s_waitcnt vmcnt(1)
  v_mfma_f32_16x16x16_bf16 v[72:75], v[56:57], v[176:177], v[72:75]
  s_waitcnt vmcnt(0)
  v_mfma_f32_16x16x16_bf16 v[76:79], v[58:59], v[178:179], v[76:79]
  v_add_u32 v62, 79872, v0
  s_nop 6
  v_add_f32 v72, v72, v76
  v_add_f32 v73, v73, v77
  v_add_f32 v74, v74, v78
  v_add_f32 v75, v75, v79
  v_fma_f32 v72, -v70, v16, v72
  v_fma_f32 v73, -v70, v17, v73
  v_fma_f32 v74, -v70, v18, v74
  v_fma_f32 v75, -v70, v19, v75
  v_mov_b32 v80, 163220
  s_add_u32 s23, s7, s8
  s_cmp_eq_u32 s6, 7
  s_cbranch_scc0 L_gu_w_62
  s_cmp_lt_u32 s75, 40
  s_cbranch_scc1 L_gu_w_62
  ds_write_b128 v62, v[72:75]
  v_mov_b32 v81, s23
  s_waitcnt lgkmcnt(0)
  ds_write_b32 v80, v81
L_gu_w_62:
  v_mov_b32 v60, v86
  global_load_dwordx4 v[64:67], v60, s[60:61] sc1
  s_cmp_eq_u32 s6, 6
  s_cbranch_scc0 L_gu_e_63
  s_cmp_lt_u32 s74, 216
  s_cbranch_scc0 L_gu_e_63
  v_rcp_f32 v71, v71
  s_mov_b32 s22, 0
  s_nop 0
L_gu_s_64:
  ds_read_b32 v81, v80
  s_add_u32 s22, s22, 1
  s_waitcnt lgkmcnt(0)
  v_cmp_ne_u32 vcc, s23, v81
  s_cmp_lt_u32 s22, s9
  s_cselect_b64 s[24:25], -1, 0
  s_and_b64 vcc, vcc, s[24:25]
  s_nop 1
  s_cbranch_vccnz L_gu_s_64
  ds_read_b128 v[76:79], v62
  s_mul_i32 s21, s8, 16384
  s_add_u32 s21, s21, 671744
  s_lshl_b32 s20, s74, 6
  s_add_u32 s20, s20, s21
  v_lshlrev_b32 v62, 5, v6
  v_lshl_add_u32 v62, v7, 4, v62
  v_add_u32 v62, s20, v62
  s_waitcnt lgkmcnt(0)
  v_add_f32 v72, v72, v76
  v_add_f32 v73, v73, v77
  v_add_f32 v74, v74, v78
  v_add_f32 v75, v75, v79
  v_mul_f32 v72, v72, v71
  v_mul_f32 v73, v73, v71
  v_mul_f32 v74, v74, v71
  v_mul_f32 v75, v75, v71
  v_cvt_pk_bf16_f32 v72, v72, v72
  v_cvt_pk_bf16_f32 v73, v73, v73
  v_cvt_pk_bf16_f32 v74, v74, v74
  v_cvt_pk_bf16_f32 v75, v75, v75
  v_lshlrev_b32 v72, 16, v72
  v_lshlrev_b32 v73, 16, v73
  v_lshlrev_b32 v74, 16, v74
  v_lshlrev_b32 v75, 16, v75
  v_mov_b32 v76, v72
  v_mov_b32 v77, v73
  v_mov_b32 v78, v74
  v_mov_b32 v79, v75
  v_mul_f32 v80, 0xbfb8aa3b, v72
  v_mul_f32 v81, 0xbfb8aa3b, v73
  v_mul_f32 v82, 0xbfb8aa3b, v74
  v_mul_f32 v83, 0xbfb8aa3b, v75
  v_exp_f32 v80, v80
  v_exp_f32 v81, v81
  v_exp_f32 v82, v82
  v_exp_f32 v83, v83
  v_permlane32_swap_b32 v72, v76
  v_permlane32_swap_b32 v73, v77
  v_permlane32_swap_b32 v74, v78
  v_permlane32_swap_b32 v75, v79
  v_add_f32 v80, 1.0, v80
  v_add_f32 v81, 1.0, v81
  v_add_f32 v82, 1.0, v82
  v_add_f32 v83, 1.0, v83
  v_rcp_f32 v80, v80
  v_rcp_f32 v81, v81
  v_rcp_f32 v82, v82
  v_rcp_f32 v83, v83
  v_mul_f32 v72, v72, v80
  v_mul_f32 v73, v73, v81
  v_mul_f32 v74, v74, v82
  v_mul_f32 v75, v75, v83
  v_cvt_pk_bf16_f32 v72, v72, v72
  v_cvt_pk_bf16_f32 v73, v73, v73
  v_cvt_pk_bf16_f32 v74, v74, v74
  v_cvt_pk_bf16_f32 v75, v75, v75
  v_lshlrev_b32 v72, 16, v72
  v_lshlrev_b32 v73, 16, v73
  v_lshlrev_b32 v74, 16, v74
  v_lshlrev_b32 v75, 16, v75
  v_mul_f32 v72, v72, v76
  v_mul_f32 v73, v73, v77
  v_mul_f32 v74, v74, v78
  v_mul_f32 v75, v75, v79
  v_cvt_pk_bf16_f32 v72, v72, v73
  v_cvt_pk_bf16_f32 v73, v74, v75
  v_mov_b32 v74, s7
  v_mov_b32 v75, s32
  s_mov_b64 exec, 0x30003
  global_store_dwordx4 v62, v[72:75], s[60:61] sc1
  s_mov_b64 exec, -1
  s_nop 0
L_gu_e_63:
L_f_kv2:
  s_barrier
  s_mov_b32 s20, 0
  s_branch PC_67
PL_65:
  global_load_dwordx4 v[64:67], v60, s[60:61] sc1
PC_67:
  s_waitcnt vmcnt(0)
  v_cmp_ne_u32 vcc, s7, v67
  s_nop 4
  s_cbranch_vccz PD_66
  s_sleep 4
  s_add_u32 s20, s20, 1
  s_cmp_lt_u32 s20, s9
  s_cbranch_scc1 PL_65
  s_mov_b32 s9, 0
PD_66:
  v_max_u32_dpp v61, v64, v64 row_ror:1 row_mask:0xf bank_mask:0xf
  s_nop 1
  v_max_u32_dpp v61, v61, v61 row_ror:2 row_mask:0xf bank_mask:0xf
  s_nop 1
  v_max_u32_dpp v61, v61, v61 row_ror:4 row_mask:0xf bank_mask:0xf
  s_nop 1
  v_max_u32_dpp v61, v61, v61 row_ror:8 row_mask:0xf bank_mask:0xf
  s_nop 0
  v_readlane_b32 s28, v61, 0
  v_readlane_b32 s24, v61, 16
  v_readlane_b32 s25, v61, 32
  v_readlane_b32 s26, v61, 48
  s_max_u32 s28, s28, s24
  s_max_u32 s25, s25, s26
  s_max_u32 s28, s28, s25
  v_cmp_eq_u32 vcc, s28, v64
  s_and_b32 s12, s28, 0x7ff
  s_ff1_i32_b64 s29, vcc
  v_cndmask_b32 v64, v64, 0, vcc
  v_readlane_b32 s96, v65, s29
  v_readlane_b32 s98, v66, s29
  v_max_u32_dpp v61, v64, v64 row_ror:1 row_mask:0xf bank_mask:0xf
  s_nop 1
  v_max_u32_dpp v61, v61, v61 row_ror:2 row_mask:0xf bank_mask:0xf
  s_nop 1
  v_max_u32_dpp v61, v61, v61 row_ror:4 row_mask:0xf bank_mask:0xf
  s_nop 1
  v_max_u32_dpp v61, v61, v61 row_ror:8 row_mask:0xf bank_mask:0xf
  s_nop 0
  v_readlane_b32 s28, v61, 0
  v_readlane_b32 s24, v61, 16
  v_readlane_b32 s25, v61, 32
  v_readlane_b32 s26, v61, 48
  s_max_u32 s28, s28, s24
  s_max_u32 s25, s25, s26
  s_max_u32 s28, s28, s25
  v_cmp_eq_u32 vcc, s28, v64
  s_and_b32 s13, s28, 0x7ff
  s_ff1_i32_b64 s29, vcc
  v_cndmask_b32 v64, v64, 0, vcc
  v_readlane_b32 s97, v65, s29
  v_readlane_b32 s99, v66, s29
  s_lshl_b32 s33, s13, 11
  s_or_b32 s33, s33, s12
  s_cmp_eq_u32 s32, s33
  s_nop 1
  s_cbranch_scc1 L_f_down
  s_cmp_lt_u32 s75, 40
  s_cbranch_scc1 L_f_down
  v_mov_b32 v64, s12
  v_mov_b32 v65, s13
  v_mov_b32 v66, s96
  v_mov_b32 v67, s97
  v_mov_b32 v68, s98
  v_mov_b32 v69, s99
  v_and_b32 v6, 15, v1
  v_lshrrev_b32 v7, 4, v1
  v_cmp_eq_u32 vcc, 1, v6
  s_nop 1
  v_cndmask_b32 v60, v64, v65, vcc
  v_cndmask_b32 v70, v68, v69, vcc
  v_bfe_u32 v62, v60, 5, 1
  v_mul_u32_u24 v62, 40960, v62
  v_and_b32 v61, 31, v60
  v_lshl_add_u32 v61, v61, 4, v62
  v_lshrrev_b32 v62, 6, v60
  v_mul_u32_u24 v62, 0x54400, v62
  v_add_u32 v61, v61, v62
  v_lshrrev_b32 v62, 1, v7
  v_lshl_add_u32 v61, v62, 9, v61
  v_and_b32 v62, 1, v7
  v_lshl_add_u32 v61, v62, 3, v61
  s_sub_u32 s20, s6, 6
  s_mul_i32 s20, s20, 20480
  s_add_u32 s64, s72, s20
  s_addc_u32 s65, s73, 0
  global_load_dwordx2 v[140:141], v61, s[64:65] offset:0 sc1
  global_load_dwordx2 v[142:143], v61, s[64:65] offset:1024 sc1
  global_load_dwordx2 v[144:145], v61, s[64:65] offset:2048 sc1
  global_load_dwordx2 v[146:147], v61, s[64:65] offset:3072 sc1
  s_add_u32 s64, s64, 4096
  s_addc_u32 s65, s65, 0
  global_load_dwordx2 v[148:149], v61, s[64:65] offset:0 sc1
  global_load_dwordx2 v[150:151], v61, s[64:65] offset:1024 sc1
  global_load_dwordx2 v[152:153], v61, s[64:65] offset:2048 sc1
  global_load_dwordx2 v[154:155], v61, s[64:65] offset:3072 sc1
  s_add_u32 s64, s64, 4096
  s_addc_u32 s65, s65, 0
  global_load_dwordx2 v[156:157], v61, s[64:65] offset:0 sc1
  global_load_dwordx2 v[158:159], v61, s[64:65] offset:1024 sc1
  global_load_dwordx2 v[160:161], v61, s[64:65] offset:2048 sc1
  global_load_dwordx2 v[162:163], v61, s[64:65] offset:3072 sc1
  s_add_u32 s64, s64, 4096
  s_addc_u32 s65, s65, 0
  global_load_dwordx2 v[164:165], v61, s[64:65] offset:0 sc1
  global_load_dwordx2 v[166:167], v61, s[64:65] offset:1024 sc1
  global_load_dwordx2 v[168:169], v61, s[64:65] offset:2048 sc1
  global_load_dwordx2 v[170:171], v61, s[64:65] offset:3072 sc1
  s_add_u32 s64, s64, 4096
  s_addc_u32 s65, s65, 0
  global_load_dwordx2 v[172:173], v61, s[64:65] offset:0 sc1
  global_load_dwordx2 v[174:175], v61, s[64:65] offset:1024 sc1
  global_load_dwordx2 v[176:177], v61, s[64:65] offset:2048 sc1
  global_load_dwordx2 v[178:179], v61, s[64:65] offset:3072 sc1
  v_and_b32 v71, 0xffff0000, v70
  v_lshlrev_b32 v70, 16, v70
  s_waitcnt vmcnt(19)
  v_mfma_f32_16x16x16_bf16 v[72:75], v[20:21], v[140:141], 0
  s_waitcnt vmcnt(18)
  v_mfma_f32_16x16x16_bf16 v[76:79], v[22:23], v[142:143], 0
  s_waitcnt vmcnt(17)
  v_mfma_f32_16x16x16_bf16 v[72:75], v[24:25], v[144:145], v[72:75]
  s_waitcnt vmcnt(16)
  v_mfma_f32_16x16x16_bf16 v[76:79], v[26:27], v[146:147], v[76:79]
  s_waitcnt vmcnt(15)
  v_mfma_f32_16x16x16_bf16 v[72:75], v[28:29], v[148:149], v[72:75]
  s_waitcnt vmcnt(14)
  v_mfma_f32_16x16x16_bf16 v[76:79], v[30:31], v[150:151], v[76:79]
  s_waitcnt vmcnt(13)
  v_mfma_f32_16x16x16_bf16 v[72:75], v[32:33], v[152:153], v[72:75]
  s_waitcnt vmcnt(12)
  v_mfma_f32_16x16x16_bf16 v[76:79], v[34:35], v[154:155], v[76:79]
  s_waitcnt vmcnt(11)
  v_mfma_f32_16x16x16_bf16 v[72:75], v[36:37], v[156:157], v[72:75]
  s_waitcnt vmcnt(10)
  v_mfma_f32_16x16x16_bf16 v[76:79], v[38:39], v[158:159], v[76:79]
  s_waitcnt vmcnt(9)
  v_mfma_f32_16x16x16_bf16 v[72:75], v[40:41], v[160:161], v[72:75]
  s_waitcnt vmcnt(8)
  v_mfma_f32_16x16x16_bf16 v[76:79], v[42:43], v[162:163], v[76:79]
  s_waitcnt vmcnt(7)
  v_mfma_f32_16x16x16_bf16 v[72:75], v[44:45], v[164:165], v[72:75]
  s_waitcnt vmcnt(6)
  v_mfma_f32_16x16x16_bf16 v[76:79], v[46:47], v[166:167], v[76:79]
  s_waitcnt vmcnt(5)
  v_mfma_f32_16x16x16_bf16 v[72:75], v[48:49], v[168:169], v[72:75]
  s_waitcnt vmcnt(4)
  v_mfma_f32_16x16x16_bf16 v[76:79], v[50:51], v[170:171], v[76:79]
  s_waitcnt vmcnt(3)
  v_mfma_f32_16x16x16_bf16 v[72:75], v[52:53], v[172:173], v[72:75]
  s_waitcnt vmcnt(2)
  v_mfma_f32_16x16x16_bf16 v[76:79], v[54:55], v[174:175], v[76:79]
  s_waitcnt vmcnt(1)
  v_mfma_f32_16x16x16_bf16 v[72:75], v[56:57], v[176:177], v[72:75]
  s_waitcnt vmcnt(0)
  v_mfma_f32_16x16x16_bf16 v[76:79], v[58:59], v[178:179], v[76:79]
  v_add_u32 v62, 160768, v0
  s_nop 6
  v_add_f32 v72, v72, v76
  v_add_f32 v73, v73, v77
  v_add_f32 v74, v74, v78
  v_add_f32 v75, v75, v79
  v_fma_f32 v72, -v70, v16, v72
  v_fma_f32 v73, -v70, v17, v73
  v_fma_f32 v74, -v70, v18, v74
  v_fma_f32 v75, -v70, v19, v75
  v_mov_b32 v80, 163216
  s_add_u32 s23, s7, s8
  s_cmp_eq_u32 s6, 7
  s_cbranch_scc0 L_gu_w_68
  s_cmp_lt_u32 s75, 40
  s_cbranch_scc1 L_gu_w_68
  ds_write_b128 v62, v[72:75]
  v_mov_b32 v81, s23
  s_waitcnt lgkmcnt(0)
  ds_write_b32 v80, v81
L_gu_w_68:
  s_cmp_eq_u32 s6, 6
  s_cbranch_scc0 L_gu_e_69
  s_cmp_lt_u32 s74, 216
  s_cbranch_scc0 L_gu_e_69
  v_rcp_f32 v71, v71
  s_mov_b32 s22, 0
  s_nop 0
L_gu_s_70:
  ds_read_b32 v81, v80
  s_add_u32 s22, s22, 1
  s_waitcnt lgkmcnt(0)
  v_cmp_ne_u32 vcc, s23, v81
  s_cmp_lt_u32 s22, s9
  s_cselect_b64 s[24:25], -1, 0
  s_and_b64 vcc, vcc, s[24:25]
  s_nop 1
  s_cbranch_vccnz L_gu_s_70
  ds_read_b128 v[76:79], v62
  s_mul_i32 s21, s8, 16384
  s_add_u32 s21, s21, 671744
  s_lshl_b32 s20, s74, 6
  s_add_u32 s20, s20, s21
  v_lshlrev_b32 v62, 5, v6
  v_lshl_add_u32 v62, v7, 4, v62
  v_add_u32 v62, s20, v62
  s_waitcnt lgkmcnt(0)
  v_add_f32 v72, v72, v76
  v_add_f32 v73, v73, v77
  v_add_f32 v74, v74, v78
  v_add_f32 v75, v75, v79
  v_mul_f32 v72, v72, v71
  v_mul_f32 v73, v73, v71
  v_mul_f32 v74, v74, v71
  v_mul_f32 v75, v75, v71
  v_cvt_pk_bf16_f32 v72, v72, v72
  v_cvt_pk_bf16_f32 v73, v73, v73
  v_cvt_pk_bf16_f32 v74, v74, v74
  v_cvt_pk_bf16_f32 v75, v75, v75
  v_lshlrev_b32 v72, 16, v72
  v_lshlrev_b32 v73, 16, v73
  v_lshlrev_b32 v74, 16, v74
  v_lshlrev_b32 v75, 16, v75
  v_mov_b32 v76, v72
  v_mov_b32 v77, v73
  v_mov_b32 v78, v74
  v_mov_b32 v79, v75
  v_mul_f32 v80, 0xbfb8aa3b, v72
  v_mul_f32 v81, 0xbfb8aa3b, v73
  v_mul_f32 v82, 0xbfb8aa3b, v74
  v_mul_f32 v83, 0xbfb8aa3b, v75
  v_exp_f32 v80, v80
  v_exp_f32 v81, v81
  v_exp_f32 v82, v82
  v_exp_f32 v83, v83
  v_permlane32_swap_b32 v72, v76
  v_permlane32_swap_b32 v73, v77
  v_permlane32_swap_b32 v74, v78
  v_permlane32_swap_b32 v75, v79
  v_add_f32 v80, 1.0, v80
  v_add_f32 v81, 1.0, v81
  v_add_f32 v82, 1.0, v82
  v_add_f32 v83, 1.0, v83
  v_rcp_f32 v80, v80
  v_rcp_f32 v81, v81
  v_rcp_f32 v82, v82
  v_rcp_f32 v83, v83
  v_mul_f32 v72, v72, v80
  v_mul_f32 v73, v73, v81
  v_mul_f32 v74, v74, v82
  v_mul_f32 v75, v75, v83
  v_cvt_pk_bf16_f32 v72, v72, v72
  v_cvt_pk_bf16_f32 v73, v73, v73
  v_cvt_pk_bf16_f32 v74, v74, v74
  v_cvt_pk_bf16_f32 v75, v75, v75
  v_lshlrev_b32 v72, 16, v72
  v_lshlrev_b32 v73, 16, v73
  v_lshlrev_b32 v74, 16, v74
  v_lshlrev_b32 v75, 16, v75
  v_mul_f32 v72, v72, v76
  v_mul_f32 v73, v73, v77
  v_mul_f32 v74, v74, v78
  v_mul_f32 v75, v75, v79
  v_cvt_pk_bf16_f32 v72, v72, v73
  v_cvt_pk_bf16_f32 v73, v74, v75
  v_mov_b32 v74, s7
  v_mov_b32 v75, s33
  s_mov_b64 exec, 0x30003
  global_store_dwordx4 v62, v[72:75], s[60:61] sc1
  s_mov_b64 exec, -1
  s_nop 0
L_gu_e_69:
L_f_down:
  s_cmp_lt_u32 s75, 40
  s_cbranch_scc0 L_dn_skipf
  s_cmp_ge_u32 s6, 6
  s_cbranch_scc1 L_dn_bf
  s_mul_i32 s21, s8, 16384
  s_add_u32 s21, s21, 671744
  s_add_u32 s64, s60, s21
  s_addc_u32 s65, s61, 0
  s_min_u32 s20, s6, 5
  s_mul_i32 s20, s20, 144
  v_add_u32 v6, s20, v1
  v_add_u32 v7, 64, v6
  v_min_u32 v86, 15, v1
  s_add_u32 s20, s20, 128
  v_add_u32 v86, s20, v86
  v_lshlrev_b32 v8, 4, v6
  v_lshlrev_b32 v9, 4, v86
  global_load_dwordx4 v[72:75], v8, s[64:65] sc1
  global_load_dwordx4 v[76:79], v8, s[64:65] offset:1024 sc1
  global_load_dwordx4 v[100:103], v9, s[64:65] sc1
  v_mov_b32 v64, s12
  v_mov_b32 v65, s13
  v_mov_b32 v66, s96
  v_mov_b32 v67, s97
  v_mov_b32 v68, s98
  v_mov_b32 v69, s99
  v_and_b32 v60, 15, v1
  v_lshrrev_b32 v61, 4, v1
  v_cmp_eq_u32 vcc, 1, v60
  s_nop 1
  v_cndmask_b32 v62, v64, v65, vcc
  v_cndmask_b32 v66, v66, v67, vcc
  v_cndmask_b32 v68, v68, v69, vcc
  v_bfe_u32 v70, v62, 5, 1
  v_mul_u32_u24 v70, 40960, v70
  v_and_b32 v63, 31, v62
  v_lshl_add_u32 v63, v63, 4, v70
  v_lshrrev_b32 v70, 6, v62
  v_mul_u32_u24 v70, 0x54400, v70
  v_add_u32 v63, v63, v70
  s_mov_b32 s22, s75
  s_lshl_b32 s20, s22, 10
  v_and_b32 v70, 1, v61
  v_lshl_add_u32 v63, v70, 3, v63
  v_lshrrev_b32 v70, 1, v61
  v_lshl_add_u32 v63, v70, 9, v63
  v_add_u32 v63, s20, v63
  global_load_dwordx2 v[70:71], v63, s[72:73] sc1
  v_lshrrev_b32 v80, 2, v6
  v_lshlrev_b32 v80, 4, v80
  v_and_b32 v81, 1, v6
  v_lshl_add_u32 v80, v81, 3, v80
  v_bfe_u32 v81, v6, 1, 1
  v_mul_u32_u24 v81, 3456, v81
  v_add_u32 v80, v80, v81
  v_add_u32 v10, 153600, v80
  v_lshrrev_b32 v80, 2, v7
  v_lshlrev_b32 v80, 4, v80
  v_and_b32 v81, 1, v7
  v_lshl_add_u32 v80, v81, 3, v80
  v_bfe_u32 v81, v7, 1, 1
  v_mul_u32_u24 v81, 3456, v81
  v_add_u32 v80, v80, v81
  v_add_u32 v11, 153600, v80
  v_lshrrev_b32 v80, 2, v86
  v_lshlrev_b32 v80, 4, v80
  v_and_b32 v81, 1, v86
  v_lshl_add_u32 v80, v81, 3, v80
  v_bfe_u32 v81, v86, 1, 1
  v_mul_u32_u24 v81, 3456, v81
  v_add_u32 v80, v80, v81
  v_add_u32 v87, 153600, v80
  v_and_b32 v82, 1, v60
  v_mul_u32_u24 v82, 3456, v82
  v_lshl_add_u32 v82, v61, 4, v82
  s_mul_i32 s20, s6, 576
  s_add_u32 s20, s20, 153600
  v_add_u32 v82, s20, v82
  v_lshlrev_b32 v83, 6, v60
  v_lshl_add_u32 v83, v61, 4, v83
  v_add_u32 v84, 160768, v83
  s_lshl_b32 s20, s6, 7
  v_add_u32 v85, s20, v84
  v_cvt_pk_bf16_f32 v66, v66, v66
  v_lshlrev_b32 v66, 16, v66
  v_mul_f32 v66, 0xbfb8aa3b, v66
  v_exp_f32 v66, v66
  s_nop 0
  v_add_f32 v66, 1.0, v66
  v_rcp_f32 v66, v66
  s_nop 0
  v_cvt_pk_bf16_f32 v66, v66, v66
  v_lshlrev_b32 v66, 16, v66
  v_and_b32 v69, 0xffff0000, v68
  v_lshlrev_b32 v68, 16, v68
  v_rcp_f32 v69, v69
  s_lshl_b32 s33, s13, 11
  s_or_b32 s33, s33, s12
  s_mov_b32 s20, 0
  s_branch PC_73
PL_71:
  global_load_dwordx4 v[72:75], v8, s[64:65] sc1
  global_load_dwordx4 v[76:79], v8, s[64:65] offset:1024 sc1
  global_load_dwordx4 v[100:103], v9, s[64:65] sc1
PC_73:
  s_waitcnt vmcnt(0)
  v_cmp_ne_u32 vcc, s7, v74
  v_cmp_ne_u32 s[24:25], s7, v78
  s_nop 0
  s_or_b64 vcc, vcc, s[24:25]
  v_cmp_ne_u32 s[24:25], s7, v102
  s_nop 0
  s_or_b64 vcc, vcc, s[24:25]
  v_cmp_ne_u32 s[24:25], s33, v75
  s_nop 0
  s_or_b64 vcc, vcc, s[24:25]
  v_cmp_ne_u32 s[24:25], s33, v79
  s_nop 0
  s_or_b64 vcc, vcc, s[24:25]
  v_cmp_ne_u32 s[24:25], s33, v103
  s_nop 0
  s_or_b64 vcc, vcc, s[24:25]
  s_nop 2
  s_cbranch_vccz PD_72
  s_add_u32 s20, s20, 1
  s_cmp_lt_u32 s20, s9
  s_cbranch_scc1 PL_71
  s_mov_b32 s9, 0
PD_72:
  ds_write_b64 v10, v[72:73]
  ds_write_b64 v11, v[76:77]
  ds_write_b64 v87, v[100:101]
  v_lshlrev_b32 v90, 16, v70
  v_and_b32 v91, 0xffff0000, v70
  v_lshlrev_b32 v92, 16, v71
  v_and_b32 v93, 0xffff0000, v71
  v_sub_f32 v94, v90, v68
  v_sub_f32 v95, v91, v68
  v_sub_f32 v96, v92, v68
  v_sub_f32 v97, v93, v68
  v_cvt_pk_bf16_f32 v94, v94, v94
  v_lshlrev_b32 v94, 16, v94
  v_cvt_pk_bf16_f32 v95, v95, v95
  v_lshlrev_b32 v95, 16, v95
  v_cvt_pk_bf16_f32 v96, v96, v96
  v_lshlrev_b32 v96, 16, v96
  v_cvt_pk_bf16_f32 v97, v97, v97
  v_lshlrev_b32 v97, 16, v97
  v_mul_f32 v94, v94, v69
  v_mul_f32 v95, v95, v69
  v_mul_f32 v96, v96, v69
  v_mul_f32 v97, v97, v69
  v_cvt_pk_bf16_f32 v94, v94, v94
  v_lshlrev_b32 v94, 16, v94
  v_cvt_pk_bf16_f32 v95, v95, v95
  v_lshlrev_b32 v95, 16, v95
  v_cvt_pk_bf16_f32 v96, v96, v96
  v_lshlrev_b32 v96, 16, v96
  v_cvt_pk_bf16_f32 v97, v97, v97
  v_lshlrev_b32 v97, 16, v97
  s_waitcnt lgkmcnt(0)
  ds_read_b128 v[140:143], v82 offset:0
  ds_read_b128 v[144:147], v82 offset:64
  ds_read_b128 v[148:151], v82 offset:128
  ds_read_b128 v[152:155], v82 offset:192
  ds_read_b128 v[156:159], v82 offset:256
  ds_read_b128 v[160:163], v82 offset:320
  ds_read_b128 v[164:167], v82 offset:384
  ds_read_b128 v[168:171], v82 offset:448
  ds_read_b128 v[172:175], v82 offset:512
  s_waitcnt lgkmcnt(8)
  v_mfma_f32_16x16x32_bf16 v[72:75], v[20:23], v[140:143], 0
  s_waitcnt lgkmcnt(7)
  v_mfma_f32_16x16x32_bf16 v[72:75], v[24:27], v[144:147], v[72:75]
  s_waitcnt lgkmcnt(6)
  v_mfma_f32_16x16x32_bf16 v[72:75], v[28:31], v[148:151], v[72:75]
  s_waitcnt lgkmcnt(5)
  v_mfma_f32_16x16x32_bf16 v[72:75], v[32:35], v[152:155], v[72:75]
  s_waitcnt lgkmcnt(4)
  v_mfma_f32_16x16x32_bf16 v[72:75], v[36:39], v[156:159], v[72:75]
  s_waitcnt lgkmcnt(3)
  v_mfma_f32_16x16x32_bf16 v[72:75], v[40:43], v[160:163], v[72:75]
  s_waitcnt lgkmcnt(2)
  v_mfma_f32_16x16x32_bf16 v[72:75], v[44:47], v[164:167], v[72:75]
  s_waitcnt lgkmcnt(1)
  v_mfma_f32_16x16x32_bf16 v[72:75], v[48:51], v[168:171], v[72:75]
  s_waitcnt lgkmcnt(0)
  v_mfma_f32_16x16x32_bf16 v[72:75], v[52:55], v[172:175], v[72:75]
  s_mov_b32 exec_lo, 0x30003
  s_mov_b32 exec_hi, 0x30003
  s_nop 5
  ds_write_b128 v85, v[72:75]
  s_mov_b64 exec, -1
  s_waitcnt lgkmcnt(0)
L_dn_bf:
  s_barrier
  s_cmp_eq_u32 s6, 0
  s_cbranch_scc0 L_dn_skipf
  s_mov_b32 exec_lo, 0x30003
  s_mov_b32 exec_hi, 0x30003
  ds_read_b128 v[140:143], v84 offset:0
  ds_read_b128 v[144:147], v84 offset:128
  ds_read_b128 v[148:151], v84 offset:256
  ds_read_b128 v[152:155], v84 offset:384
  ds_read_b128 v[156:159], v84 offset:512
  ds_read_b128 v[160:163], v84 offset:640
  v_mul_u32_u24 v8, 1280, v62
  v_lshl_add_u32 v8, v61, 3, v8
  s_lshl_b32 s20, s22, 5
  v_add_u32 v8, s20, v8
  s_waitcnt lgkmcnt(0)
  v_add_f32 v140, v140, v144
  v_add_f32 v141, v141, v145
  v_add_f32 v142, v142, v146
  v_add_f32 v143, v143, v147
  v_add_f32 v148, v148, v152
  v_add_f32 v149, v149, v153
  v_add_f32 v150, v150, v154
  v_add_f32 v151, v151, v155
  v_add_f32 v156, v156, v160
  v_add_f32 v157, v157, v161
  v_add_f32 v158, v158, v162
  v_add_f32 v159, v159, v163
  v_add_f32 v140, v140, v148
  v_add_f32 v141, v141, v149
  v_add_f32 v142, v142, v150
  v_add_f32 v143, v143, v151
  v_add_f32 v140, v140, v156
  v_add_f32 v141, v141, v157
  v_add_f32 v142, v142, v158
  v_add_f32 v143, v143, v159
  v_cvt_pk_bf16_f32 v140, v140, v140
  v_lshlrev_b32 v140, 16, v140
  v_cvt_pk_bf16_f32 v141, v141, v141
  v_lshlrev_b32 v141, 16, v141
  v_cvt_pk_bf16_f32 v142, v142, v142
  v_lshlrev_b32 v142, 16, v142
  v_cvt_pk_bf16_f32 v143, v143, v143
  v_lshlrev_b32 v143, 16, v143
  v_mul_f32 v140, v140, v66
  v_mul_f32 v141, v141, v66
  v_mul_f32 v142, v142, v66
  v_mul_f32 v143, v143, v66
  v_cvt_pk_bf16_f32 v140, v140, v140
  v_lshlrev_b32 v140, 16, v140
  v_cvt_pk_bf16_f32 v141, v141, v141
  v_lshlrev_b32 v141, 16, v141
  v_cvt_pk_bf16_f32 v142, v142, v142
  v_lshlrev_b32 v142, 16, v142
  v_cvt_pk_bf16_f32 v143, v143, v143
  v_lshlrev_b32 v143, 16, v143
  v_add_f32 v140, v140, v94
  v_add_f32 v141, v141, v95
  v_add_f32 v142, v142, v96
  v_add_f32 v143, v143, v97
  v_cvt_pk_bf16_f32 v140, v140, v140
  v_lshlrev_b32 v140, 16, v140
  v_cvt_pk_bf16_f32 v141, v141, v141
  v_lshlrev_b32 v141, 16, v141
  v_cvt_pk_bf16_f32 v142, v142, v142
  v_lshlrev_b32 v142, 16, v142
  v_cvt_pk_bf16_f32 v143, v143, v143
  v_lshlrev_b32 v143, 16, v143
  v_add_f32 v140, v140, v90
  v_add_f32 v141, v141, v91
  v_add_f32 v142, v142, v92
  v_add_f32 v143, v143, v93
  v_cvt_pk_bf16_f32 v72, v140, v141
  v_cvt_pk_bf16_f32 v73, v142, v143
  global_store_dwordx2 v8, v[72:73], s[56:57]
  s_mov_b64 exec, -1
L_dn_skipf:
L_END:
L_EXIT:
  s_endpgm
L_FALLBACK:
  s_mov_b32 s11, 1
  s_waitcnt vmcnt(0) lgkmcnt(0)
  s_barrier
  v_mov_b32 v84, 0xff800000
  v_mov_b32 v85, 0xff800000
  v_mov_b32 v86, 0xff800000
  v_mov_b32 v87, 0xff800000
  s_mov_b32 s66, s62
  s_mov_b32 s67, s63
  s_mov_b32 s22, 16
L_fb_loop:
  global_load_dwordx4 v[212:215], v0, s[66:67] sc1
  global_load_dwordx2 v[216:217], v2, s[66:67] sc1
  s_waitcnt vmcnt(0)
  v_mfma_f32_32x32x16_bf16 v[148:163], v[212:215], v[60:63], 0
  v_mfma_f32_32x32x8_bf16 v[148:163], v[216:217], v[64:65], v[148:163]
  s_nop 11
  v_max3_f32 v84, v84, v148, v149
  v_max3_f32 v84, v84, v150, v151
  v_max3_f32 v84, v84, v152, v153
  v_max3_f32 v84, v84, v154, v155
  v_max3_f32 v84, v84, v156, v157
  v_max3_f32 v84, v84, v158, v159
  v_max3_f32 v84, v84, v160, v161
  v_max3_f32 v84, v84, v162, v163
  v_mfma_f32_32x32x16_bf16 v[148:163], v[212:215], v[66:69], 0
  v_mfma_f32_32x32x8_bf16 v[148:163], v[216:217], v[70:71], v[148:163]
  s_nop 11
  v_max3_f32 v85, v85, v148, v149
  v_max3_f32 v85, v85, v150, v151
  v_max3_f32 v85, v85, v152, v153
  v_max3_f32 v85, v85, v154, v155
  v_max3_f32 v85, v85, v156, v157
  v_max3_f32 v85, v85, v158, v159
  v_max3_f32 v85, v85, v160, v161
  v_max3_f32 v85, v85, v162, v163
  v_mfma_f32_32x32x16_bf16 v[148:163], v[212:215], v[72:75], 0
  v_mfma_f32_32x32x8_bf16 v[148:163], v[216:217], v[76:77], v[148:163]
  s_nop 11
  v_max3_f32 v86, v86, v148, v149
  v_max3_f32 v86, v86, v150, v151
  v_max3_f32 v86, v86, v152, v153
  v_max3_f32 v86, v86, v154, v155
  v_max3_f32 v86, v86, v156, v157
  v_max3_f32 v86, v86, v158, v159
  v_max3_f32 v86, v86, v160, v161
  v_max3_f32 v86, v86, v162, v163
  v_mfma_f32_32x32x16_bf16 v[148:163], v[212:215], v[78:81], 0
  v_mfma_f32_32x32x8_bf16 v[148:163], v[216:217], v[82:83], v[148:163]
  s_nop 11
  v_max3_f32 v87, v87, v148, v149
  v_max3_f32 v87, v87, v150, v151
  v_max3_f32 v87, v87, v152, v153
  v_max3_f32 v87, v87, v154, v155
  v_max3_f32 v87, v87, v156, v157
  v_max3_f32 v87, v87, v158, v159
  v_max3_f32 v87, v87, v160, v161
  v_max3_f32 v87, v87, v162, v163
  s_bitcmp1_b32 s22, 0
  s_cselect_b32 s20, 21504, 0
  s_add_u32 s20, s20, 3584
  s_add_u32 s66, s66, s20
  s_addc_u32 s67, s67, 0
  s_sub_u32 s22, s22, 1
  s_cmp_lg_u32 s22, 0
  s_cbranch_scc1 L_fb_loop
  v_mov_b32 v88, v84
  v_mov_b32 v89, v85
  v_mov_b32 v90, v86
  v_mov_b32 v91, v87
  v_permlane32_swap_b32 v84, v88
  v_permlane32_swap_b32 v85, v89
  v_permlane32_swap_b32 v86, v90
  v_permlane32_swap_b32 v87, v91
  v_max_f32 v84, v84, v88
  v_max_f32 v85, v85, v89
  v_max_f32 v86, v86, v90
  v_max_f32 v87, v87, v91
  s_lshl_b32 s20, s6, 10
  s_add_u32 s20, s20, 71680
  v_add_u32 v6, s20, v0
  ds_write_b128 v6, v[84:87]
  s_and_b32 s20, s6, 4
  s_lshl_b32 s20, s20, 10
  s_add_u32 s20, s20, 71680
  v_add_u32 v6, s20, v0
  s_waitcnt lgkmcnt(0)
  s_barrier
  ds_read_b128 v[92:95], v6 offset:0
  ds_read_b128 v[96:99], v6 offset:1024
  ds_read_b128 v[100:103], v6 offset:2048
  ds_read_b128 v[104:107], v6 offset:3072
  v_cmp_gt_u32 vcc, 32, v1
  s_waitcnt lgkmcnt(0)
  s_barrier
  v_max3_f32 v84, v92, v96, v100
  v_max_f32 v84, v84, v104
  v_sub_f32 v84, 0, v84
  v_cvt_pk_bf16_f32 v88, v84, v84
  v_lshlrev_b32 v88, 16, v88
  v_sub_f32 v89, v84, v88
  v_cvt_pk_bf16_f32 v88, v88, v89
  v_cndmask_b32 v64, v88, v64, vcc
  v_max3_f32 v85, v93, v97, v101
  v_max_f32 v85, v85, v105
  v_sub_f32 v85, 0, v85
  v_cvt_pk_bf16_f32 v88, v85, v85
  v_lshlrev_b32 v88, 16, v88
  v_sub_f32 v89, v85, v88
  v_cvt_pk_bf16_f32 v88, v88, v89
  v_cndmask_b32 v70, v88, v70, vcc
  v_max3_f32 v86, v94, v98, v102
  v_max_f32 v86, v86, v106
  v_sub_f32 v86, 0, v86
  v_cvt_pk_bf16_f32 v88, v86, v86
  v_lshlrev_b32 v88, 16, v88
  v_sub_f32 v89, v86, v88
  v_cvt_pk_bf16_f32 v88, v88, v89
  v_cndmask_b32 v76, v88, v76, vcc
  v_max3_f32 v87, v95, v99, v103
  v_max_f32 v87, v87, v107
  v_sub_f32 v87, 0, v87
  v_cvt_pk_bf16_f32 v88, v87, v87
  v_lshlrev_b32 v88, 16, v88
  v_sub_f32 v89, v87, v88
  v_cvt_pk_bf16_f32 v88, v88, v89
  v_cndmask_b32 v82, v88, v82, vcc
  s_mov_b32 s34, 0x01010101
  s_mov_b32 s35, 0x01010101
  global_load_dwordx2 v[240:241], v248, s[60:61] sc1
  s_waitcnt vmcnt(0)
  s_and_b64 s[24:25], s[100:101], s[34:35]
  s_cmp_eq_u64 s[24:25], s[34:35]
  s_cbranch_scc1 SK_nbp_74
  v_cmp_eq_u32 vcc, v249, v240
  v_cmp_eq_u32 s[24:25], v249, v241
  s_nop 0
  s_and_b64 s[24:25], s[24:25], vcc
  s_lshr_b64 s[26:27], s[24:25], 4
  s_and_b64 s[24:25], s[24:25], s[26:27]
  s_lshr_b64 s[26:27], s[24:25], 2
  s_and_b64 s[24:25], s[24:25], s[26:27]
  s_lshr_b64 s[26:27], s[24:25], 1
  s_and_b64 s[24:25], s[24:25], s[26:27]
  s_mov_b64 s[100:101], s[24:25]
  s_and_b64 s[24:25], s[24:25], s[34:35]
  s_cbranch_scc1 SK_nbp_74
  s_mov_b32 s20, 0
L_nbpp_74:
  global_load_dwordx2 v[240:241], v248, s[60:61] sc1
  s_waitcnt vmcnt(0)
  v_cmp_eq_u32 vcc, v249, v240
  v_cmp_eq_u32 s[24:25], v249, v241
  s_nop 0
  s_and_b64 s[24:25], s[24:25], vcc
  s_lshr_b64 s[26:27], s[24:25], 4
  s_and_b64 s[24:25], s[24:25], s[26:27]
  s_lshr_b64 s[26:27], s[24:25], 2
  s_and_b64 s[24:25], s[24:25], s[26:27]
  s_lshr_b64 s[26:27], s[24:25], 1
  s_and_b64 s[24:25], s[24:25], s[26:27]
  s_mov_b64 s[100:101], s[24:25]
  s_and_b64 s[24:25], s[24:25], s[34:35]
  s_cbranch_scc1 SK_nbp_74
  s_add_u32 s20, s20, 1
  s_cmp_lt_u32 s20, s9
  s_cbranch_scc1 L_nbpp_74
  s_mov_b32 s9, 0
  s_mov_b64 s[24:25], s[34:35]
SK_nbp_74:
  s_ff1_i32_b64 s20, s[24:25]
  s_bitset0_b64 s[34:35], s20
  s_mul_i32 s20, s20, 3584
  s_add_u32 s66, s62, s20
  s_addc_u32 s67, s63, 0
  global_load_dwordx4 v[212:215], v0, s[66:67] sc1
  global_load_dwordx2 v[216:217], v5, s[66:67] sc1
  global_load_dwordx4 v[218:221], v4, s[66:67] offset:1536 sc1
  global_load_dwordx4 v[222:225], v4, s[66:67] offset:2560 sc1
  s_branch L_ATT_RUN
L_CODE_END:
.section .rodata,"a"
.p2align 6
.amdhsa_kernel interleave_layers__grouped_kv_mqa__moe_arch_mod__prompt_kernel
  .amdhsa_next_free_vgpr 256
  .amdhsa_next_free_sgpr 102
  .amdhsa_accum_offset 256
  .amdhsa_group_segment_fixed_size 0
  .amdhsa_kernarg_size 104
  .amdhsa_user_sgpr_count 2
  .amdhsa_user_sgpr_kernarg_segment_ptr 1
  .amdhsa_system_sgpr_workgroup_id_x 1
.end_amdhsa_kernel
```
